```python
import torch

def _softmax(x, axis=-1):
    return torch.softmax(x, dim=axis)
def _gelu(x):
    return torch.nn.functional.gelu(x, approximate="tanh")
def _silu(x):
    return torch.nn.functional.silu(x)
def _sigmoid(x):
    return torch.sigmoid(x)
def _layernorm(x, axis=-1, eps=1e-5):
    m = x.mean(dim=axis, keepdim=True)
    v = x.var(dim=axis, keepdim=True, unbiased=False)
    return (x - m) / torch.sqrt(v + eps)
def _scatter_add(tgt, idx, src, axis=0):
    return tgt.clone().index_add_(axis, idx, src)
def _segment_sum(src, seg, n):
    out = torch.zeros((n,) + src.shape[1:], dtype=src.dtype)
    return out.index_add_(0, seg, src)
def _pad(x, pw):
    flat = tuple(v for pair in reversed(pw) for v in pair)
    return torch.nn.functional.pad(x, flat)

kernel_name = 'gated_mix__linear_kernel_hedgehog__dense_activation_relu__prompt'

def setup_inputs():

    _w = (lambda a: (lambda t: t.to(torch.bfloat16) if t.is_floating_point() else t)(torch.as_tensor(a)))
    def _A_setup():
        B, S, D, H = 1, 2048, 512, 32
        Dh = D // H
        return {
            "x": _w((lambda *s: torch.randn(*s, dtype=torch.bfloat16) * 0.05)(B, S, D)),
            "wqkv": _w((lambda *s: torch.randn(*s, dtype=torch.bfloat16) * 0.8)(D, 3 * D)),
            "w_phi": _w((lambda *s: torch.randn(*s, dtype=torch.bfloat16) * 0.8)(H, Dh, Dh) * (Dh ** -0.5)),
            "wo": _w((lambda *s: torch.randn(*s, dtype=torch.bfloat16) * 0.2)(D, D)),
        }
    _A_in = _A_setup()

    def _B_setup():
        B, S, D, Dff = 1, 2048, 512, 1792
        return {
            "x": _w((lambda *s: torch.randn(*s, dtype=torch.bfloat16) * 0.05)(B, S, D)),
            "w1": _w((lambda *s: torch.randn(*s, dtype=torch.bfloat16) * 0.05)(D, Dff)),
            "w2": _w((lambda *s: torch.randn(*s, dtype=torch.bfloat16) * 0.05)(Dff, D)),
        }
    _B_in = _B_setup()

    return {
        "A_x": _A_in["x"],
        "A_wqkv": _A_in["wqkv"],
        "A_w_phi": _A_in["w_phi"],
        "A_wo": _A_in["wo"],
        "B_x": _B_in["x"],
        "B_w1": _B_in["w1"],
        "B_w2": _B_in["w2"],
        "gate_w": _w((lambda *s: torch.randn(*s, dtype=torch.bfloat16) * 0.05)(512) * 16.0),
    }

def reference(A_x, A_wqkv, A_w_phi, A_wo, B_x, B_w1, B_w2, gate_w):
    def _A_ref(x, wqkv, w_phi, wo):
        B, S, D = x.shape
        H = 32; Dh = D // H
        qkv = (lambda x, *d: x.permute(*d))((x @ wqkv).reshape(B, S, 3, H, Dh), 2, 0, 3, 1, 4)
        q, k, v = qkv[0], qkv[1], qkv[2]
        pq = torch.einsum("bhsd,hdf->bhsf", q, w_phi)
        pk = torch.einsum("bhsd,hdf->bhsf", k, w_phi)
        phi_q = torch.concatenate([_softmax(pq, axis=-1), _softmax(-pq, axis=-1)], axis=-1)
        phi_k = torch.concatenate([_softmax(pk, axis=-1), _softmax(-pk, axis=-1)], axis=-1)
        kv = torch.einsum("bhsf,bhsd->bhfd", phi_k, v)
        z  = torch.einsum("bhsf->bhf", phi_k)
        num = torch.einsum("bhqf,bhfd->bhqd", phi_q, kv)
        den = torch.einsum("bhqf,bhf->bhq", phi_q, z)[..., None] + 1e-6
        o = num / den
        return (lambda x, *d: x.permute(*d))(o, 0, 2, 1, 3).reshape(B, S, D) @ wo

    def _B_ref(x, w1, w2):
        h = torch.einsum("bsd,df->bsf", x, w1)
        zero = torch.zeros_like(h)
        h = torch.maximum(h, zero)
        return torch.einsum("bsf,fd->bsd", h, w2)

    x = A_x
    g = _sigmoid((x * gate_w).sum(-1, keepdims=True))
    a = _A_ref(x, A_wqkv, A_w_phi, A_wo)
    b = _B_ref(x, B_w1, B_w2)
    return g * a + (1 - g) * b
```

```asm
; @launch grid=(256,1,1) block=(768,1,1) lds=163840
.amdgcn_target "amdgcn-amd-amdhsa--gfx950"
.text
.globl gated_mix__linear_kernel_hedgehog__dense_activation_relu__prompt_kernel
.p2align 8
.type gated_mix__linear_kernel_hedgehog__dense_activation_relu__prompt_kernel,@function
gated_mix__linear_kernel_hedgehog__dense_activation_relu__prompt_kernel:
    s_load_dwordx16 s[16:31], s[0:1], 0
    s_load_dwordx4 s[32:35], s[0:1], 64
    s_load_dwordx2 s[36:37], s[0:1], 80
    v_lshrrev_b32 v1, 6, v0
    v_and_b32 v0, 63, v0
    v_readfirstlane_b32 s3, v1
    s_cmp_ge_u32 s2, 256
    s_cbranch_scc1 L_exit
    s_lshr_b32 s12, s2, 3
    s_and_b32 s11, s2, 7
    s_and_b32 s4, s11, 1
    s_lshl_b32 s4, s4, 3
    s_and_b32 s9, s12, 7
    s_add_u32 s4, s4, s9
    s_lshr_b32 s13, s12, 3
    s_lshl_b32 s7, s13, 1
    s_add_u32 s7, s7, s4
    s_bfe_u32 s14, s2, 0x10001
    s_add_u32 s7, s7, s14
    s_and_b32 s7, s7, 3
    s_lshl_b32 s7, s7, 1
    s_lshr_b32 s5, s13, 1
    s_and_b32 s6, s11, 6
    s_and_b32 s14, s13, 1
    s_add_u32 s6, s6, s14
    s_lshl_b32 s8, s11, 2
    s_add_u32 s8, s8, s13
    s_and_b32 s10, s3, 3
    s_cmp_ge_u32 s3, 4
    s_cbranch_scc1 L_groupAB
    s_lshl_b32 s88, s10, 10
    v_lshrrev_b32 v8, 3, v0
    v_and_b32 v9, 7, v0
    v_lshrrev_b32 v10, 4, v0
    s_and_b32 s14, s10, 1
    s_lshl_b32 s12, s14, 2
    v_or_b32 v10, s12, v10
    v_xor_b32 v10, v10, v9
    v_lshlrev_b32 v10, 4, v10
    v_lshl_or_b32 v2, v8, 10, v10
    s_lshl_b32 s12, s4, 17
    s_lshl_b32 s13, s10, 13
    s_add_u32 s12, s12, s13
    v_add_u32 v2, s12, v2
    s_lshl_b32 s68, s7, 7
    s_mov_b32 s42, 2097152
    s_mov_b32 s43, 0x20000
    s_mul_i32 s11, s6, 224
    s_bitcmp1_b32 s6, 0
    s_cselect_b32 s84, 32, 0
    s_cselect_b32 s86, 0, 192
    s_add_u32 s84, s84, s11
    s_add_u32 s85, s84, 128
    s_add_u32 s86, s86, s11
    s_lshl_b32 s11, s6, 7
    s_lshl_b32 s12, s14, 10
    s_add_u32 s11, s11, s12
    s_add_u32 s11, s11, 1024
    s_lshl_b32 s12, s84, 1
    s_lshl_b32 s13, s14, 7
    s_add_u32 s12, s12, s13
    s_mov_b32 s87, 3072
    s_cmp_eq_u32 s5, 0
    s_cselect_b32 s101, s11, s12
    s_cselect_b32 s87, s87, 3584
    s_lshl_b32 s46, s87, 9
    s_mov_b32 s47, 0x20000
    v_bfe_u32 v10, v0, 4, 1
    v_lshlrev_b32 v10, 2, v10
    v_xor_b32 v10, v10, v9
    v_lshlrev_b32 v10, 4, v10
    v_mul_u32_u24 v11, s87, v8
    s_lshr_b32 s12, s10, 1
    s_lshl_b32 s89, s14, 12
    s_lshl_b32 s13, s12, 10
    s_add_u32 s89, s89, s13
    s_lshl_b32 s13, s14, 5
    v_xor_b32 v3, s13, v10
    s_mul_i32 s12, s12, s87
    s_lshl_b32 s12, s12, 3
    s_add_u32 s12, s12, s101
    v_add3_u32 v3, v3, v11, s12
    s_lshl_b32 s90, s87, 4
    s_lshl_b32 s13, s87, 6
    s_mul_i32 s76, s7, s13
    s_lshl_b32 s91, s87, 5
    s_add_u32 s92, s90, s91
    s_add_u32 s12, s7, 1
    s_and_b32 s12, s12, 7
    s_lshl_b32 s69, s12, 7
    s_mul_i32 s77, s12, s13
    s_cmp_eq_u32 s5, 0
    s_waitcnt lgkmcnt(0)
    s_mov_b64 s[40:41], s[16:17]
    s_cselect_b64 s[44:45], s[18:19], s[26:27]
    s_add_u32 m0, s88, 0
    s_add_u32 s11, s68, 0
    buffer_load_dwordx4 v2, s[40:43], s11 offen lds
    s_add_u32 m0, s89, 131072
    s_add_u32 s11, s76, 0
    buffer_load_dwordx4 v3, s[44:47], s11 offen lds
    s_add_u32 m0, s88, 4096
    s_add_u32 s11, s68, 32768
    buffer_load_dwordx4 v2, s[40:43], s11 offen lds
    s_add_u32 m0, s89, 133120
    s_add_u32 s11, s76, s90
    buffer_load_dwordx4 v3, s[44:47], s11 offen lds
    s_add_u32 m0, s88, 8192
    s_add_u32 s11, s68, 65536
    buffer_load_dwordx4 v2, s[40:43], s11 offen lds
    s_add_u32 m0, s88, 12288
    s_add_u32 s11, s68, 98304
    buffer_load_dwordx4 v2, s[40:43], s11 offen lds
    s_add_u32 m0, s89, 139264
    s_add_u32 s11, s76, s91
    buffer_load_dwordx4 v3, s[44:47], s11 offen lds
    s_add_u32 m0, s89, 141312
    s_add_u32 s11, s76, s92
    buffer_load_dwordx4 v3, s[44:47], s11 offen lds
    s_add_u32 m0, s88, 16384
    s_add_u32 s11, s69, 0
    buffer_load_dwordx4 v2, s[40:43], s11 offen lds
    s_add_u32 m0, s88, 20480
    s_add_u32 s11, s69, 32768
    buffer_load_dwordx4 v2, s[40:43], s11 offen lds
    s_add_u32 s12, s7, 2
    s_and_b32 s12, s12, 7
    s_lshl_b32 s70, s12, 7
    s_mul_i32 s78, s12, s13
    s_add_u32 s12, s7, 3
    s_and_b32 s12, s12, 7
    s_lshl_b32 s71, s12, 7
    s_mul_i32 s79, s12, s13
    s_add_u32 s12, s7, 4
    s_and_b32 s12, s12, 7
    s_lshl_b32 s72, s12, 7
    s_mul_i32 s80, s12, s13
    s_add_u32 s12, s7, 5
    s_and_b32 s12, s12, 7
    s_lshl_b32 s73, s12, 7
    s_mul_i32 s81, s12, s13
    s_add_u32 s12, s7, 6
    s_and_b32 s12, s12, 7
    s_lshl_b32 s74, s12, 7
    s_mul_i32 s82, s12, s13
    s_add_u32 s12, s7, 7
    s_and_b32 s12, s12, 7
    s_lshl_b32 s75, s12, 7
    s_mul_i32 s83, s12, s13
    s_mov_b64 s[64:65], s[20:21]
    s_mov_b32 s66, 16384
    s_mov_b32 s67, 0x20000
    v_lshlrev_b32 v6, 4, v0
    s_lshl_b32 s93, s10, 9
    s_lshl_b32 s11, s6, 11
    s_add_u32 s11, s11, s93
    s_add_u32 m0, s93, 122880
    s_mov_b32 exec_hi, 0
    buffer_load_dwordx4 v6, s[64:67], s11 offen lds
    s_mov_b64 exec, -1
    s_sub_u32 s38, 6656, s87
    s_lshl_b32 s12, s6, 7
    s_lshl_b32 s14, s85, 1
    s_lshl_b32 s101, s86, 1
    s_cmp_eq_u32 s5, 0
    s_cselect_b32 s14, s14, s12
    s_cselect_b32 s60, s26, s18
    s_cselect_b32 s61, s27, s19
    s_lshl_b32 s62, s38, 9
    s_mov_b32 s63, 0x20000
    s_mul_i32 s12, s10, s38
    s_lshl_b32 s12, s12, 3
    s_add_u32 s14, s14, s12
    v_mul_u32_u24 v11, s38, v8
    v_add3_u32 v4, v10, v11, s14
    v_lshrrev_b32 v5, 2, v0
    v_mul_u32_u24 v5, s38, v5
    v_and_b32 v11, 3, v0
    v_lshl_add_u32 v5, v11, 4, v5
    s_add_u32 s101, s101, s12
    v_add_u32 v5, s101, v5
    s_lshl_b32 s39, s38, 5
    s_mul_i32 s94, s7, s39
    s_lshl_b32 s94, s94, 1
    s_mov_b64 s[48:49], s[28:29]
    s_mov_b32 s50, 1835008
    s_mov_b32 s51, 0x20000
    s_mov_b64 s[52:53], s[22:23]
    s_mov_b32 s54, 524288
    s_mov_b32 s55, 0x20000
    s_mov_b64 s[56:57], s[36:37]
    s_mov_b32 s58, 13631488
    s_mov_b32 s59, 0x20000
    s_cmp_eq_u32 s5, 0
    s_cbranch_scc1 L_D_ffn
    s_setprio 3
    s_add_u32 m0, s88, 24576
    s_add_u32 s11, s69, 65536
    buffer_load_dwordx4 v2, s[40:43], s11 offen lds
    s_add_u32 m0, s88, 28672
    s_add_u32 s11, s69, 98304
    buffer_load_dwordx4 v2, s[40:43], s11 offen lds
    s_add_u32 m0, s89, 147456
    s_add_u32 s11, s77, 0
    buffer_load_dwordx4 v3, s[44:47], s11 offen lds
    s_add_u32 m0, s89, 149504
    s_add_u32 s11, s77, s90
    buffer_load_dwordx4 v3, s[44:47], s11 offen lds
    s_waitcnt vmcnt(9)
    s_barrier
    s_add_u32 m0, s89, 155648
    s_add_u32 s11, s77, s91
    buffer_load_dwordx4 v3, s[44:47], s11 offen lds
    s_add_u32 m0, s89, 157696
    s_add_u32 s11, s77, s92
    buffer_load_dwordx4 v3, s[44:47], s11 offen lds
    s_waitcnt vmcnt(9)
    s_barrier
    s_add_u32 m0, s88, 32768
    s_add_u32 s11, s70, 0
    buffer_load_dwordx4 v2, s[40:43], s11 offen lds
    s_add_u32 m0, s88, 36864
    s_add_u32 s11, s70, 32768
    buffer_load_dwordx4 v2, s[40:43], s11 offen lds
    s_add_u32 m0, s88, 40960
    s_add_u32 s11, s70, 65536
    buffer_load_dwordx4 v2, s[40:43], s11 offen lds
    s_add_u32 m0, s88, 45056
    s_add_u32 s11, s70, 98304
    buffer_load_dwordx4 v2, s[40:43], s11 offen lds
    s_add_u32 m0, s89, 131072
    s_add_u32 s11, s78, 0
    buffer_load_dwordx4 v3, s[44:47], s11 offen lds
    s_add_u32 m0, s89, 133120
    s_add_u32 s11, s78, s90
    buffer_load_dwordx4 v3, s[44:47], s11 offen lds
    s_lshl_b32 s16, s10, 9
    s_lshl_b32 s17, s10, 10
    s_lshl_b32 s18, s10, 11
    v_lshlrev_b32 v6, 4, v0
    v_mov_b32 v16, 0
    v_lshrrev_b32 v8, 3, v0
    v_and_b32 v9, 7, v0
    v_bfe_u32 v10, v0, 4, 1
    v_lshlrev_b32 v10, 2, v10
    v_xor_b32 v10, v10, v9
    v_lshlrev_b32 v10, 4, v10
    v_lshl_or_b32 v7, v8, 10, v10
    s_waitcnt vmcnt(8)
    s_barrier
    s_add_u32 m0, s88, 49152
    s_add_u32 s11, s71, 0
    buffer_load_dwordx4 v2, s[40:43], s11 offen lds
    s_add_u32 m0, s88, 53248
    s_add_u32 s11, s71, 32768
    buffer_load_dwordx4 v2, s[40:43], s11 offen lds
    s_add_u32 m0, s89, 139264
    s_add_u32 s11, s78, s91
    buffer_load_dwordx4 v3, s[44:47], s11 offen lds
    s_add_u32 m0, s89, 141312
    s_add_u32 s11, s78, s92
    buffer_load_dwordx4 v3, s[44:47], s11 offen lds
    s_lshl_b32 s12, s9, 7
    s_lshl_b32 s13, s10, 14
    s_add_u32 s12, s12, s13
    v_add_u32 v7, s12, v7
    s_lshl_b32 s12, s8, 1
    s_lshr_b32 s13, s10, 1
    s_add_u32 s12, s12, s13
    s_mul_i32 s12, s12, 147456
    s_and_b32 s13, s10, 1
    s_lshl_b32 s13, s13, 11
    s_add_u32 s19, s12, s13
    s_lshr_b32 s12, s8, 1
    s_waitcnt vmcnt(10)
    s_barrier
    s_add_u32 m0, s88, 57344
    s_add_u32 s11, s71, 65536
    buffer_load_dwordx4 v2, s[40:43], s11 offen lds
    s_add_u32 m0, s88, 61440
    s_add_u32 s11, s71, 98304
    buffer_load_dwordx4 v2, s[40:43], s11 offen lds
    s_add_u32 m0, s89, 147456
    s_add_u32 s11, s79, 0
    buffer_load_dwordx4 v3, s[44:47], s11 offen lds
    s_add_u32 m0, s89, 149504
    s_add_u32 s11, s79, s90
    buffer_load_dwordx4 v3, s[44:47], s11 offen lds
    s_mul_i32 s12, s12, 4352
    s_add_u32 s20, s12, 10485760
    s_mul_i32 s12, s8, 4352
    s_add_u32 s21, s12, 10555392
    s_add_u32 s22, s12, 10694656
    s_lshr_b32 s33, s9, 1
    s_add_u32 s33, s33, s8
    s_and_b32 s33, s33, 3
    s_and_b32 s13, s9, 1
    s_lshl_b32 s23, s13, 14
    s_xor_b32 s24, s23, 0x4000
    s_lshl_b32 s29, s33, 1
    s_waitcnt vmcnt(8)
    s_barrier
    s_add_u32 m0, s88, 65536
    s_add_u32 s11, s72, 0
    buffer_load_dwordx4 v2, s[40:43], s11 offen lds
    s_add_u32 m0, s88, 69632
    s_add_u32 s11, s72, 32768
    buffer_load_dwordx4 v2, s[40:43], s11 offen lds
    s_add_u32 m0, s89, 155648
    s_add_u32 s11, s79, s91
    buffer_load_dwordx4 v3, s[44:47], s11 offen lds
    s_add_u32 m0, s89, 157696
    s_add_u32 s11, s79, s92
    buffer_load_dwordx4 v3, s[44:47], s11 offen lds
    s_add_u32 s29, s29, s13
    s_lshl_b32 s29, s29, 12
    s_add_u32 s13, s33, 0
    s_and_b32 s13, s13, 3
    s_mul_i32 s25, s13, 28672
    s_add_u32 s13, s33, 1
    s_and_b32 s13, s13, 3
    s_mul_i32 s26, s13, 28672
    s_add_u32 s13, s33, 2
    s_and_b32 s13, s13, 3
    s_mul_i32 s27, s13, 28672
    s_add_u32 s13, s33, 3
    s_waitcnt vmcnt(8)
    s_barrier
    s_add_u32 m0, s88, 73728
    s_add_u32 s11, s72, 65536
    buffer_load_dwordx4 v2, s[40:43], s11 offen lds
    s_add_u32 m0, s88, 77824
    s_add_u32 s11, s72, 98304
    buffer_load_dwordx4 v2, s[40:43], s11 offen lds
    s_add_u32 m0, s89, 131072
    s_add_u32 s11, s80, 0
    buffer_load_dwordx4 v3, s[44:47], s11 offen lds
    s_add_u32 m0, s89, 133120
    s_add_u32 s11, s80, s90
    buffer_load_dwordx4 v3, s[44:47], s11 offen lds
    s_and_b32 s13, s13, 3
    s_mul_i32 s28, s13, 28672
    s_lshl_b32 s12, s4, 3
    s_add_u32 s12, s12, s6
    s_lshl_b32 s12, s12, 2
    s_add_u32 s12, s12, s10
    s_lshl_b32 s12, s12, 7
    v_lshl_add_u32 v18, v0, 16, s12
    s_waitcnt vmcnt(8)
    s_barrier
    s_add_u32 m0, s88, 81920
    s_add_u32 s11, s73, 0
    buffer_load_dwordx4 v2, s[40:43], s11 offen lds
    s_add_u32 m0, s88, 86016
    s_add_u32 s11, s73, 32768
    buffer_load_dwordx4 v2, s[40:43], s11 offen lds
    s_add_u32 m0, s89, 139264
    s_add_u32 s11, s80, s91
    buffer_load_dwordx4 v3, s[44:47], s11 offen lds
    s_add_u32 m0, s89, 141312
    s_add_u32 s11, s80, s92
    buffer_load_dwordx4 v3, s[44:47], s11 offen lds
    s_waitcnt vmcnt(8)
    s_barrier
    s_add_u32 m0, s88, 90112
    s_add_u32 s11, s73, 65536
    buffer_load_dwordx4 v2, s[40:43], s11 offen lds
    s_add_u32 m0, s88, 94208
    s_add_u32 s11, s73, 98304
    buffer_load_dwordx4 v2, s[40:43], s11 offen lds
    s_add_u32 m0, s89, 147456
    s_add_u32 s11, s81, 0
    buffer_load_dwordx4 v3, s[44:47], s11 offen lds
    s_add_u32 m0, s89, 149504
    s_add_u32 s11, s81, s90
    buffer_load_dwordx4 v3, s[44:47], s11 offen lds
    s_waitcnt vmcnt(8)
    s_barrier
    s_add_u32 m0, s88, 98304
    s_add_u32 s11, s74, 0
    buffer_load_dwordx4 v2, s[40:43], s11 offen lds
    s_add_u32 m0, s88, 102400
    s_add_u32 s11, s74, 32768
    buffer_load_dwordx4 v2, s[40:43], s11 offen lds
    s_add_u32 m0, s89, 155648
    s_add_u32 s11, s81, s91
    buffer_load_dwordx4 v3, s[44:47], s11 offen lds
    s_add_u32 m0, s89, 157696
    s_add_u32 s11, s81, s92
    buffer_load_dwordx4 v3, s[44:47], s11 offen lds
    s_waitcnt vmcnt(8)
    s_barrier
    s_add_u32 m0, s88, 106496
    s_add_u32 s11, s74, 65536
    buffer_load_dwordx4 v2, s[40:43], s11 offen lds
    s_add_u32 m0, s88, 110592
    s_add_u32 s11, s74, 98304
    buffer_load_dwordx4 v2, s[40:43], s11 offen lds
    s_add_u32 m0, s89, 131072
    s_add_u32 s11, s82, 0
    buffer_load_dwordx4 v3, s[44:47], s11 offen lds
    s_add_u32 m0, s89, 133120
    s_add_u32 s11, s82, s90
    buffer_load_dwordx4 v3, s[44:47], s11 offen lds
    s_waitcnt vmcnt(8)
    s_barrier
    s_add_u32 m0, s88, 114688
    s_add_u32 s11, s75, 0
    buffer_load_dwordx4 v2, s[40:43], s11 offen lds
    s_add_u32 m0, s88, 118784
    s_add_u32 s11, s75, 32768
    buffer_load_dwordx4 v2, s[40:43], s11 offen lds
    s_add_u32 m0, s89, 139264
    s_add_u32 s11, s82, s91
    buffer_load_dwordx4 v3, s[44:47], s11 offen lds
    s_add_u32 m0, s89, 141312
    s_add_u32 s11, s82, s92
    buffer_load_dwordx4 v3, s[44:47], s11 offen lds
    s_waitcnt vmcnt(8)
    s_barrier
    s_add_u32 m0, s88, 122880
    s_add_u32 s11, s75, 65536
    buffer_load_dwordx4 v2, s[40:43], s11 offen lds
    s_add_u32 m0, s88, 126976
    s_add_u32 s11, s75, 98304
    buffer_load_dwordx4 v2, s[40:43], s11 offen lds
    s_add_u32 m0, s89, 147456
    s_add_u32 s11, s83, 0
    buffer_load_dwordx4 v3, s[44:47], s11 offen lds
    s_add_u32 m0, s89, 149504
    s_add_u32 s11, s83, s90
    buffer_load_dwordx4 v3, s[44:47], s11 offen lds
    s_load_dword s15, s[34:35], 0
    s_waitcnt vmcnt(8)
    s_barrier
    s_add_u32 m0, s89, 155648
    s_add_u32 s11, s83, s91
    buffer_load_dwordx4 v3, s[44:47], s11 offen lds
    s_add_u32 m0, s89, 157696
    s_add_u32 s11, s83, s92
    buffer_load_dwordx4 v3, s[44:47], s11 offen lds
    s_waitcnt lgkmcnt(0)
    s_cmp_lg_u32 s15, 0
    s_cbranch_scc1 L_nok_1
    s_mov_b32 s100, 0
L_nlp_2:
    s_sleep 16
    v_mov_b32 v17, 0
    global_load_dword v17, v17, s[34:35] sc1
    s_waitcnt vmcnt(0)
    s_nop 0
    v_readfirstlane_b32 s15, v17
    s_add_u32 s100, s100, 1
    s_cmp_ge_u32 s100, 20000
    s_cbranch_scc1 L_nok_1
    s_cmp_eq_u32 s15, 0
    s_cbranch_scc1 L_nlp_2
L_nok_1:
    v_mov_b32 v17, s15
    s_mov_b64 s[44:45], s[60:61]
    s_mov_b32 s46, s62
    s_mul_i32 s76, s68, s38
    s_lshr_b32 s76, s76, 1
    s_mul_i32 s77, s69, s38
    s_lshr_b32 s77, s77, 1
    s_mul_i32 s78, s70, s38
    s_lshr_b32 s78, s78, 1
    s_mul_i32 s79, s71, s38
    s_lshr_b32 s79, s79, 1
    s_mul_i32 s80, s72, s38
    s_lshr_b32 s80, s80, 1
    s_mul_i32 s81, s73, s38
    s_lshr_b32 s81, s81, 1
    s_mul_i32 s82, s74, s38
    s_lshr_b32 s82, s82, 1
    s_mul_i32 s83, s75, s38
    s_lshr_b32 s83, s83, 1
    s_waitcnt vmcnt(6)
    s_barrier
    s_add_u32 m0, s88, 131072
    s_add_u32 s11, s76, s39
    buffer_load_dwordx4 v4, s[44:47], s76 offen lds
    s_add_u32 m0, s88, 135168
    s_add_u32 s11, s76, s39
    buffer_load_dwordx4 v4, s[44:47], s11 offen lds
    s_waitcnt vmcnt(4)
    s_barrier
    s_add_u32 m0, s88, 139264
    s_add_u32 s11, s77, s39
    buffer_load_dwordx4 v4, s[44:47], s77 offen lds
    s_add_u32 m0, s88, 143360
    s_add_u32 s11, s77, s39
    buffer_load_dwordx4 v4, s[44:47], s11 offen lds
    s_waitcnt vmcnt(4)
    s_barrier
    s_add_u32 m0, s88, 147456
    s_add_u32 s11, s78, s39
    buffer_load_dwordx4 v4, s[44:47], s78 offen lds
    s_add_u32 m0, s88, 151552
    s_add_u32 s11, s78, s39
    buffer_load_dwordx4 v4, s[44:47], s11 offen lds
    s_mov_b32 s42, s15
    s_mov_b32 s43, s15
    s_waitcnt vmcnt(4)
    s_barrier
    s_add_u32 m0, s88, 155648
    s_add_u32 s11, s79, s39
    buffer_load_dwordx4 v4, s[44:47], s79 offen lds
    s_add_u32 m0, s88, 159744
    s_add_u32 s11, s79, s39
    buffer_load_dwordx4 v4, s[44:47], s11 offen lds
    s_waitcnt vmcnt(4)
    s_barrier
    s_waitcnt vmcnt(2)
    s_barrier
    s_add_u32 m0, s88, 131072
    s_add_u32 s11, s80, s39
    buffer_load_dwordx4 v4, s[44:47], s80 offen lds
    s_add_u32 m0, s88, 135168
    s_add_u32 s11, s80, s39
    buffer_load_dwordx4 v4, s[44:47], s11 offen lds
    s_add_u32 m0, s88, 0
    s_add_u32 s11, s81, s39
    buffer_load_dwordx4 v4, s[44:47], s81 offen lds
    s_add_u32 m0, s88, 4096
    s_add_u32 s11, s81, s39
    buffer_load_dwordx4 v4, s[44:47], s11 offen lds
    s_add_u32 m0, s88, 8192
    s_add_u32 s11, s82, s39
    buffer_load_dwordx4 v4, s[44:47], s82 offen lds
    s_add_u32 m0, s88, 12288
    s_add_u32 s11, s82, s39
    buffer_load_dwordx4 v4, s[44:47], s11 offen lds
    s_waitcnt vmcnt(6)
    s_barrier
    s_add_u32 m0, s88, 139264
    s_add_u32 s11, s83, s39
    buffer_load_dwordx4 v4, s[44:47], s83 offen lds
    s_add_u32 m0, s88, 143360
    s_add_u32 s11, s83, s39
    buffer_load_dwordx4 v4, s[44:47], s11 offen lds
    s_lshl_b32 s12, s10, 2
    s_add_u32 s12, s12, 24576
    v_mov_b32 v8, s12
    v_lshlrev_b32 v9, 2, v0
    v_add_u32 v9, 25600, v9
    v_cmp_eq_u32 vcc, 0, v0
    v_mov_b32 v16, 24576
    s_mov_b32 s95, 0
    v_cndmask_b32 v21, v9, v8, vcc
    v_lshlrev_b32 v9, 2, v0
    v_add_u32 v9, 24576, v9
    v_mov_b32 v8, 0
    ds_write_b32 v9, v8
    s_waitcnt lgkmcnt(0)
    s_waitcnt vmcnt(6)
    s_barrier
    s_waitcnt vmcnt(4)
    s_barrier
    s_add_u32 s12, s25, s23
    s_add_u32 m0, s18, 16384
    s_lshl_b32 s11, s12, 4
    buffer_load_dwordx4 v7, s[48:51], s11 offen lds
    s_add_u32 m0, s18, 17408
    s_add_u32 s11, s11, 8192
    buffer_load_dwordx4 v7, s[48:51], s11 offen lds
    s_add_u32 s12, s25, s23
    s_add_u32 s12, s12, 4096
    s_add_u32 m0, s18, 32768
    s_lshl_b32 s11, s12, 4
    buffer_load_dwordx4 v7, s[48:51], s11 offen lds
    s_add_u32 m0, s18, 33792
    s_add_u32 s11, s11, 8192
    buffer_load_dwordx4 v7, s[48:51], s11 offen lds
    s_waitcnt vmcnt(6)
    s_barrier
    s_add_u32 s12, s25, s24
    s_add_u32 m0, s18, 40960
    s_lshl_b32 s11, s12, 4
    buffer_load_dwordx4 v7, s[48:51], s11 offen lds
    s_add_u32 m0, s18, 41984
    s_add_u32 s11, s11, 8192
    buffer_load_dwordx4 v7, s[48:51], s11 offen lds
    s_add_u32 s12, s25, s24
    s_add_u32 s12, s12, 4096
    s_add_u32 m0, s18, 49152
    s_lshl_b32 s11, s12, 4
    buffer_load_dwordx4 v7, s[48:51], s11 offen lds
    s_add_u32 m0, s18, 50176
    s_add_u32 s11, s11, 8192
    buffer_load_dwordx4 v7, s[48:51], s11 offen lds
    s_waitcnt vmcnt(8)
    s_barrier
    s_add_u32 s12, s26, s23
    s_add_u32 m0, s18, 57344
    s_lshl_b32 s11, s12, 4
    buffer_load_dwordx4 v7, s[48:51], s11 offen lds
    s_add_u32 m0, s18, 58368
    s_add_u32 s11, s11, 8192
    buffer_load_dwordx4 v7, s[48:51], s11 offen lds
    s_add_u32 s12, s26, s23
    s_add_u32 s12, s12, 4096
    s_add_u32 m0, s18, 155648
    s_lshl_b32 s11, s12, 4
    buffer_load_dwordx4 v7, s[48:51], s11 offen lds
    s_add_u32 m0, s18, 156672
    s_add_u32 s11, s11, 8192
    buffer_load_dwordx4 v7, s[48:51], s11 offen lds
    s_barrier
    s_add_u32 s12, s26, s24
    s_add_u32 m0, s18, 65536
    s_lshl_b32 s11, s12, 4
    buffer_load_dwordx4 v7, s[48:51], s11 offen lds
    s_add_u32 m0, s18, 66560
    s_add_u32 s11, s11, 8192
    buffer_load_dwordx4 v7, s[48:51], s11 offen lds
    s_add_u32 s12, s26, s24
    s_add_u32 s12, s12, 4096
    s_add_u32 m0, s18, 73728
    s_lshl_b32 s11, s12, 4
    buffer_load_dwordx4 v7, s[48:51], s11 offen lds
    s_add_u32 m0, s18, 74752
    s_add_u32 s11, s11, 8192
    buffer_load_dwordx4 v7, s[48:51], s11 offen lds
    s_barrier
    s_add_u32 s12, s27, s23
    s_add_u32 m0, s18, 131072
    s_lshl_b32 s11, s12, 4
    buffer_load_dwordx4 v7, s[48:51], s11 offen lds
    s_add_u32 m0, s18, 132096
    s_add_u32 s11, s11, 8192
    buffer_load_dwordx4 v7, s[48:51], s11 offen lds
    s_add_u32 s12, s27, s23
    s_add_u32 s12, s12, 4096
    s_add_u32 m0, s18, 81920
    s_lshl_b32 s11, s12, 4
    buffer_load_dwordx4 v7, s[48:51], s11 offen lds
    s_add_u32 m0, s18, 82944
    s_add_u32 s11, s11, 8192
    buffer_load_dwordx4 v7, s[48:51], s11 offen lds
    s_cmp_lg_u32 s10, 0
    s_cbranch_scc1 L_pi_3
    s_add_u32 s13, s33, 0
    s_and_b32 s13, s13, 3
    s_mul_i32 s13, s13, 32
    s_add_u32 s40, s20, s13
    s_add_u32 s13, s33, 1
    s_and_b32 s13, s13, 3
    s_mul_i32 s13, s13, 32
    s_add_u32 s41, s20, s13
    s_load_dwordx8 s[60:67], s[56:57], s40 glc
    s_load_dwordx8 s[68:75], s[56:57], s41 glc
L_pi_3:
    s_cmp_lg_u32 s10, 0
    s_cbranch_scc1 L_gdn_6
    s_mov_b32 s100, 0
L_glp_5:
    s_waitcnt lgkmcnt(0)
    s_xor_b64 s[60:61], s[60:61], s[42:43]
    s_xor_b64 s[62:63], s[62:63], s[42:43]
    s_xor_b64 s[64:65], s[64:65], s[42:43]
    s_xor_b64 s[66:67], s[66:67], s[42:43]
    s_xor_b64 s[68:69], s[68:69], s[42:43]
    s_xor_b64 s[70:71], s[70:71], s[42:43]
    s_xor_b64 s[72:73], s[72:73], s[42:43]
    s_xor_b64 s[74:75], s[74:75], s[42:43]
    s_or_b64 s[60:61], s[60:61], s[62:63]
    s_or_b64 s[60:61], s[60:61], s[64:65]
    s_or_b64 s[60:61], s[60:61], s[66:67]
    s_or_b64 s[60:61], s[60:61], s[68:69]
    s_or_b64 s[60:61], s[60:61], s[70:71]
    s_or_b64 s[60:61], s[60:61], s[72:73]
    s_or_b64 s[60:61], s[60:61], s[74:75]
    s_cbranch_scc0 L_gok_4
    s_add_u32 s100, s100, 1
    s_cmp_ge_u32 s100, 20000
    s_cbranch_scc1 L_gok_4
    s_sleep 3
    s_load_dwordx8 s[60:67], s[56:57], s40 glc
    s_load_dwordx8 s[68:75], s[56:57], s41 glc
    s_branch L_glp_5
L_gok_4:
    v_mov_b32 v11, 1
    ds_write_b32 v21, v11 offset:48
    s_nop 0
    s_branch L_gfn_7
L_gdn_6:
    s_mov_b32 s100, 0
L_gl2_8:
    ds_read_b32 v10, v16 offset:48
    s_add_u32 s100, s100, 1
    s_waitcnt lgkmcnt(0)
    v_readfirstlane_b32 s11, v10
    s_cmp_ge_u32 s100, 0x80000
    s_cbranch_scc1 L_gfn_7
    s_cmp_lt_u32 s11, 1
    s_cbranch_scc1 L_gl2_8
    s_nop 0
L_gfn_7:
    s_add_u32 s12, s25, s23
    s_add_u32 m0, s18, 90112
    s_add_u32 s11, s19, s12
    buffer_load_dwordx4 v6, s[56:59], s11 offen sc1 lds
    buffer_load_dwordx4 v6, s[56:59], s11 offen offset:1024 sc1 lds
    s_add_u32 s12, s25, s23
    s_add_u32 s12, s12, 4096
    s_add_u32 m0, s18, 0
    s_add_u32 s11, s19, s12
    buffer_load_dwordx4 v6, s[56:59], s11 offen sc1 lds
    buffer_load_dwordx4 v6, s[56:59], s11 offen offset:1024 sc1 lds
    s_add_u32 s12, s25, s24
    s_add_u32 m0, s18, 98304
    s_add_u32 s11, s19, s12
    buffer_load_dwordx4 v6, s[56:59], s11 offen sc1 lds
    buffer_load_dwordx4 v6, s[56:59], s11 offen offset:1024 sc1 lds
    s_add_u32 s12, s25, s24
    s_add_u32 s12, s12, 4096
    s_add_u32 m0, s18, 106496
    s_add_u32 s11, s19, s12
    buffer_load_dwordx4 v6, s[56:59], s11 offen sc1 lds
    buffer_load_dwordx4 v6, s[56:59], s11 offen offset:1024 sc1 lds
    s_add_u32 s12, s26, s23
    s_add_u32 m0, s18, 8192
    s_add_u32 s11, s19, s12
    buffer_load_dwordx4 v6, s[56:59], s11 offen sc1 lds
    buffer_load_dwordx4 v6, s[56:59], s11 offen offset:1024 sc1 lds
    s_add_u32 s12, s26, s23
    s_add_u32 s12, s12, 4096
    s_add_u32 m0, s18, 114688
    s_add_u32 s11, s19, s12
    buffer_load_dwordx4 v6, s[56:59], s11 offen sc1 lds
    buffer_load_dwordx4 v6, s[56:59], s11 offen offset:1024 sc1 lds
    s_waitcnt vmcnt(6)
    v_mov_b32 v11, 1
    ds_write_b32 v21, v11 offset:0
    s_mov_b32 s100, 0
    v_mov_b32 v11, 2
    s_nop 1
L_dw_9:
    s_getreg_b32 s11, hwreg(HW_REG_IB_STS, 0, 4)
    s_getreg_b32 s12, hwreg(HW_REG_IB_STS, 22, 2)
    s_lshl4_add_u32 s11, s12, s11
    s_cmp_gt_u32 s11, 0
    s_cbranch_scc1 L_dn_11
    s_waitcnt vmcnt(0)
    ds_write_b32 v21, v11
L_dn_11:
L_do_10:
    s_cmp_lg_u32 s10, 0
    s_cbranch_scc1 L_pi_12
    s_add_u32 s13, s33, 2
    s_and_b32 s13, s13, 3
    s_mul_i32 s13, s13, 32
    s_add_u32 s40, s20, s13
    s_load_dwordx8 s[60:67], s[56:57], s40 glc
L_pi_12:
    s_waitcnt vmcnt(4)
    s_add_u32 s12, s26, s24
    s_add_u32 m0, s18, 122880
    s_add_u32 s11, s19, s12
    buffer_load_dwordx4 v6, s[56:59], s11 offen sc1 lds
    buffer_load_dwordx4 v6, s[56:59], s11 offen offset:1024 sc1 lds
    s_waitcnt vmcnt(4)
    s_add_u32 s12, s26, s24
    s_add_u32 s12, s12, 4096
    s_add_u32 m0, s18, 139264
    s_add_u32 s11, s19, s12
    buffer_load_dwordx4 v6, s[56:59], s11 offen sc1 lds
    buffer_load_dwordx4 v6, s[56:59], s11 offen offset:1024 sc1 lds
    s_waitcnt vmcnt(4)
    v_mov_b32 v11, 2
    ds_write_b32 v21, v11 offset:0
    s_mov_b32 s100, 0
    v_mov_b32 v11, 3
    s_nop 1
L_dw_13:
    ds_read_b128 v[24:27], v16 offset:32
    s_add_u32 s100, s100, 1
    s_waitcnt lgkmcnt(0)
    v_min3_u32 v24, v24, v25, v26
    v_min_u32 v24, v24, v27
    s_nop 0
    v_readfirstlane_b32 s95, v24
    s_cmp_ge_u32 s100, 0x40000
    s_cbranch_scc1 L_do_14
    s_cmp_lt_u32 s95, 1
    s_cbranch_scc1 L_dw_13
    s_nop 0
L_do_14:
    s_cmp_lg_u32 s10, 0
    s_cbranch_scc1 L_gdn_18
    s_mov_b32 s100, 0
L_glp_17:
    s_waitcnt lgkmcnt(0)
    s_xor_b64 s[60:61], s[60:61], s[42:43]
    s_xor_b64 s[62:63], s[62:63], s[42:43]
    s_xor_b64 s[64:65], s[64:65], s[42:43]
    s_xor_b64 s[66:67], s[66:67], s[42:43]
    s_or_b64 s[60:61], s[60:61], s[62:63]
    s_or_b64 s[60:61], s[60:61], s[64:65]
    s_or_b64 s[60:61], s[60:61], s[66:67]
    s_cbranch_scc0 L_gok_16
    s_add_u32 s100, s100, 1
    s_cmp_ge_u32 s100, 20000
    s_cbranch_scc1 L_gok_16
    s_sleep 3
    s_load_dwordx8 s[60:67], s[56:57], s40 glc
    s_branch L_glp_17
L_gok_16:
    v_mov_b32 v11, 2
    ds_write_b32 v21, v11 offset:48
    s_nop 0
    s_branch L_gfn_19
L_gdn_18:
    s_mov_b32 s100, 0
L_gl2_20:
    ds_read_b32 v10, v16 offset:48
    s_add_u32 s100, s100, 1
    s_waitcnt lgkmcnt(0)
    v_readfirstlane_b32 s11, v10
    s_cmp_ge_u32 s100, 0x80000
    s_cbranch_scc1 L_gfn_19
    s_cmp_lt_u32 s11, 2
    s_cbranch_scc1 L_gl2_20
    s_nop 0
L_gfn_19:
    s_cmp_lg_u32 s10, 0
    s_cbranch_scc1 L_pi_21
    s_add_u32 s13, s33, 3
    s_and_b32 s13, s13, 3
    s_mul_i32 s13, s13, 32
    s_add_u32 s40, s20, s13
    s_load_dwordx8 s[60:67], s[56:57], s40 glc
L_pi_21:
    s_add_u32 s12, s27, s23
    s_add_u32 m0, s18, 90112
    s_add_u32 s11, s19, s12
    buffer_load_dwordx4 v6, s[56:59], s11 offen sc1 lds
    buffer_load_dwordx4 v6, s[56:59], s11 offen offset:1024 sc1 lds
    s_waitcnt vmcnt(4)
    s_add_u32 s12, s27, s23
    s_add_u32 s12, s12, 4096
    s_add_u32 m0, s18, 16384
    s_add_u32 s11, s19, s12
    buffer_load_dwordx4 v6, s[56:59], s11 offen sc1 lds
    buffer_load_dwordx4 v6, s[56:59], s11 offen offset:1024 sc1 lds
    s_waitcnt vmcnt(4)
    s_add_u32 s12, s27, s24
    s_add_u32 m0, s18, 0
    s_add_u32 s11, s19, s12
    buffer_load_dwordx4 v6, s[56:59], s11 offen sc1 lds
    buffer_load_dwordx4 v6, s[56:59], s11 offen offset:1024 sc1 lds
    s_waitcnt vmcnt(4)
    s_add_u32 s12, s27, s24
    s_add_u32 m0, s18, 32768
    s_lshl_b32 s11, s12, 4
    buffer_load_dwordx4 v7, s[48:51], s11 offen lds
    s_add_u32 m0, s18, 33792
    s_add_u32 s11, s11, 8192
    buffer_load_dwordx4 v7, s[48:51], s11 offen lds
    s_waitcnt vmcnt(4)
    s_add_u32 s12, s27, s24
    s_add_u32 s12, s12, 4096
    s_add_u32 m0, s18, 98304
    s_lshl_b32 s11, s12, 4
    buffer_load_dwordx4 v7, s[48:51], s11 offen lds
    s_add_u32 m0, s18, 99328
    s_add_u32 s11, s11, 8192
    buffer_load_dwordx4 v7, s[48:51], s11 offen lds
    s_waitcnt vmcnt(4)
    s_add_u32 s12, s28, s23
    s_add_u32 m0, s18, 40960
    s_lshl_b32 s11, s12, 4
    buffer_load_dwordx4 v7, s[48:51], s11 offen lds
    s_add_u32 m0, s18, 41984
    s_add_u32 s11, s11, 8192
    buffer_load_dwordx4 v7, s[48:51], s11 offen lds
    v_mov_b32 v11, 3
    ds_write_b32 v21, v11 offset:0
    s_mov_b32 s100, 0
    v_mov_b32 v11, 4
    s_nop 1
L_dw_22:
    ds_read_b128 v[24:27], v16 offset:32
    s_add_u32 s100, s100, 1
    s_waitcnt lgkmcnt(0)
    v_min3_u32 v24, v24, v25, v26
    v_min_u32 v24, v24, v27
    s_nop 0
    v_readfirstlane_b32 s95, v24
    s_cmp_ge_u32 s100, 0x40000
    s_cbranch_scc1 L_do_23
    s_cmp_lt_u32 s95, 2
    s_cbranch_scc1 L_dw_22
    s_nop 0
L_do_23:
    s_cmp_lg_u32 s10, 0
    s_cbranch_scc1 L_gdn_27
    s_mov_b32 s100, 0
L_glp_26:
    s_waitcnt lgkmcnt(0)
    s_xor_b64 s[60:61], s[60:61], s[42:43]
    s_xor_b64 s[62:63], s[62:63], s[42:43]
    s_xor_b64 s[64:65], s[64:65], s[42:43]
    s_xor_b64 s[66:67], s[66:67], s[42:43]
    s_or_b64 s[60:61], s[60:61], s[62:63]
    s_or_b64 s[60:61], s[60:61], s[64:65]
    s_or_b64 s[60:61], s[60:61], s[66:67]
    s_cbranch_scc0 L_gok_25
    s_add_u32 s100, s100, 1
    s_cmp_ge_u32 s100, 20000
    s_cbranch_scc1 L_gok_25
    s_sleep 3
    s_load_dwordx8 s[60:67], s[56:57], s40 glc
    s_branch L_glp_26
L_gok_25:
    v_mov_b32 v11, 3
    ds_write_b32 v21, v11 offset:48
    s_nop 0
    s_branch L_gfn_28
L_gdn_27:
    s_mov_b32 s100, 0
L_gl2_29:
    ds_read_b32 v10, v16 offset:48
    s_add_u32 s100, s100, 1
    s_waitcnt lgkmcnt(0)
    v_readfirstlane_b32 s11, v10
    s_cmp_ge_u32 s100, 0x80000
    s_cbranch_scc1 L_gfn_28
    s_cmp_lt_u32 s11, 3
    s_cbranch_scc1 L_gl2_29
    s_nop 0
L_gfn_28:
    s_cmp_lg_u32 s10, 0
    s_cbranch_scc1 L_pi_30
    s_add_u32 s13, s33, 0
    s_and_b32 s13, s13, 3
    s_mul_i32 s13, s13, 16
    s_add_u32 s40, s21, s13
    s_load_dwordx4 s[60:63], s[56:57], s40 glc
L_pi_30:
    s_waitcnt vmcnt(4)
    s_add_u32 s12, s27, s24
    s_add_u32 s12, s12, 4096
    s_add_u32 m0, s18, 106496
    s_add_u32 s11, s19, s12
    buffer_load_dwordx4 v6, s[56:59], s11 offen sc1 lds
    buffer_load_dwordx4 v6, s[56:59], s11 offen offset:1024 sc1 lds
    s_waitcnt vmcnt(4)
    s_add_u32 s12, s28, s23
    s_add_u32 m0, s18, 49152
    s_add_u32 s11, s19, s12
    buffer_load_dwordx4 v6, s[56:59], s11 offen sc1 lds
    buffer_load_dwordx4 v6, s[56:59], s11 offen offset:1024 sc1 lds
    s_waitcnt vmcnt(4)
    s_add_u32 s12, s28, s23
    s_add_u32 s12, s12, 4096
    s_add_u32 m0, s18, 8192
    s_add_u32 s11, s19, s12
    buffer_load_dwordx4 v6, s[56:59], s11 offen sc1 lds
    buffer_load_dwordx4 v6, s[56:59], s11 offen offset:1024 sc1 lds
    s_waitcnt vmcnt(4)
    s_add_u32 s12, s28, s23
    s_add_u32 s12, s12, 4096
    s_add_u32 m0, s18, 57344
    s_lshl_b32 s11, s12, 4
    buffer_load_dwordx4 v7, s[48:51], s11 offen lds
    s_add_u32 m0, s18, 58368
    s_add_u32 s11, s11, 8192
    buffer_load_dwordx4 v7, s[48:51], s11 offen lds
    s_waitcnt vmcnt(4)
    s_add_u32 s12, s28, s24
    s_add_u32 m0, s18, 114688
    s_lshl_b32 s11, s12, 4
    buffer_load_dwordx4 v7, s[48:51], s11 offen lds
    s_add_u32 m0, s18, 115712
    s_add_u32 s11, s11, 8192
    buffer_load_dwordx4 v7, s[48:51], s11 offen lds
    s_waitcnt vmcnt(4)
    s_add_u32 s12, s28, s24
    s_add_u32 s12, s12, 4096
    s_add_u32 m0, s18, 155648
    s_lshl_b32 s11, s12, 4
    buffer_load_dwordx4 v7, s[48:51], s11 offen lds
    s_add_u32 m0, s18, 156672
    s_add_u32 s11, s11, 8192
    buffer_load_dwordx4 v7, s[48:51], s11 offen lds
    v_mov_b32 v11, 4
    ds_write_b32 v21, v11 offset:0
    s_mov_b32 s100, 0
    v_mov_b32 v11, 5
    s_nop 1
L_dw_31:
    ds_read_b128 v[24:27], v16 offset:32
    s_add_u32 s100, s100, 1
    s_waitcnt lgkmcnt(0)
    v_min3_u32 v24, v24, v25, v26
    v_min_u32 v24, v24, v27
    s_nop 0
    v_readfirstlane_b32 s95, v24
    s_cmp_ge_u32 s100, 0x40000
    s_cbranch_scc1 L_do_32
    s_cmp_lt_u32 s95, 3
    s_cbranch_scc1 L_dw_31
    s_nop 0
L_do_32:
    s_cmp_lg_u32 s10, 0
    s_cbranch_scc1 L_gdn_36
    s_mov_b32 s100, 0
L_glp_35:
    s_waitcnt lgkmcnt(0)
    s_xor_b64 s[60:61], s[60:61], s[42:43]
    s_xor_b64 s[62:63], s[62:63], s[42:43]
    s_or_b64 s[60:61], s[60:61], s[62:63]
    s_cbranch_scc0 L_gok_34
    s_add_u32 s100, s100, 1
    s_cmp_ge_u32 s100, 20000
    s_cbranch_scc1 L_gok_34
    s_sleep 3
    s_load_dwordx4 s[60:63], s[56:57], s40 glc
    s_branch L_glp_35
L_gok_34:
    v_mov_b32 v11, 4
    ds_write_b32 v21, v11 offset:48
    s_nop 0
    s_branch L_gfn_37
L_gdn_36:
    s_mov_b32 s100, 0
L_gl2_38:
    ds_read_b32 v10, v16 offset:48
    s_add_u32 s100, s100, 1
    s_waitcnt lgkmcnt(0)
    v_readfirstlane_b32 s11, v10
    s_cmp_ge_u32 s100, 0x80000
    s_cbranch_scc1 L_gfn_37
    s_cmp_lt_u32 s11, 4
    s_cbranch_scc1 L_gl2_38
    s_nop 0
L_gfn_37:
    s_cmp_lg_u32 s10, 0
    s_cbranch_scc1 L_pi_39
    s_add_u32 s13, s33, 1
    s_and_b32 s13, s13, 3
    s_mul_i32 s13, s13, 16
    s_add_u32 s40, s21, s13
    s_load_dwordx4 s[60:63], s[56:57], s40 glc
L_pi_39:
    s_waitcnt vmcnt(4)
    s_add_u32 s12, s28, s24
    s_add_u32 m0, s18, 122880
    s_add_u32 s11, s19, s12
    buffer_load_dwordx4 v6, s[56:59], s11 offen sc1 lds
    buffer_load_dwordx4 v6, s[56:59], s11 offen offset:1024 sc1 lds
    s_waitcnt vmcnt(4)
    s_add_u32 s12, s28, s24
    s_add_u32 s12, s12, 4096
    s_add_u32 m0, s18, 65536
    s_add_u32 s11, s19, s12
    buffer_load_dwordx4 v6, s[56:59], s11 offen sc1 lds
    buffer_load_dwordx4 v6, s[56:59], s11 offen offset:1024 sc1 lds
    s_waitcnt vmcnt(4)
    s_add_u32 s12, s25, 8192
    s_add_u32 m0, s18, 139264
    s_add_u32 s11, s19, s12
    buffer_load_dwordx4 v6, s[56:59], s11 offen sc1 lds
    buffer_load_dwordx4 v6, s[56:59], s11 offen offset:1024 sc1 lds
    s_waitcnt vmcnt(4)
    s_add_u32 s12, s25, 8192
    s_add_u32 m0, s18, 73728
    s_lshl_b32 s11, s12, 4
    buffer_load_dwordx4 v7, s[48:51], s11 offen lds
    s_add_u32 m0, s18, 74752
    s_add_u32 s11, s11, 8192
    buffer_load_dwordx4 v7, s[48:51], s11 offen lds
    s_waitcnt vmcnt(4)
    s_add_u32 s12, s25, 12288
    s_add_u32 m0, s18, 90112
    s_lshl_b32 s11, s12, 4
    buffer_load_dwordx4 v7, s[48:51], s11 offen lds
    s_add_u32 m0, s18, 91136
    s_add_u32 s11, s11, 8192
    buffer_load_dwordx4 v7, s[48:51], s11 offen lds
    s_waitcnt vmcnt(4)
    s_add_u32 s12, s25, 24576
    s_add_u32 m0, s18, 131072
    s_lshl_b32 s11, s12, 4
    buffer_load_dwordx4 v7, s[48:51], s11 offen lds
    s_add_u32 m0, s18, 132096
    s_add_u32 s11, s11, 8192
    buffer_load_dwordx4 v7, s[48:51], s11 offen lds
    s_cmp_lg_u32 s10, 0
    s_cbranch_scc1 L_gdn_42
    s_mov_b32 s100, 0
L_glp_41:
    s_waitcnt lgkmcnt(0)
    s_xor_b64 s[60:61], s[60:61], s[42:43]
    s_xor_b64 s[62:63], s[62:63], s[42:43]
    s_or_b64 s[60:61], s[60:61], s[62:63]
    s_cbranch_scc0 L_gok_40
    s_add_u32 s100, s100, 1
    s_cmp_ge_u32 s100, 20000
    s_cbranch_scc1 L_gok_40
    s_sleep 3
    s_load_dwordx4 s[60:63], s[56:57], s40 glc
    s_branch L_glp_41
L_gok_40:
L_gdn_42:
    s_barrier
    s_cmp_lg_u32 s10, 0
    s_cbranch_scc1 L_pi_43
    s_add_u32 s13, s33, 2
    s_and_b32 s13, s13, 3
    s_mul_i32 s13, s13, 16
    s_add_u32 s40, s21, s13
    s_load_dwordx4 s[60:63], s[56:57], s40 glc
L_pi_43:
    s_add_u32 s12, s25, 12288
    s_add_u32 m0, s18, 16384
    s_add_u32 s11, s19, s12
    buffer_load_dwordx4 v6, s[56:59], s11 offen sc1 lds
    buffer_load_dwordx4 v6, s[56:59], s11 offen offset:1024 sc1 lds
    s_add_u32 s12, s25, 24576
    s_add_u32 m0, s18, 81920
    s_add_u32 s11, s19, s12
    buffer_load_dwordx4 v6, s[56:59], s11 offen sc1 lds
    buffer_load_dwordx4 v6, s[56:59], s11 offen offset:1024 sc1 lds
    s_add_u32 s12, s26, 8192
    s_add_u32 m0, s18, 0
    s_add_u32 s11, s19, s12
    buffer_load_dwordx4 v6, s[56:59], s11 offen sc1 lds
    buffer_load_dwordx4 v6, s[56:59], s11 offen offset:1024 sc1 lds
    s_add_u32 s12, s26, 8192
    s_add_u32 m0, s18, 32768
    s_lshl_b32 s11, s12, 4
    buffer_load_dwordx4 v7, s[48:51], s11 offen lds
    s_add_u32 m0, s18, 33792
    s_add_u32 s11, s11, 8192
    buffer_load_dwordx4 v7, s[48:51], s11 offen lds
    s_add_u32 s12, s26, 12288
    s_add_u32 m0, s18, 106496
    s_lshl_b32 s11, s12, 4
    buffer_load_dwordx4 v7, s[48:51], s11 offen lds
    s_add_u32 m0, s18, 107520
    s_add_u32 s11, s11, 8192
    buffer_load_dwordx4 v7, s[48:51], s11 offen lds
    s_add_u32 s12, s26, 24576
    s_add_u32 m0, s18, 98304
    s_lshl_b32 s11, s12, 4
    buffer_load_dwordx4 v7, s[48:51], s11 offen lds
    s_add_u32 m0, s18, 99328
    s_add_u32 s11, s11, 8192
    buffer_load_dwordx4 v7, s[48:51], s11 offen lds
    s_waitcnt vmcnt(10)
    s_cmp_lg_u32 s10, 0
    s_cbranch_scc1 L_gdn_46
    s_mov_b32 s100, 0
L_glp_45:
    s_waitcnt lgkmcnt(0)
    s_xor_b64 s[60:61], s[60:61], s[42:43]
    s_xor_b64 s[62:63], s[62:63], s[42:43]
    s_or_b64 s[60:61], s[60:61], s[62:63]
    s_cbranch_scc0 L_gok_44
    s_add_u32 s100, s100, 1
    s_cmp_ge_u32 s100, 20000
    s_cbranch_scc1 L_gok_44
    s_sleep 3
    s_load_dwordx4 s[60:63], s[56:57], s40 glc
    s_branch L_glp_45
L_gok_44:
L_gdn_46:
    s_barrier
    s_cmp_lg_u32 s10, 0
    s_cbranch_scc1 L_pi_47
    s_add_u32 s13, s33, 3
    s_and_b32 s13, s13, 3
    s_mul_i32 s13, s13, 16
    s_add_u32 s40, s21, s13
    s_load_dwordx4 s[60:63], s[56:57], s40 glc
L_pi_47:
    s_add_u32 s12, s26, 12288
    s_add_u32 m0, s18, 49152
    s_add_u32 s11, s19, s12
    buffer_load_dwordx4 v6, s[56:59], s11 offen sc1 lds
    buffer_load_dwordx4 v6, s[56:59], s11 offen offset:1024 sc1 lds
    s_add_u32 s12, s26, 24576
    s_add_u32 m0, s18, 40960
    s_add_u32 s11, s19, s12
    buffer_load_dwordx4 v6, s[56:59], s11 offen sc1 lds
    buffer_load_dwordx4 v6, s[56:59], s11 offen offset:1024 sc1 lds
    s_add_u32 s12, s27, 8192
    s_add_u32 m0, s18, 8192
    s_add_u32 s11, s19, s12
    buffer_load_dwordx4 v6, s[56:59], s11 offen sc1 lds
    buffer_load_dwordx4 v6, s[56:59], s11 offen offset:1024 sc1 lds
    s_add_u32 s12, s27, 8192
    s_add_u32 m0, s18, 57344
    s_lshl_b32 s11, s12, 4
    buffer_load_dwordx4 v7, s[48:51], s11 offen lds
    s_add_u32 m0, s18, 58368
    s_add_u32 s11, s11, 8192
    buffer_load_dwordx4 v7, s[48:51], s11 offen lds
    s_add_u32 s12, s27, 12288
    s_add_u32 m0, s18, 122880
    s_lshl_b32 s11, s12, 4
    buffer_load_dwordx4 v7, s[48:51], s11 offen lds
    s_add_u32 m0, s18, 123904
    s_add_u32 s11, s11, 8192
    buffer_load_dwordx4 v7, s[48:51], s11 offen lds
    s_add_u32 s12, s27, 24576
    s_add_u32 m0, s18, 114688
    s_lshl_b32 s11, s12, 4
    buffer_load_dwordx4 v7, s[48:51], s11 offen lds
    s_add_u32 m0, s18, 115712
    s_add_u32 s11, s11, 8192
    buffer_load_dwordx4 v7, s[48:51], s11 offen lds
    s_waitcnt vmcnt(10)
    s_cmp_lg_u32 s10, 0
    s_cbranch_scc1 L_gdn_50
    s_mov_b32 s100, 0
L_glp_49:
    s_waitcnt lgkmcnt(0)
    s_xor_b64 s[60:61], s[60:61], s[42:43]
    s_xor_b64 s[62:63], s[62:63], s[42:43]
    s_or_b64 s[60:61], s[60:61], s[62:63]
    s_cbranch_scc0 L_gok_48
    s_add_u32 s100, s100, 1
    s_cmp_ge_u32 s100, 20000
    s_cbranch_scc1 L_gok_48
    s_sleep 3
    s_load_dwordx4 s[60:63], s[56:57], s40 glc
    s_branch L_glp_49
L_gok_48:
L_gdn_50:
    s_barrier
    s_cmp_lg_u32 s10, 0
    s_cbranch_scc1 L_pi_51
    s_mov_b32 s40, s22
    s_load_dwordx16 s[60:75], s[56:57], s40 glc
L_pi_51:
    s_add_u32 s12, s27, 12288
    s_add_u32 m0, s18, 65536
    s_add_u32 s11, s19, s12
    buffer_load_dwordx4 v6, s[56:59], s11 offen sc1 lds
    buffer_load_dwordx4 v6, s[56:59], s11 offen offset:1024 sc1 lds
    s_add_u32 s12, s27, 24576
    s_add_u32 m0, s18, 155648
    s_add_u32 s11, s19, s12
    buffer_load_dwordx4 v6, s[56:59], s11 offen sc1 lds
    buffer_load_dwordx4 v6, s[56:59], s11 offen offset:1024 sc1 lds
    s_add_u32 s12, s28, 8192
    s_add_u32 m0, s18, 139264
    s_add_u32 s11, s19, s12
    buffer_load_dwordx4 v6, s[56:59], s11 offen sc1 lds
    buffer_load_dwordx4 v6, s[56:59], s11 offen offset:1024 sc1 lds
    s_add_u32 s12, s28, 8192
    s_add_u32 m0, s18, 73728
    s_lshl_b32 s11, s12, 4
    buffer_load_dwordx4 v7, s[48:51], s11 offen lds
    s_add_u32 m0, s18, 74752
    s_add_u32 s11, s11, 8192
    buffer_load_dwordx4 v7, s[48:51], s11 offen lds
    s_add_u32 s12, s28, 12288
    s_add_u32 m0, s18, 16384
    s_lshl_b32 s11, s12, 4
    buffer_load_dwordx4 v7, s[48:51], s11 offen lds
    s_add_u32 m0, s18, 17408
    s_add_u32 s11, s11, 8192
    buffer_load_dwordx4 v7, s[48:51], s11 offen lds
    s_add_u32 s12, s28, 24576
    s_add_u32 m0, s18, 90112
    s_lshl_b32 s11, s12, 4
    buffer_load_dwordx4 v7, s[48:51], s11 offen lds
    s_add_u32 m0, s18, 91136
    s_add_u32 s11, s11, 8192
    buffer_load_dwordx4 v7, s[48:51], s11 offen lds
    s_waitcnt vmcnt(10)
    s_barrier
    s_add_u32 s12, s28, 12288
    s_add_u32 m0, s18, 81920
    s_add_u32 s11, s19, s12
    buffer_load_dwordx4 v6, s[56:59], s11 offen sc1 lds
    buffer_load_dwordx4 v6, s[56:59], s11 offen offset:1024 sc1 lds
    s_add_u32 s12, s28, 24576
    s_add_u32 m0, s18, 131072
    s_add_u32 s11, s19, s12
    buffer_load_dwordx4 v6, s[56:59], s11 offen sc1 lds
    buffer_load_dwordx4 v6, s[56:59], s11 offen offset:1024 sc1 lds
    s_add_u32 s12, s29, 0
    s_and_b32 s12, s12, 0x7fff
    s_add_u32 m0, s18, 49152
    s_lshl_b32 s11, s12, 4
    buffer_load_dwordx4 v7, s[52:55], s11 offen lds
    s_add_u32 m0, s18, 50176
    s_add_u32 s11, s11, 8192
    buffer_load_dwordx4 v7, s[52:55], s11 offen lds
    s_add_u32 s12, s29, 4096
    s_and_b32 s12, s12, 0x7fff
    s_add_u32 m0, s18, 106496
    s_lshl_b32 s11, s12, 4
    buffer_load_dwordx4 v7, s[52:55], s11 offen lds
    s_add_u32 m0, s18, 107520
    s_add_u32 s11, s11, 8192
    buffer_load_dwordx4 v7, s[52:55], s11 offen lds
    s_cmp_lg_u32 s10, 0
    s_cbranch_scc1 L_gdn_54
    s_mov_b32 s100, 0
L_glp_53:
    s_waitcnt lgkmcnt(0)
    s_xor_b64 s[60:61], s[60:61], s[42:43]
    s_xor_b64 s[62:63], s[62:63], s[42:43]
    s_xor_b64 s[64:65], s[64:65], s[42:43]
    s_xor_b64 s[66:67], s[66:67], s[42:43]
    s_xor_b64 s[68:69], s[68:69], s[42:43]
    s_xor_b64 s[70:71], s[70:71], s[42:43]
    s_xor_b64 s[72:73], s[72:73], s[42:43]
    s_xor_b64 s[74:75], s[74:75], s[42:43]
    s_or_b64 s[60:61], s[60:61], s[62:63]
    s_or_b64 s[60:61], s[60:61], s[64:65]
    s_or_b64 s[60:61], s[60:61], s[66:67]
    s_or_b64 s[60:61], s[60:61], s[68:69]
    s_or_b64 s[60:61], s[60:61], s[70:71]
    s_or_b64 s[60:61], s[60:61], s[72:73]
    s_or_b64 s[60:61], s[60:61], s[74:75]
    s_cbranch_scc0 L_gok_52
    s_add_u32 s100, s100, 1
    s_cmp_ge_u32 s100, 20000
    s_cbranch_scc1 L_gok_52
    s_sleep 3
    s_load_dwordx16 s[60:75], s[56:57], s40 glc
    s_branch L_glp_53
L_gok_52:
    v_mov_b32 v11, 5
    ds_write_b32 v21, v11 offset:48
    s_nop 0
    s_branch L_gfn_55
L_gdn_54:
    s_mov_b32 s100, 0
L_gl2_56:
    ds_read_b32 v10, v16 offset:48
    s_add_u32 s100, s100, 1
    s_waitcnt lgkmcnt(0)
    v_readfirstlane_b32 s11, v10
    s_cmp_ge_u32 s100, 0x80000
    s_cbranch_scc1 L_gfn_55
    s_cmp_lt_u32 s11, 5
    s_cbranch_scc1 L_gl2_56
    s_nop 0
L_gfn_55:
    s_add_u32 s12, s29, 0
    s_and_b32 s12, s12, 0x7fff
    s_add_u32 s12, s12, 114688
    s_add_u32 m0, s18, 0
    s_add_u32 s11, s19, s12
    buffer_load_dwordx4 v6, s[56:59], s11 offen sc1 lds
    buffer_load_dwordx4 v6, s[56:59], s11 offen offset:1024 sc1 lds
    s_add_u32 s12, s29, 4096
    s_and_b32 s12, s12, 0x7fff
    s_add_u32 s12, s12, 114688
    s_add_u32 m0, s18, 32768
    s_add_u32 s11, s19, s12
    buffer_load_dwordx4 v6, s[56:59], s11 offen sc1 lds
    buffer_load_dwordx4 v6, s[56:59], s11 offen offset:1024 sc1 lds
    s_waitcnt vmcnt(10)
    s_barrier
    s_add_u32 s12, s29, 8192
    s_and_b32 s12, s12, 0x7fff
    s_add_u32 s12, s12, 114688
    s_add_u32 m0, s18, 40960
    s_add_u32 s11, s19, s12
    buffer_load_dwordx4 v6, s[56:59], s11 offen sc1 lds
    buffer_load_dwordx4 v6, s[56:59], s11 offen offset:1024 sc1 lds
    s_add_u32 s12, s29, 8192
    s_and_b32 s12, s12, 0x7fff
    s_add_u32 m0, s18, 57344
    s_lshl_b32 s11, s12, 4
    buffer_load_dwordx4 v7, s[52:55], s11 offen lds
    s_add_u32 m0, s18, 58368
    s_add_u32 s11, s11, 8192
    buffer_load_dwordx4 v7, s[52:55], s11 offen lds
    s_add_u32 s12, s29, 12288
    s_and_b32 s12, s12, 0x7fff
    s_add_u32 s12, s12, 114688
    s_add_u32 m0, s18, 98304
    s_add_u32 s11, s19, s12
    buffer_load_dwordx4 v6, s[56:59], s11 offen sc1 lds
    buffer_load_dwordx4 v6, s[56:59], s11 offen offset:1024 sc1 lds
    s_add_u32 s12, s29, 12288
    s_and_b32 s12, s12, 0x7fff
    s_add_u32 m0, s18, 65536
    s_lshl_b32 s11, s12, 4
    buffer_load_dwordx4 v7, s[52:55], s11 offen lds
    s_add_u32 m0, s18, 66560
    s_add_u32 s11, s11, 8192
    buffer_load_dwordx4 v7, s[52:55], s11 offen lds
    s_add_u32 s12, s29, 16384
    s_and_b32 s12, s12, 0x7fff
    s_add_u32 s12, s12, 114688
    s_add_u32 m0, s18, 8192
    s_add_u32 s11, s19, s12
    buffer_load_dwordx4 v6, s[56:59], s11 offen sc1 lds
    buffer_load_dwordx4 v6, s[56:59], s11 offen offset:1024 sc1 lds
    s_add_u32 s12, s29, 16384
    s_and_b32 s12, s12, 0x7fff
    s_add_u32 m0, s18, 122880
    s_lshl_b32 s11, s12, 4
    buffer_load_dwordx4 v7, s[52:55], s11 offen lds
    s_add_u32 m0, s18, 123904
    s_add_u32 s11, s11, 8192
    buffer_load_dwordx4 v7, s[52:55], s11 offen lds
    s_waitcnt vmcnt(12)
    s_barrier
    s_add_u32 s12, s29, 20480
    s_and_b32 s12, s12, 0x7fff
    s_add_u32 s12, s12, 114688
    s_add_u32 m0, s18, 155648
    s_add_u32 s11, s19, s12
    buffer_load_dwordx4 v6, s[56:59], s11 offen sc1 lds
    buffer_load_dwordx4 v6, s[56:59], s11 offen offset:1024 sc1 lds
    s_add_u32 s12, s29, 20480
    s_and_b32 s12, s12, 0x7fff
    s_add_u32 m0, s18, 73728
    s_lshl_b32 s11, s12, 4
    buffer_load_dwordx4 v7, s[52:55], s11 offen lds
    s_add_u32 m0, s18, 74752
    s_add_u32 s11, s11, 8192
    buffer_load_dwordx4 v7, s[52:55], s11 offen lds
    s_add_u32 s12, s29, 24576
    s_and_b32 s12, s12, 0x7fff
    s_add_u32 s12, s12, 114688
    s_add_u32 m0, s18, 114688
    s_add_u32 s11, s19, s12
    buffer_load_dwordx4 v6, s[56:59], s11 offen sc1 lds
    buffer_load_dwordx4 v6, s[56:59], s11 offen offset:1024 sc1 lds
    s_add_u32 s12, s29, 24576
    s_and_b32 s12, s12, 0x7fff
    s_add_u32 m0, s18, 81920
    s_lshl_b32 s11, s12, 4
    buffer_load_dwordx4 v7, s[52:55], s11 offen lds
    s_add_u32 m0, s18, 82944
    s_add_u32 s11, s11, 8192
    buffer_load_dwordx4 v7, s[52:55], s11 offen lds
    s_add_u32 s12, s29, 28672
    s_and_b32 s12, s12, 0x7fff
    s_add_u32 s12, s12, 114688
    s_add_u32 m0, s18, 139264
    s_add_u32 s11, s19, s12
    buffer_load_dwordx4 v6, s[56:59], s11 offen sc1 lds
    buffer_load_dwordx4 v6, s[56:59], s11 offen offset:1024 sc1 lds
    s_add_u32 s12, s29, 28672
    s_and_b32 s12, s12, 0x7fff
    s_add_u32 m0, s18, 16384
    s_lshl_b32 s11, s12, 4
    buffer_load_dwordx4 v7, s[52:55], s11 offen lds
    s_add_u32 m0, s18, 17408
    s_add_u32 s11, s11, 8192
    buffer_load_dwordx4 v7, s[52:55], s11 offen lds
    s_waitcnt vmcnt(12)
    s_barrier
    s_waitcnt vmcnt(4)
    s_barrier
    s_waitcnt vmcnt(0)
    s_barrier
    s_endpgm
.p2align 6
L_D_ffn:
    s_setprio 3
    s_add_u32 m0, s88, 24576
    s_add_u32 s11, s69, 65536
    buffer_load_dwordx4 v2, s[40:43], s11 offen lds
    s_add_u32 m0, s88, 28672
    s_add_u32 s11, s69, 98304
    buffer_load_dwordx4 v2, s[40:43], s11 offen lds
    s_add_u32 m0, s89, 147456
    s_add_u32 s11, s77, 0
    buffer_load_dwordx4 v3, s[44:47], s11 offen lds
    s_add_u32 m0, s89, 149504
    s_add_u32 s11, s77, s90
    buffer_load_dwordx4 v3, s[44:47], s11 offen lds
    s_waitcnt vmcnt(9)
    s_barrier
    s_add_u32 m0, s89, 155648
    s_add_u32 s11, s77, s91
    buffer_load_dwordx4 v3, s[44:47], s11 offen lds
    s_add_u32 m0, s89, 157696
    s_add_u32 s11, s77, s92
    buffer_load_dwordx4 v3, s[44:47], s11 offen lds
    s_waitcnt vmcnt(9)
    s_barrier
    s_add_u32 m0, s88, 32768
    s_add_u32 s11, s70, 0
    buffer_load_dwordx4 v2, s[40:43], s11 offen lds
    s_add_u32 m0, s88, 36864
    s_add_u32 s11, s70, 32768
    buffer_load_dwordx4 v2, s[40:43], s11 offen lds
    s_add_u32 m0, s88, 40960
    s_add_u32 s11, s70, 65536
    buffer_load_dwordx4 v2, s[40:43], s11 offen lds
    s_add_u32 m0, s88, 45056
    s_add_u32 s11, s70, 98304
    buffer_load_dwordx4 v2, s[40:43], s11 offen lds
    s_add_u32 m0, s89, 131072
    s_add_u32 s11, s78, 0
    buffer_load_dwordx4 v3, s[44:47], s11 offen lds
    s_add_u32 m0, s89, 133120
    s_add_u32 s11, s78, s90
    buffer_load_dwordx4 v3, s[44:47], s11 offen lds
    s_lshl_b32 s16, s10, 9
    s_lshl_b32 s17, s10, 10
    s_lshl_b32 s18, s10, 11
    v_lshlrev_b32 v6, 4, v0
    v_mov_b32 v16, 0
    v_lshrrev_b32 v8, 3, v0
    v_and_b32 v9, 7, v0
    v_bfe_u32 v10, v0, 4, 1
    v_lshlrev_b32 v10, 2, v10
    v_xor_b32 v10, v10, v9
    v_lshlrev_b32 v10, 4, v10
    v_lshl_or_b32 v7, v8, 10, v10
    s_waitcnt vmcnt(8)
    s_barrier
    s_add_u32 m0, s88, 49152
    s_add_u32 s11, s71, 0
    buffer_load_dwordx4 v2, s[40:43], s11 offen lds
    s_add_u32 m0, s88, 53248
    s_add_u32 s11, s71, 32768
    buffer_load_dwordx4 v2, s[40:43], s11 offen lds
    s_add_u32 m0, s89, 139264
    s_add_u32 s11, s78, s91
    buffer_load_dwordx4 v3, s[44:47], s11 offen lds
    s_add_u32 m0, s89, 141312
    s_add_u32 s11, s78, s92
    buffer_load_dwordx4 v3, s[44:47], s11 offen lds
    s_lshl_b32 s12, s9, 7
    s_lshl_b32 s13, s10, 14
    s_add_u32 s12, s12, s13
    v_add_u32 v7, s12, v7
    s_lshl_b32 s12, s8, 1
    s_lshr_b32 s13, s10, 1
    s_add_u32 s12, s12, s13
    s_mul_i32 s12, s12, 147456
    s_and_b32 s13, s10, 1
    s_lshl_b32 s13, s13, 11
    s_add_u32 s19, s12, s13
    s_lshr_b32 s12, s8, 1
    s_waitcnt vmcnt(10)
    s_barrier
    s_add_u32 m0, s88, 57344
    s_add_u32 s11, s71, 65536
    buffer_load_dwordx4 v2, s[40:43], s11 offen lds
    s_add_u32 m0, s88, 61440
    s_add_u32 s11, s71, 98304
    buffer_load_dwordx4 v2, s[40:43], s11 offen lds
    s_add_u32 m0, s89, 147456
    s_add_u32 s11, s79, 0
    buffer_load_dwordx4 v3, s[44:47], s11 offen lds
    s_add_u32 m0, s89, 149504
    s_add_u32 s11, s79, s90
    buffer_load_dwordx4 v3, s[44:47], s11 offen lds
    s_mul_i32 s12, s12, 4352
    s_add_u32 s20, s12, 10485760
    s_mul_i32 s12, s8, 4352
    s_add_u32 s21, s12, 10555392
    s_add_u32 s22, s12, 10694656
    s_lshr_b32 s33, s9, 1
    s_add_u32 s33, s33, s8
    s_and_b32 s33, s33, 3
    s_and_b32 s13, s9, 1
    s_lshl_b32 s23, s13, 14
    s_xor_b32 s24, s23, 0x4000
    s_lshl_b32 s29, s33, 1
    s_waitcnt vmcnt(8)
    s_barrier
    s_add_u32 m0, s88, 65536
    s_add_u32 s11, s72, 0
    buffer_load_dwordx4 v2, s[40:43], s11 offen lds
    s_add_u32 m0, s88, 69632
    s_add_u32 s11, s72, 32768
    buffer_load_dwordx4 v2, s[40:43], s11 offen lds
    s_add_u32 m0, s89, 155648
    s_add_u32 s11, s79, s91
    buffer_load_dwordx4 v3, s[44:47], s11 offen lds
    s_add_u32 m0, s89, 157696
    s_add_u32 s11, s79, s92
    buffer_load_dwordx4 v3, s[44:47], s11 offen lds
    s_add_u32 s29, s29, s13
    s_lshl_b32 s29, s29, 12
    s_add_u32 s13, s33, 0
    s_and_b32 s13, s13, 3
    s_mul_i32 s25, s13, 28672
    s_add_u32 s13, s33, 1
    s_and_b32 s13, s13, 3
    s_mul_i32 s26, s13, 28672
    s_add_u32 s13, s33, 2
    s_and_b32 s13, s13, 3
    s_mul_i32 s27, s13, 28672
    s_add_u32 s13, s33, 3
    s_waitcnt vmcnt(8)
    s_barrier
    s_add_u32 m0, s88, 73728
    s_add_u32 s11, s72, 65536
    buffer_load_dwordx4 v2, s[40:43], s11 offen lds
    s_add_u32 m0, s88, 77824
    s_add_u32 s11, s72, 98304
    buffer_load_dwordx4 v2, s[40:43], s11 offen lds
    s_add_u32 m0, s89, 131072
    s_add_u32 s11, s80, 0
    buffer_load_dwordx4 v3, s[44:47], s11 offen lds
    s_add_u32 m0, s89, 133120
    s_add_u32 s11, s80, s90
    buffer_load_dwordx4 v3, s[44:47], s11 offen lds
    s_and_b32 s13, s13, 3
    s_mul_i32 s28, s13, 28672
    s_lshl_b32 s12, s4, 3
    s_add_u32 s12, s12, s6
    s_lshl_b32 s12, s12, 2
    s_add_u32 s12, s12, s10
    s_lshl_b32 s12, s12, 7
    v_lshl_add_u32 v18, v0, 16, s12
    s_waitcnt vmcnt(8)
    s_barrier
    s_add_u32 m0, s88, 81920
    s_add_u32 s11, s73, 0
    buffer_load_dwordx4 v2, s[40:43], s11 offen lds
    s_add_u32 m0, s88, 86016
    s_add_u32 s11, s73, 32768
    buffer_load_dwordx4 v2, s[40:43], s11 offen lds
    s_add_u32 m0, s89, 139264
    s_add_u32 s11, s80, s91
    buffer_load_dwordx4 v3, s[44:47], s11 offen lds
    s_add_u32 m0, s89, 141312
    s_add_u32 s11, s80, s92
    buffer_load_dwordx4 v3, s[44:47], s11 offen lds
    s_waitcnt vmcnt(8)
    s_barrier
    s_add_u32 m0, s88, 90112
    s_add_u32 s11, s73, 65536
    buffer_load_dwordx4 v2, s[40:43], s11 offen lds
    s_add_u32 m0, s88, 94208
    s_add_u32 s11, s73, 98304
    buffer_load_dwordx4 v2, s[40:43], s11 offen lds
    s_add_u32 m0, s89, 147456
    s_add_u32 s11, s81, 0
    buffer_load_dwordx4 v3, s[44:47], s11 offen lds
    s_add_u32 m0, s89, 149504
    s_add_u32 s11, s81, s90
    buffer_load_dwordx4 v3, s[44:47], s11 offen lds
    s_waitcnt vmcnt(8)
    s_barrier
    s_add_u32 m0, s88, 98304
    s_add_u32 s11, s74, 0
    buffer_load_dwordx4 v2, s[40:43], s11 offen lds
    s_add_u32 m0, s88, 102400
    s_add_u32 s11, s74, 32768
    buffer_load_dwordx4 v2, s[40:43], s11 offen lds
    s_add_u32 m0, s89, 155648
    s_add_u32 s11, s81, s91
    buffer_load_dwordx4 v3, s[44:47], s11 offen lds
    s_add_u32 m0, s89, 157696
    s_add_u32 s11, s81, s92
    buffer_load_dwordx4 v3, s[44:47], s11 offen lds
    s_waitcnt vmcnt(8)
    s_barrier
    s_add_u32 m0, s88, 106496
    s_add_u32 s11, s74, 65536
    buffer_load_dwordx4 v2, s[40:43], s11 offen lds
    s_add_u32 m0, s88, 110592
    s_add_u32 s11, s74, 98304
    buffer_load_dwordx4 v2, s[40:43], s11 offen lds
    s_add_u32 m0, s89, 131072
    s_add_u32 s11, s82, 0
    buffer_load_dwordx4 v3, s[44:47], s11 offen lds
    s_add_u32 m0, s89, 133120
    s_add_u32 s11, s82, s90
    buffer_load_dwordx4 v3, s[44:47], s11 offen lds
    s_waitcnt vmcnt(8)
    s_barrier
    s_add_u32 m0, s88, 114688
    s_add_u32 s11, s75, 0
    buffer_load_dwordx4 v2, s[40:43], s11 offen lds
    s_add_u32 m0, s88, 118784
    s_add_u32 s11, s75, 32768
    buffer_load_dwordx4 v2, s[40:43], s11 offen lds
    s_add_u32 m0, s89, 139264
    s_add_u32 s11, s82, s91
    buffer_load_dwordx4 v3, s[44:47], s11 offen lds
    s_add_u32 m0, s89, 141312
    s_add_u32 s11, s82, s92
    buffer_load_dwordx4 v3, s[44:47], s11 offen lds
    s_waitcnt vmcnt(8)
    s_barrier
    s_add_u32 m0, s88, 122880
    s_add_u32 s11, s75, 65536
    buffer_load_dwordx4 v2, s[40:43], s11 offen lds
    s_add_u32 m0, s88, 126976
    s_add_u32 s11, s75, 98304
    buffer_load_dwordx4 v2, s[40:43], s11 offen lds
    s_add_u32 m0, s89, 147456
    s_add_u32 s11, s83, 0
    buffer_load_dwordx4 v3, s[44:47], s11 offen lds
    s_add_u32 m0, s89, 149504
    s_add_u32 s11, s83, s90
    buffer_load_dwordx4 v3, s[44:47], s11 offen lds
    s_load_dword s15, s[34:35], 0
    s_waitcnt vmcnt(8)
    s_barrier
    s_add_u32 m0, s89, 155648
    s_add_u32 s11, s83, s91
    buffer_load_dwordx4 v3, s[44:47], s11 offen lds
    s_add_u32 m0, s89, 157696
    s_add_u32 s11, s83, s92
    buffer_load_dwordx4 v3, s[44:47], s11 offen lds
    s_waitcnt lgkmcnt(0)
    s_cmp_lg_u32 s15, 0
    s_cbranch_scc1 L_nok_57
    s_mov_b32 s100, 0
L_nlp_58:
    s_sleep 16
    v_mov_b32 v17, 0
    global_load_dword v17, v17, s[34:35] sc1
    s_waitcnt vmcnt(0)
    s_nop 0
    v_readfirstlane_b32 s15, v17
    s_add_u32 s100, s100, 1
    s_cmp_ge_u32 s100, 20000
    s_cbranch_scc1 L_nok_57
    s_cmp_eq_u32 s15, 0
    s_cbranch_scc1 L_nlp_58
L_nok_57:
    v_mov_b32 v17, s15
    s_mov_b64 s[44:45], s[60:61]
    s_mov_b32 s46, s62
    s_mul_i32 s76, s68, s38
    s_lshr_b32 s76, s76, 1
    s_mul_i32 s77, s69, s38
    s_lshr_b32 s77, s77, 1
    s_mul_i32 s78, s70, s38
    s_lshr_b32 s78, s78, 1
    s_mul_i32 s79, s71, s38
    s_lshr_b32 s79, s79, 1
    s_mul_i32 s80, s72, s38
    s_lshr_b32 s80, s80, 1
    s_mul_i32 s81, s73, s38
    s_lshr_b32 s81, s81, 1
    s_mul_i32 s82, s74, s38
    s_lshr_b32 s82, s82, 1
    s_mul_i32 s83, s75, s38
    s_lshr_b32 s83, s83, 1
    s_waitcnt vmcnt(6)
    s_barrier
    s_add_u32 m0, s88, 131072
    s_add_u32 s11, s76, 0
    buffer_load_dwordx4 v4, s[44:47], s11 offen lds
    s_add_u32 m0, s93, 135168
    s_mov_b32 exec_hi, 0
    buffer_load_dwordx4 v5, s[44:47], s11 offen lds
    s_mov_b64 exec, -1
    s_waitcnt vmcnt(4)
    s_barrier
    s_add_u32 m0, s88, 139264
    s_add_u32 s11, s76, s39
    buffer_load_dwordx4 v4, s[44:47], s11 offen lds
    s_add_u32 m0, s93, 143360
    s_mov_b32 exec_hi, 0
    buffer_load_dwordx4 v5, s[44:47], s11 offen lds
    s_mov_b64 exec, -1
    s_waitcnt vmcnt(4)
    s_barrier
    s_add_u32 m0, s88, 147456
    s_add_u32 s11, s77, 0
    buffer_load_dwordx4 v4, s[44:47], s11 offen lds
    s_add_u32 m0, s93, 151552
    s_mov_b32 exec_hi, 0
    buffer_load_dwordx4 v5, s[44:47], s11 offen lds
    s_mov_b64 exec, -1
    s_mov_b32 s42, s15
    s_mov_b32 s43, s15
    s_waitcnt vmcnt(4)
    s_barrier
    s_add_u32 m0, s88, 155648
    s_add_u32 s11, s77, s39
    buffer_load_dwordx4 v4, s[44:47], s11 offen lds
    s_add_u32 m0, s93, 159744
    s_mov_b32 exec_hi, 0
    buffer_load_dwordx4 v5, s[44:47], s11 offen lds
    s_mov_b64 exec, -1
    buffer_load_dword v15, v18, s[48:51], 0 offen
    buffer_load_dword v15, v18, s[52:55], 0 offen
    s_waitcnt vmcnt(6)
    s_barrier
    s_add_u32 m0, s88, 131072
    s_add_u32 s11, s78, 0
    buffer_load_dwordx4 v4, s[44:47], s11 offen lds
    s_add_u32 m0, s93, 135168
    s_mov_b32 exec_hi, 0
    buffer_load_dwordx4 v5, s[44:47], s11 offen lds
    s_mov_b64 exec, -1
    s_waitcnt vmcnt(6)
    s_barrier
    s_lshl_b32 s12, s10, 2
    s_add_u32 s12, s12, 161792
    v_mov_b32 v8, s12
    v_lshlrev_b32 v9, 2, v0
    v_add_u32 v9, 162816, v9
    v_cmp_eq_u32 vcc, 0, v0
    v_mov_b32 v16, 161792
    s_mov_b32 s95, 0
    v_cndmask_b32 v21, v9, v8, vcc
    v_lshlrev_b32 v9, 2, v0
    v_add_u32 v9, 161792, v9
    v_mov_b32 v8, 0
    ds_write_b32 v9, v8
    s_waitcnt lgkmcnt(0)
    s_add_u32 m0, s88, 139264
    s_add_u32 s11, s78, s39
    buffer_load_dwordx4 v4, s[44:47], s11 offen lds
    s_add_u32 m0, s93, 143360
    s_mov_b32 exec_hi, 0
    buffer_load_dwordx4 v5, s[44:47], s11 offen lds
    s_mov_b64 exec, -1
    s_add_u32 m0, s88, 0
    s_add_u32 s11, s79, 0
    buffer_load_dwordx4 v4, s[44:47], s11 offen lds
    s_add_u32 m0, s93, 4096
    s_mov_b32 exec_hi, 0
    buffer_load_dwordx4 v5, s[44:47], s11 offen lds
    s_mov_b64 exec, -1
    s_add_u32 m0, s88, 8192
    s_add_u32 s11, s79, s39
    buffer_load_dwordx4 v4, s[44:47], s11 offen lds
    s_add_u32 m0, s93, 12288
    s_mov_b32 exec_hi, 0
    buffer_load_dwordx4 v5, s[44:47], s11 offen lds
    s_mov_b64 exec, -1
    s_waitcnt vmcnt(10)
    s_barrier
    s_add_u32 m0, s88, 147456
    s_add_u32 s11, s80, 0
    buffer_load_dwordx4 v4, s[44:47], s11 offen lds
    s_add_u32 m0, s93, 151552
    s_mov_b32 exec_hi, 0
    buffer_load_dwordx4 v5, s[44:47], s11 offen lds
    s_mov_b64 exec, -1
    s_waitcnt vmcnt(8)
    s_barrier
    s_add_u32 m0, s88, 155648
    s_add_u32 s11, s80, s39
    buffer_load_dwordx4 v4, s[44:47], s11 offen lds
    s_add_u32 m0, s93, 159744
    s_mov_b32 exec_hi, 0
    buffer_load_dwordx4 v5, s[44:47], s11 offen lds
    s_mov_b64 exec, -1
    s_add_u32 m0, s88, 16384
    s_add_u32 s11, s81, 0
    buffer_load_dwordx4 v4, s[44:47], s11 offen lds
    s_add_u32 m0, s93, 20480
    s_mov_b32 exec_hi, 0
    buffer_load_dwordx4 v5, s[44:47], s11 offen lds
    s_mov_b64 exec, -1
    s_add_u32 m0, s88, 24576
    s_add_u32 s11, s81, s39
    buffer_load_dwordx4 v4, s[44:47], s11 offen lds
    s_add_u32 m0, s93, 28672
    s_mov_b32 exec_hi, 0
    buffer_load_dwordx4 v5, s[44:47], s11 offen lds
    s_mov_b64 exec, -1
    s_waitcnt vmcnt(12)
    s_barrier
    s_add_u32 m0, s88, 131072
    s_add_u32 s11, s82, 0
    buffer_load_dwordx4 v4, s[44:47], s11 offen lds
    s_add_u32 m0, s93, 135168
    s_mov_b32 exec_hi, 0
    buffer_load_dwordx4 v5, s[44:47], s11 offen lds
    s_mov_b64 exec, -1
    s_waitcnt vmcnt(12)
    s_barrier
    s_add_u32 m0, s88, 139264
    s_add_u32 s11, s82, s39
    buffer_load_dwordx4 v4, s[44:47], s11 offen lds
    s_add_u32 m0, s93, 143360
    s_mov_b32 exec_hi, 0
    buffer_load_dwordx4 v5, s[44:47], s11 offen lds
    s_mov_b64 exec, -1
    s_add_u32 m0, s88, 32768
    s_add_u32 s11, s83, 0
    buffer_load_dwordx4 v4, s[44:47], s11 offen lds
    s_add_u32 m0, s93, 36864
    s_mov_b32 exec_hi, 0
    buffer_load_dwordx4 v5, s[44:47], s11 offen lds
    s_mov_b64 exec, -1
    s_add_u32 m0, s88, 40960
    s_add_u32 s11, s83, s39
    buffer_load_dwordx4 v4, s[44:47], s11 offen lds
    s_add_u32 m0, s93, 45056
    s_mov_b32 exec_hi, 0
    buffer_load_dwordx4 v5, s[44:47], s11 offen lds
    s_mov_b64 exec, -1
    s_waitcnt vmcnt(16)
    s_barrier
    s_add_u32 s12, s25, s23
    s_add_u32 m0, s18, 0
    s_lshl_b32 s11, s12, 4
    buffer_load_dwordx4 v7, s[48:51], s11 offen lds
    s_add_u32 m0, s18, 1024
    s_add_u32 s11, s11, 8192
    buffer_load_dwordx4 v7, s[48:51], s11 offen lds
    s_waitcnt vmcnt(16)
    s_barrier
    s_add_u32 s12, s25, s23
    s_add_u32 s12, s12, 4096
    s_add_u32 m0, s18, 49152
    s_lshl_b32 s11, s12, 4
    buffer_load_dwordx4 v7, s[48:51], s11 offen lds
    s_add_u32 m0, s18, 50176
    s_add_u32 s11, s11, 8192
    buffer_load_dwordx4 v7, s[48:51], s11 offen lds
    s_add_u32 s12, s25, s24
    s_add_u32 m0, s18, 57344
    s_lshl_b32 s11, s12, 4
    buffer_load_dwordx4 v7, s[48:51], s11 offen lds
    s_add_u32 m0, s18, 58368
    s_add_u32 s11, s11, 8192
    buffer_load_dwordx4 v7, s[48:51], s11 offen lds
    s_waitcnt vmcnt(18)
    s_barrier
    s_add_u32 s12, s25, s24
    s_add_u32 s12, s12, 4096
    s_add_u32 m0, s18, 8192
    s_lshl_b32 s11, s12, 4
    buffer_load_dwordx4 v7, s[48:51], s11 offen lds
    s_add_u32 m0, s18, 9216
    s_add_u32 s11, s11, 8192
    buffer_load_dwordx4 v7, s[48:51], s11 offen lds
    s_add_u32 s12, s26, s23
    s_add_u32 m0, s18, 147456
    s_lshl_b32 s11, s12, 4
    buffer_load_dwordx4 v7, s[48:51], s11 offen lds
    s_add_u32 m0, s18, 148480
    s_add_u32 s11, s11, 8192
    buffer_load_dwordx4 v7, s[48:51], s11 offen lds
    s_waitcnt vmcnt(20)
    s_barrier
    s_cmp_lg_u32 s10, 0
    s_cbranch_scc1 L_pi_59
    s_add_u32 s13, s33, 0
    s_and_b32 s13, s13, 3
    s_mul_i32 s13, s13, 32
    s_add_u32 s40, s20, s13
    s_load_dwordx8 s[60:67], s[56:57], s40 glc
L_pi_59:
    s_add_u32 s12, s26, s23
    s_add_u32 s12, s12, 4096
    s_add_u32 m0, s18, 65536
    s_lshl_b32 s11, s12, 4
    buffer_load_dwordx4 v7, s[48:51], s11 offen lds
    s_add_u32 m0, s18, 66560
    s_add_u32 s11, s11, 8192
    buffer_load_dwordx4 v7, s[48:51], s11 offen lds
    s_add_u32 s12, s26, s24
    s_add_u32 m0, s18, 73728
    s_lshl_b32 s11, s12, 4
    buffer_load_dwordx4 v7, s[48:51], s11 offen lds
    s_add_u32 m0, s18, 74752
    s_add_u32 s11, s11, 8192
    buffer_load_dwordx4 v7, s[48:51], s11 offen lds
    s_waitcnt vmcnt(22)
    s_barrier
    s_add_u32 s12, s26, s24
    s_add_u32 s12, s12, 4096
    s_add_u32 m0, s18, 16384
    s_lshl_b32 s11, s12, 4
    buffer_load_dwordx4 v7, s[48:51], s11 offen lds
    s_add_u32 m0, s18, 17408
    s_add_u32 s11, s11, 8192
    buffer_load_dwordx4 v7, s[48:51], s11 offen lds
    s_waitcnt vmcnt(22)
    s_barrier
    s_waitcnt vmcnt(20)
    s_cmp_lg_u32 s10, 0
    s_cbranch_scc1 L_gdn_62
    s_mov_b32 s100, 0
L_glp_61:
    s_waitcnt lgkmcnt(0)
    s_xor_b64 s[60:61], s[60:61], s[42:43]
    s_xor_b64 s[62:63], s[62:63], s[42:43]
    s_xor_b64 s[64:65], s[64:65], s[42:43]
    s_xor_b64 s[66:67], s[66:67], s[42:43]
    s_or_b64 s[60:61], s[60:61], s[62:63]
    s_or_b64 s[60:61], s[60:61], s[64:65]
    s_or_b64 s[60:61], s[60:61], s[66:67]
    s_cbranch_scc0 L_gok_60
    s_add_u32 s100, s100, 1
    s_cmp_ge_u32 s100, 20000
    s_cbranch_scc1 L_gok_60
    s_sleep 3
    s_load_dwordx8 s[60:67], s[56:57], s40 glc
    s_branch L_glp_61
L_gok_60:
L_gdn_62:
    s_barrier
    s_cmp_lg_u32 s10, 0
    s_cbranch_scc1 L_pi_63
    s_add_u32 s13, s33, 1
    s_and_b32 s13, s13, 3
    s_mul_i32 s13, s13, 32
    s_add_u32 s40, s20, s13
    s_load_dwordx8 s[60:67], s[56:57], s40 glc
L_pi_63:
    s_add_u32 s12, s25, s23
    s_add_u32 m0, s18, 81920
    s_add_u32 s11, s19, s12
    buffer_load_dwordx4 v6, s[56:59], s11 offen sc1 lds
    buffer_load_dwordx4 v6, s[56:59], s11 offen offset:1024 sc1 lds
    s_add_u32 s12, s25, s23
    s_add_u32 s12, s12, 4096
    s_add_u32 m0, s18, 90112
    s_add_u32 s11, s19, s12
    buffer_load_dwordx4 v6, s[56:59], s11 offen sc1 lds
    buffer_load_dwordx4 v6, s[56:59], s11 offen offset:1024 sc1 lds
    s_waitcnt vmcnt(22)
    s_barrier
    s_add_u32 s12, s25, s24
    s_add_u32 m0, s18, 24576
    s_add_u32 s11, s19, s12
    buffer_load_dwordx4 v6, s[56:59], s11 offen sc1 lds
    buffer_load_dwordx4 v6, s[56:59], s11 offen offset:1024 sc1 lds
    s_add_u32 s12, s25, s24
    s_add_u32 s12, s12, 4096
    s_add_u32 m0, s18, 131072
    s_add_u32 s11, s19, s12
    buffer_load_dwordx4 v6, s[56:59], s11 offen sc1 lds
    buffer_load_dwordx4 v6, s[56:59], s11 offen offset:1024 sc1 lds
    s_waitcnt vmcnt(24)
    s_cmp_lg_u32 s10, 0
    s_cbranch_scc1 L_gdn_66
    s_mov_b32 s100, 0
L_glp_65:
    s_waitcnt lgkmcnt(0)
    s_xor_b64 s[60:61], s[60:61], s[42:43]
    s_xor_b64 s[62:63], s[62:63], s[42:43]
    s_xor_b64 s[64:65], s[64:65], s[42:43]
    s_xor_b64 s[66:67], s[66:67], s[42:43]
    s_or_b64 s[60:61], s[60:61], s[62:63]
    s_or_b64 s[60:61], s[60:61], s[64:65]
    s_or_b64 s[60:61], s[60:61], s[66:67]
    s_cbranch_scc0 L_gok_64
    s_add_u32 s100, s100, 1
    s_cmp_ge_u32 s100, 20000
    s_cbranch_scc1 L_gok_64
    s_sleep 3
    s_load_dwordx8 s[60:67], s[56:57], s40 glc
    s_branch L_glp_65
L_gok_64:
L_gdn_66:
    s_barrier
    s_add_u32 s12, s26, s23
    s_add_u32 m0, s18, 98304
    s_add_u32 s11, s19, s12
    buffer_load_dwordx4 v6, s[56:59], s11 offen sc1 lds
    buffer_load_dwordx4 v6, s[56:59], s11 offen offset:1024 sc1 lds
    s_add_u32 s12, s26, s23
    s_add_u32 s12, s12, 4096
    s_add_u32 m0, s18, 106496
    s_add_u32 s11, s19, s12
    buffer_load_dwordx4 v6, s[56:59], s11 offen sc1 lds
    buffer_load_dwordx4 v6, s[56:59], s11 offen offset:1024 sc1 lds
    s_barrier
    s_waitcnt vmcnt(6)
    v_mov_b32 v11, 1
    ds_write_b32 v21, v11 offset:0
    s_mov_b32 s100, 0
    v_mov_b32 v11, 2
    s_nop 1
L_dw_67:
    s_getreg_b32 s11, hwreg(HW_REG_IB_STS, 0, 4)
    s_getreg_b32 s12, hwreg(HW_REG_IB_STS, 22, 2)
    s_lshl4_add_u32 s11, s12, s11
    s_cmp_gt_u32 s11, 0
    s_cbranch_scc1 L_dn_69
    s_waitcnt vmcnt(0)
    ds_write_b32 v21, v11
L_dn_69:
L_do_68:
    s_cmp_lg_u32 s10, 0
    s_cbranch_scc1 L_pi_70
    s_add_u32 s13, s33, 2
    s_and_b32 s13, s13, 3
    s_mul_i32 s13, s13, 32
    s_add_u32 s40, s20, s13
    s_load_dwordx8 s[60:67], s[56:57], s40 glc
L_pi_70:
    s_add_u32 s12, s26, s24
    s_add_u32 m0, s18, 139264
    s_add_u32 s11, s19, s12
    buffer_load_dwordx4 v6, s[56:59], s11 offen sc1 lds
    buffer_load_dwordx4 v6, s[56:59], s11 offen offset:1024 sc1 lds
    s_add_u32 s12, s26, s24
    s_add_u32 s12, s12, 4096
    s_add_u32 m0, s18, 32768
    s_add_u32 s11, s19, s12
    buffer_load_dwordx4 v6, s[56:59], s11 offen sc1 lds
    buffer_load_dwordx4 v6, s[56:59], s11 offen offset:1024 sc1 lds
    s_add_u32 s12, s27, s23
    s_add_u32 m0, s18, 114688
    s_lshl_b32 s11, s12, 4
    buffer_load_dwordx4 v7, s[48:51], s11 offen lds
    s_add_u32 m0, s18, 115712
    s_add_u32 s11, s11, 8192
    buffer_load_dwordx4 v7, s[48:51], s11 offen lds
    s_add_u32 s12, s27, s23
    s_add_u32 s12, s12, 4096
    s_add_u32 m0, s18, 122880
    s_lshl_b32 s11, s12, 4
    buffer_load_dwordx4 v7, s[48:51], s11 offen lds
    s_add_u32 m0, s18, 123904
    s_add_u32 s11, s11, 8192
    buffer_load_dwordx4 v7, s[48:51], s11 offen lds
    s_waitcnt vmcnt(8)
    v_mov_b32 v11, 2
    ds_write_b32 v21, v11 offset:0
    s_add_u32 s12, s27, s24
    s_add_u32 m0, s18, 40960
    s_lshl_b32 s11, s12, 4
    buffer_load_dwordx4 v7, s[48:51], s11 offen lds
    s_add_u32 m0, s18, 41984
    s_add_u32 s11, s11, 8192
    buffer_load_dwordx4 v7, s[48:51], s11 offen lds
    s_mov_b32 s100, 0
    v_mov_b32 v11, 3
    s_nop 1
L_dw_71:
    ds_read_b128 v[24:27], v16 offset:32
    s_add_u32 s100, s100, 1
    s_waitcnt lgkmcnt(0)
    v_min3_u32 v24, v24, v25, v26
    v_min_u32 v24, v24, v27
    s_nop 0
    v_readfirstlane_b32 s95, v24
    s_cmp_ge_u32 s100, 0x40000
    s_cbranch_scc1 L_do_72
    s_cmp_lt_u32 s95, 1
    s_cbranch_scc1 L_dw_71
    s_nop 0
L_do_72:
    s_cmp_lg_u32 s10, 0
    s_cbranch_scc1 L_gdn_76
    s_mov_b32 s100, 0
L_glp_75:
    s_waitcnt lgkmcnt(0)
    s_xor_b64 s[60:61], s[60:61], s[42:43]
    s_xor_b64 s[62:63], s[62:63], s[42:43]
    s_xor_b64 s[64:65], s[64:65], s[42:43]
    s_xor_b64 s[66:67], s[66:67], s[42:43]
    s_or_b64 s[60:61], s[60:61], s[62:63]
    s_or_b64 s[60:61], s[60:61], s[64:65]
    s_or_b64 s[60:61], s[60:61], s[66:67]
    s_cbranch_scc0 L_gok_74
    s_add_u32 s100, s100, 1
    s_cmp_ge_u32 s100, 20000
    s_cbranch_scc1 L_gok_74
    s_sleep 3
    s_load_dwordx8 s[60:67], s[56:57], s40 glc
    s_branch L_glp_75
L_gok_74:
    v_mov_b32 v11, 1
    ds_write_b32 v21, v11 offset:48
    s_nop 0
    s_branch L_gfn_77
L_gdn_76:
    s_mov_b32 s100, 0
L_gl2_78:
    ds_read_b32 v10, v16 offset:48
    s_add_u32 s100, s100, 1
    s_waitcnt lgkmcnt(0)
    v_readfirstlane_b32 s11, v10
    s_cmp_ge_u32 s100, 0x80000
    s_cbranch_scc1 L_gfn_77
    s_cmp_lt_u32 s11, 1
    s_cbranch_scc1 L_gl2_78
    s_nop 0
L_gfn_77:
    s_cmp_lg_u32 s10, 0
    s_cbranch_scc1 L_pi_79
    s_add_u32 s13, s33, 3
    s_and_b32 s13, s13, 3
    s_mul_i32 s13, s13, 32
    s_add_u32 s40, s20, s13
    s_load_dwordx8 s[60:67], s[56:57], s40 glc
L_pi_79:
    s_add_u32 s12, s27, s23
    s_add_u32 m0, s18, 81920
    s_add_u32 s11, s19, s12
    buffer_load_dwordx4 v6, s[56:59], s11 offen sc1 lds
    buffer_load_dwordx4 v6, s[56:59], s11 offen offset:1024 sc1 lds
    s_add_u32 s12, s27, s23
    s_add_u32 s12, s12, 4096
    s_add_u32 m0, s18, 0
    s_add_u32 s11, s19, s12
    buffer_load_dwordx4 v6, s[56:59], s11 offen sc1 lds
    buffer_load_dwordx4 v6, s[56:59], s11 offen offset:1024 sc1 lds
    s_add_u32 s12, s27, s24
    s_add_u32 m0, s18, 90112
    s_add_u32 s11, s19, s12
    buffer_load_dwordx4 v6, s[56:59], s11 offen sc1 lds
    buffer_load_dwordx4 v6, s[56:59], s11 offen offset:1024 sc1 lds
    s_add_u32 s12, s27, s24
    s_add_u32 s12, s12, 4096
    s_add_u32 m0, s18, 49152
    s_lshl_b32 s11, s12, 4
    buffer_load_dwordx4 v7, s[48:51], s11 offen lds
    s_add_u32 m0, s18, 50176
    s_add_u32 s11, s11, 8192
    buffer_load_dwordx4 v7, s[48:51], s11 offen lds
    s_add_u32 s12, s28, s23
    s_add_u32 m0, s18, 24576
    s_lshl_b32 s11, s12, 4
    buffer_load_dwordx4 v7, s[48:51], s11 offen lds
    s_add_u32 m0, s18, 25600
    s_add_u32 s11, s11, 8192
    buffer_load_dwordx4 v7, s[48:51], s11 offen lds
    s_add_u32 s12, s28, s23
    s_add_u32 s12, s12, 4096
    s_add_u32 m0, s18, 57344
    s_lshl_b32 s11, s12, 4
    buffer_load_dwordx4 v7, s[48:51], s11 offen lds
    s_add_u32 m0, s18, 58368
    s_add_u32 s11, s11, 8192
    buffer_load_dwordx4 v7, s[48:51], s11 offen lds
    s_waitcnt vmcnt(10)
    s_cmp_lg_u32 s10, 0
    s_cbranch_scc1 L_gdn_82
    s_mov_b32 s100, 0
L_glp_81:
    s_waitcnt lgkmcnt(0)
    s_xor_b64 s[60:61], s[60:61], s[42:43]
    s_xor_b64 s[62:63], s[62:63], s[42:43]
    s_xor_b64 s[64:65], s[64:65], s[42:43]
    s_xor_b64 s[66:67], s[66:67], s[42:43]
    s_or_b64 s[60:61], s[60:61], s[62:63]
    s_or_b64 s[60:61], s[60:61], s[64:65]
    s_or_b64 s[60:61], s[60:61], s[66:67]
    s_cbranch_scc0 L_gok_80
    s_add_u32 s100, s100, 1
    s_cmp_ge_u32 s100, 20000
    s_cbranch_scc1 L_gok_80
    s_sleep 3
    s_load_dwordx8 s[60:67], s[56:57], s40 glc
    s_branch L_glp_81
L_gok_80:
L_gdn_82:
    s_barrier
    s_cmp_lg_u32 s10, 0
    s_cbranch_scc1 L_pi_83
    s_add_u32 s13, s33, 0
    s_and_b32 s13, s13, 3
    s_mul_i32 s13, s13, 16
    s_add_u32 s40, s21, s13
    s_load_dwordx4 s[60:63], s[56:57], s40 glc
L_pi_83:
    s_add_u32 s12, s27, s24
    s_add_u32 s12, s12, 4096
    s_add_u32 m0, s18, 131072
    s_add_u32 s11, s19, s12
    buffer_load_dwordx4 v6, s[56:59], s11 offen sc1 lds
    buffer_load_dwordx4 v6, s[56:59], s11 offen offset:1024 sc1 lds
    s_add_u32 s12, s28, s23
    s_add_u32 m0, s18, 8192
    s_add_u32 s11, s19, s12
    buffer_load_dwordx4 v6, s[56:59], s11 offen sc1 lds
    buffer_load_dwordx4 v6, s[56:59], s11 offen offset:1024 sc1 lds
    s_add_u32 s12, s28, s23
    s_add_u32 s12, s12, 4096
    s_add_u32 m0, s18, 98304
    s_add_u32 s11, s19, s12
    buffer_load_dwordx4 v6, s[56:59], s11 offen sc1 lds
    buffer_load_dwordx4 v6, s[56:59], s11 offen offset:1024 sc1 lds
    s_add_u32 s12, s28, s24
    s_add_u32 m0, s18, 147456
    s_lshl_b32 s11, s12, 4
    buffer_load_dwordx4 v7, s[48:51], s11 offen lds
    s_add_u32 m0, s18, 148480
    s_add_u32 s11, s11, 8192
    buffer_load_dwordx4 v7, s[48:51], s11 offen lds
    s_add_u32 s12, s28, s24
    s_add_u32 s12, s12, 4096
    s_add_u32 m0, s18, 106496
    s_lshl_b32 s11, s12, 4
    buffer_load_dwordx4 v7, s[48:51], s11 offen lds
    s_add_u32 m0, s18, 107520
    s_add_u32 s11, s11, 8192
    buffer_load_dwordx4 v7, s[48:51], s11 offen lds
    s_add_u32 s12, s25, 8192
    s_add_u32 m0, s18, 65536
    s_lshl_b32 s11, s12, 4
    buffer_load_dwordx4 v7, s[48:51], s11 offen lds
    s_add_u32 m0, s18, 66560
    s_add_u32 s11, s11, 8192
    buffer_load_dwordx4 v7, s[48:51], s11 offen lds
    s_waitcnt vmcnt(10)
    s_barrier
    s_add_u32 s12, s28, s24
    s_add_u32 m0, s18, 139264
    s_add_u32 s11, s19, s12
    buffer_load_dwordx4 v6, s[56:59], s11 offen sc1 lds
    buffer_load_dwordx4 v6, s[56:59], s11 offen offset:1024 sc1 lds
    s_add_u32 s12, s28, s24
    s_add_u32 s12, s12, 4096
    s_add_u32 m0, s18, 73728
    s_add_u32 s11, s19, s12
    buffer_load_dwordx4 v6, s[56:59], s11 offen sc1 lds
    buffer_load_dwordx4 v6, s[56:59], s11 offen offset:1024 sc1 lds
    s_add_u32 s12, s25, 12288
    s_add_u32 m0, s18, 16384
    s_lshl_b32 s11, s12, 4
    buffer_load_dwordx4 v7, s[48:51], s11 offen lds
    s_add_u32 m0, s18, 17408
    s_add_u32 s11, s11, 8192
    buffer_load_dwordx4 v7, s[48:51], s11 offen lds
    s_add_u32 s12, s25, 24576
    s_add_u32 m0, s18, 81920
    s_lshl_b32 s11, s12, 4
    buffer_load_dwordx4 v7, s[48:51], s11 offen lds
    s_add_u32 m0, s18, 82944
    s_add_u32 s11, s11, 8192
    buffer_load_dwordx4 v7, s[48:51], s11 offen lds
    s_add_u32 s12, s26, 8192
    s_add_u32 m0, s18, 114688
    s_lshl_b32 s11, s12, 4
    buffer_load_dwordx4 v7, s[48:51], s11 offen lds
    s_add_u32 m0, s18, 115712
    s_add_u32 s11, s11, 8192
    buffer_load_dwordx4 v7, s[48:51], s11 offen lds
    s_cmp_lg_u32 s10, 0
    s_cbranch_scc1 L_gdn_86
    s_mov_b32 s100, 0
L_glp_85:
    s_waitcnt lgkmcnt(0)
    s_xor_b64 s[60:61], s[60:61], s[42:43]
    s_xor_b64 s[62:63], s[62:63], s[42:43]
    s_or_b64 s[60:61], s[60:61], s[62:63]
    s_cbranch_scc0 L_gok_84
    s_add_u32 s100, s100, 1
    s_cmp_ge_u32 s100, 20000
    s_cbranch_scc1 L_gok_84
    s_sleep 3
    s_load_dwordx4 s[60:63], s[56:57], s40 glc
    s_branch L_glp_85
L_gok_84:
    v_mov_b32 v11, 2
    ds_write_b32 v21, v11 offset:48
    s_nop 0
    s_branch L_gfn_87
L_gdn_86:
    s_mov_b32 s100, 0
L_gl2_88:
    ds_read_b32 v10, v16 offset:48
    s_add_u32 s100, s100, 1
    s_waitcnt lgkmcnt(0)
    v_readfirstlane_b32 s11, v10
    s_cmp_ge_u32 s100, 0x80000
    s_cbranch_scc1 L_gfn_87
    s_cmp_lt_u32 s11, 2
    s_cbranch_scc1 L_gl2_88
    s_nop 0
L_gfn_87:
    s_cmp_lg_u32 s10, 0
    s_cbranch_scc1 L_pi_89
    s_add_u32 s13, s33, 1
    s_and_b32 s13, s13, 3
    s_mul_i32 s13, s13, 16
    s_add_u32 s40, s21, s13
    s_load_dwordx4 s[60:63], s[56:57], s40 glc
L_pi_89:
    s_add_u32 s12, s25, 8192
    s_add_u32 m0, s18, 32768
    s_add_u32 s11, s19, s12
    buffer_load_dwordx4 v6, s[56:59], s11 offen sc1 lds
    buffer_load_dwordx4 v6, s[56:59], s11 offen offset:1024 sc1 lds
    s_waitcnt vmcnt(10)
    s_cmp_lg_u32 s10, 0
    s_cbranch_scc1 L_gdn_92
    s_mov_b32 s100, 0
L_glp_91:
    s_waitcnt lgkmcnt(0)
    s_xor_b64 s[60:61], s[60:61], s[42:43]
    s_xor_b64 s[62:63], s[62:63], s[42:43]
    s_or_b64 s[60:61], s[60:61], s[62:63]
    s_cbranch_scc0 L_gok_90
    s_add_u32 s100, s100, 1
    s_cmp_ge_u32 s100, 20000
    s_cbranch_scc1 L_gok_90
    s_sleep 3
    s_load_dwordx4 s[60:63], s[56:57], s40 glc
    s_branch L_glp_91
L_gok_90:
L_gdn_92:
    s_barrier
    s_cmp_lg_u32 s10, 0
    s_cbranch_scc1 L_pi_93
    s_add_u32 s13, s33, 2
    s_and_b32 s13, s13, 3
    s_mul_i32 s13, s13, 16
    s_add_u32 s40, s21, s13
    s_load_dwordx4 s[60:63], s[56:57], s40 glc
L_pi_93:
    s_add_u32 s12, s25, 12288
    s_add_u32 m0, s18, 0
    s_add_u32 s11, s19, s12
    buffer_load_dwordx4 v6, s[56:59], s11 offen sc1 lds
    buffer_load_dwordx4 v6, s[56:59], s11 offen offset:1024 sc1 lds
    s_add_u32 s12, s25, 24576
    s_add_u32 m0, s18, 122880
    s_add_u32 s11, s19, s12
    buffer_load_dwordx4 v6, s[56:59], s11 offen sc1 lds
    buffer_load_dwordx4 v6, s[56:59], s11 offen offset:1024 sc1 lds
    s_add_u32 s12, s26, 8192
    s_add_u32 m0, s18, 90112
    s_add_u32 s11, s19, s12
    buffer_load_dwordx4 v6, s[56:59], s11 offen sc1 lds
    buffer_load_dwordx4 v6, s[56:59], s11 offen offset:1024 sc1 lds
    s_add_u32 s12, s26, 12288
    s_add_u32 m0, s18, 40960
    s_lshl_b32 s11, s12, 4
    buffer_load_dwordx4 v7, s[48:51], s11 offen lds
    s_add_u32 m0, s18, 41984
    s_add_u32 s11, s11, 8192
    buffer_load_dwordx4 v7, s[48:51], s11 offen lds
    s_add_u32 s12, s26, 24576
    s_add_u32 m0, s18, 131072
    s_lshl_b32 s11, s12, 4
    buffer_load_dwordx4 v7, s[48:51], s11 offen lds
    s_add_u32 m0, s18, 132096
    s_add_u32 s11, s11, 8192
    buffer_load_dwordx4 v7, s[48:51], s11 offen lds
    s_add_u32 s12, s27, 8192
    s_add_u32 m0, s18, 49152
    s_lshl_b32 s11, s12, 4
    buffer_load_dwordx4 v7, s[48:51], s11 offen lds
    s_add_u32 m0, s18, 50176
    s_add_u32 s11, s11, 8192
    buffer_load_dwordx4 v7, s[48:51], s11 offen lds
    s_waitcnt vmcnt(10)
    s_cmp_lg_u32 s10, 0
    s_cbranch_scc1 L_gdn_96
    s_mov_b32 s100, 0
L_glp_95:
    s_waitcnt lgkmcnt(0)
    s_xor_b64 s[60:61], s[60:61], s[42:43]
    s_xor_b64 s[62:63], s[62:63], s[42:43]
    s_or_b64 s[60:61], s[60:61], s[62:63]
    s_cbranch_scc0 L_gok_94
    s_add_u32 s100, s100, 1
    s_cmp_ge_u32 s100, 20000
    s_cbranch_scc1 L_gok_94
    s_sleep 3
    s_load_dwordx4 s[60:63], s[56:57], s40 glc
    s_branch L_glp_95
L_gok_94:
L_gdn_96:
    s_barrier
    s_cmp_lg_u32 s10, 0
    s_cbranch_scc1 L_pi_97
    s_add_u32 s13, s33, 3
    s_and_b32 s13, s13, 3
    s_mul_i32 s13, s13, 16
    s_add_u32 s40, s21, s13
    s_load_dwordx4 s[60:63], s[56:57], s40 glc
L_pi_97:
    s_add_u32 s12, s26, 12288
    s_add_u32 m0, s18, 8192
    s_add_u32 s11, s19, s12
    buffer_load_dwordx4 v6, s[56:59], s11 offen sc1 lds
    buffer_load_dwordx4 v6, s[56:59], s11 offen offset:1024 sc1 lds
    s_add_u32 s12, s26, 24576
    s_add_u32 m0, s18, 24576
    s_add_u32 s11, s19, s12
    buffer_load_dwordx4 v6, s[56:59], s11 offen sc1 lds
    buffer_load_dwordx4 v6, s[56:59], s11 offen offset:1024 sc1 lds
    s_add_u32 s12, s27, 8192
    s_add_u32 m0, s18, 98304
    s_add_u32 s11, s19, s12
    buffer_load_dwordx4 v6, s[56:59], s11 offen sc1 lds
    buffer_load_dwordx4 v6, s[56:59], s11 offen offset:1024 sc1 lds
    s_add_u32 s12, s27, 12288
    s_add_u32 m0, s18, 57344
    s_lshl_b32 s11, s12, 4
    buffer_load_dwordx4 v7, s[48:51], s11 offen lds
    s_add_u32 m0, s18, 58368
    s_add_u32 s11, s11, 8192
    buffer_load_dwordx4 v7, s[48:51], s11 offen lds
    s_add_u32 s12, s27, 24576
    s_add_u32 m0, s18, 139264
    s_lshl_b32 s11, s12, 4
    buffer_load_dwordx4 v7, s[48:51], s11 offen lds
    s_add_u32 m0, s18, 140288
    s_add_u32 s11, s11, 8192
    buffer_load_dwordx4 v7, s[48:51], s11 offen lds
    s_add_u32 s12, s28, 8192
    s_add_u32 m0, s18, 147456
    s_lshl_b32 s11, s12, 4
    buffer_load_dwordx4 v7, s[48:51], s11 offen lds
    s_add_u32 m0, s18, 148480
    s_add_u32 s11, s11, 8192
    buffer_load_dwordx4 v7, s[48:51], s11 offen lds
    s_waitcnt vmcnt(10)
    s_cmp_lg_u32 s10, 0
    s_cbranch_scc1 L_gdn_100
    s_mov_b32 s100, 0
L_glp_99:
    s_waitcnt lgkmcnt(0)
    s_xor_b64 s[60:61], s[60:61], s[42:43]
    s_xor_b64 s[62:63], s[62:63], s[42:43]
    s_or_b64 s[60:61], s[60:61], s[62:63]
    s_cbranch_scc0 L_gok_98
    s_add_u32 s100, s100, 1
    s_cmp_ge_u32 s100, 20000
    s_cbranch_scc1 L_gok_98
    s_sleep 3
    s_load_dwordx4 s[60:63], s[56:57], s40 glc
    s_branch L_glp_99
L_gok_98:
L_gdn_100:
    s_barrier
    s_cmp_lg_u32 s10, 0
    s_cbranch_scc1 L_pi_101
    s_mov_b32 s40, s22
    s_load_dwordx16 s[60:75], s[56:57], s40 glc
L_pi_101:
    s_add_u32 s12, s27, 12288
    s_add_u32 m0, s18, 73728
    s_add_u32 s11, s19, s12
    buffer_load_dwordx4 v6, s[56:59], s11 offen sc1 lds
    buffer_load_dwordx4 v6, s[56:59], s11 offen offset:1024 sc1 lds
    s_add_u32 s12, s27, 24576
    s_add_u32 m0, s18, 106496
    s_add_u32 s11, s19, s12
    buffer_load_dwordx4 v6, s[56:59], s11 offen sc1 lds
    buffer_load_dwordx4 v6, s[56:59], s11 offen offset:1024 sc1 lds
    s_add_u32 s12, s28, 8192
    s_add_u32 m0, s18, 32768
    s_add_u32 s11, s19, s12
    buffer_load_dwordx4 v6, s[56:59], s11 offen sc1 lds
    buffer_load_dwordx4 v6, s[56:59], s11 offen offset:1024 sc1 lds
    s_add_u32 s12, s28, 12288
    s_add_u32 m0, s18, 65536
    s_lshl_b32 s11, s12, 4
    buffer_load_dwordx4 v7, s[48:51], s11 offen lds
    s_add_u32 m0, s18, 66560
    s_add_u32 s11, s11, 8192
    buffer_load_dwordx4 v7, s[48:51], s11 offen lds
    s_add_u32 s12, s28, 24576
    s_add_u32 m0, s18, 0
    s_lshl_b32 s11, s12, 4
    buffer_load_dwordx4 v7, s[48:51], s11 offen lds
    s_add_u32 m0, s18, 1024
    s_add_u32 s11, s11, 8192
    buffer_load_dwordx4 v7, s[48:51], s11 offen lds
    s_add_u32 s12, s29, 0
    s_and_b32 s12, s12, 0x7fff
    s_add_u32 m0, s18, 16384
    s_lshl_b32 s11, s12, 4
    buffer_load_dwordx4 v7, s[52:55], s11 offen lds
    s_add_u32 m0, s18, 17408
    s_add_u32 s11, s11, 8192
    buffer_load_dwordx4 v7, s[52:55], s11 offen lds
    s_waitcnt vmcnt(10)
    s_barrier
    s_add_u32 s12, s28, 12288
    s_add_u32 m0, s18, 122880
    s_add_u32 s11, s19, s12
    buffer_load_dwordx4 v6, s[56:59], s11 offen sc1 lds
    buffer_load_dwordx4 v6, s[56:59], s11 offen offset:1024 sc1 lds
    s_add_u32 s12, s28, 24576
    s_add_u32 m0, s18, 81920
    s_add_u32 s11, s19, s12
    buffer_load_dwordx4 v6, s[56:59], s11 offen sc1 lds
    buffer_load_dwordx4 v6, s[56:59], s11 offen offset:1024 sc1 lds
    s_add_u32 s12, s29, 4096
    s_and_b32 s12, s12, 0x7fff
    s_add_u32 m0, s18, 8192
    s_lshl_b32 s11, s12, 4
    buffer_load_dwordx4 v7, s[52:55], s11 offen lds
    s_add_u32 m0, s18, 9216
    s_add_u32 s11, s11, 8192
    buffer_load_dwordx4 v7, s[52:55], s11 offen lds
    s_add_u32 s12, s29, 8192
    s_and_b32 s12, s12, 0x7fff
    s_add_u32 m0, s18, 40960
    s_lshl_b32 s11, s12, 4
    buffer_load_dwordx4 v7, s[52:55], s11 offen lds
    s_add_u32 m0, s18, 41984
    s_add_u32 s11, s11, 8192
    buffer_load_dwordx4 v7, s[52:55], s11 offen lds
    s_cmp_lg_u32 s10, 0
    s_cbranch_scc1 L_gdn_104
    s_mov_b32 s100, 0
L_glp_103:
    s_waitcnt lgkmcnt(0)
    s_xor_b64 s[60:61], s[60:61], s[42:43]
    s_xor_b64 s[62:63], s[62:63], s[42:43]
    s_xor_b64 s[64:65], s[64:65], s[42:43]
    s_xor_b64 s[66:67], s[66:67], s[42:43]
    s_xor_b64 s[68:69], s[68:69], s[42:43]
    s_xor_b64 s[70:71], s[70:71], s[42:43]
    s_xor_b64 s[72:73], s[72:73], s[42:43]
    s_xor_b64 s[74:75], s[74:75], s[42:43]
    s_or_b64 s[60:61], s[60:61], s[62:63]
    s_or_b64 s[60:61], s[60:61], s[64:65]
    s_or_b64 s[60:61], s[60:61], s[66:67]
    s_or_b64 s[60:61], s[60:61], s[68:69]
    s_or_b64 s[60:61], s[60:61], s[70:71]
    s_or_b64 s[60:61], s[60:61], s[72:73]
    s_or_b64 s[60:61], s[60:61], s[74:75]
    s_cbranch_scc0 L_gok_102
    s_add_u32 s100, s100, 1
    s_cmp_ge_u32 s100, 20000
    s_cbranch_scc1 L_gok_102
    s_sleep 3
    s_load_dwordx16 s[60:75], s[56:57], s40 glc
    s_branch L_glp_103
L_gok_102:
    v_mov_b32 v11, 3
    ds_write_b32 v21, v11 offset:48
    s_nop 0
    s_branch L_gfn_105
L_gdn_104:
    s_mov_b32 s100, 0
L_gl2_106:
    ds_read_b32 v10, v16 offset:48
    s_add_u32 s100, s100, 1
    s_waitcnt lgkmcnt(0)
    v_readfirstlane_b32 s11, v10
    s_cmp_ge_u32 s100, 0x80000
    s_cbranch_scc1 L_gfn_105
    s_cmp_lt_u32 s11, 3
    s_cbranch_scc1 L_gl2_106
    s_nop 0
L_gfn_105:
    s_add_u32 s12, s29, 0
    s_and_b32 s12, s12, 0x7fff
    s_add_u32 s12, s12, 114688
    s_add_u32 m0, s18, 90112
    s_add_u32 s11, s19, s12
    buffer_load_dwordx4 v6, s[56:59], s11 offen sc1 lds
    buffer_load_dwordx4 v6, s[56:59], s11 offen offset:1024 sc1 lds
    s_add_u32 s12, s29, 4096
    s_and_b32 s12, s12, 0x7fff
    s_add_u32 s12, s12, 114688
    s_add_u32 m0, s18, 114688
    s_add_u32 s11, s19, s12
    buffer_load_dwordx4 v6, s[56:59], s11 offen sc1 lds
    buffer_load_dwordx4 v6, s[56:59], s11 offen offset:1024 sc1 lds
    s_waitcnt vmcnt(10)
    s_barrier
    s_add_u32 s12, s29, 8192
    s_and_b32 s12, s12, 0x7fff
    s_add_u32 s12, s12, 114688
    s_add_u32 m0, s18, 24576
    s_add_u32 s11, s19, s12
    buffer_load_dwordx4 v6, s[56:59], s11 offen sc1 lds
    buffer_load_dwordx4 v6, s[56:59], s11 offen offset:1024 sc1 lds
    s_add_u32 s12, s29, 12288
    s_and_b32 s12, s12, 0x7fff
    s_add_u32 s12, s12, 114688
    s_add_u32 m0, s18, 131072
    s_add_u32 s11, s19, s12
    buffer_load_dwordx4 v6, s[56:59], s11 offen sc1 lds
    buffer_load_dwordx4 v6, s[56:59], s11 offen offset:1024 sc1 lds
    s_add_u32 s12, s29, 12288
    s_and_b32 s12, s12, 0x7fff
    s_add_u32 m0, s18, 49152
    s_lshl_b32 s11, s12, 4
    buffer_load_dwordx4 v7, s[52:55], s11 offen lds
    s_add_u32 m0, s18, 50176
    s_add_u32 s11, s11, 8192
    buffer_load_dwordx4 v7, s[52:55], s11 offen lds
    s_add_u32 s12, s29, 16384
    s_and_b32 s12, s12, 0x7fff
    s_add_u32 s12, s12, 114688
    s_add_u32 m0, s18, 98304
    s_add_u32 s11, s19, s12
    buffer_load_dwordx4 v6, s[56:59], s11 offen sc1 lds
    buffer_load_dwordx4 v6, s[56:59], s11 offen offset:1024 sc1 lds
    s_add_u32 s12, s29, 16384
    s_and_b32 s12, s12, 0x7fff
    s_add_u32 m0, s18, 73728
    s_lshl_b32 s11, s12, 4
    buffer_load_dwordx4 v7, s[52:55], s11 offen lds
    s_add_u32 m0, s18, 74752
    s_add_u32 s11, s11, 8192
    buffer_load_dwordx4 v7, s[52:55], s11 offen lds
    s_add_u32 s12, s29, 20480
    s_and_b32 s12, s12, 0x7fff
    s_add_u32 m0, s18, 57344
    s_lshl_b32 s11, s12, 4
    buffer_load_dwordx4 v7, s[52:55], s11 offen lds
    s_add_u32 m0, s18, 58368
    s_add_u32 s11, s11, 8192
    buffer_load_dwordx4 v7, s[52:55], s11 offen lds
    s_waitcnt vmcnt(12)
    s_barrier
    s_add_u32 s12, s29, 20480
    s_and_b32 s12, s12, 0x7fff
    s_add_u32 s12, s12, 114688
    s_add_u32 m0, s18, 106496
    s_add_u32 s11, s19, s12
    buffer_load_dwordx4 v6, s[56:59], s11 offen sc1 lds
    buffer_load_dwordx4 v6, s[56:59], s11 offen offset:1024 sc1 lds
    s_add_u32 s12, s29, 24576
    s_and_b32 s12, s12, 0x7fff
    s_add_u32 s12, s12, 114688
    s_add_u32 m0, s18, 139264
    s_add_u32 s11, s19, s12
    buffer_load_dwordx4 v6, s[56:59], s11 offen sc1 lds
    buffer_load_dwordx4 v6, s[56:59], s11 offen offset:1024 sc1 lds
    s_add_u32 s12, s29, 24576
    s_and_b32 s12, s12, 0x7fff
    s_add_u32 m0, s18, 147456
    s_lshl_b32 s11, s12, 4
    buffer_load_dwordx4 v7, s[52:55], s11 offen lds
    s_add_u32 m0, s18, 148480
    s_add_u32 s11, s11, 8192
    buffer_load_dwordx4 v7, s[52:55], s11 offen lds
    s_add_u32 s12, s29, 28672
    s_and_b32 s12, s12, 0x7fff
    s_add_u32 s12, s12, 114688
    s_add_u32 m0, s18, 32768
    s_add_u32 s11, s19, s12
    buffer_load_dwordx4 v6, s[56:59], s11 offen sc1 lds
    buffer_load_dwordx4 v6, s[56:59], s11 offen offset:1024 sc1 lds
    s_add_u32 s12, s29, 28672
    s_and_b32 s12, s12, 0x7fff
    s_add_u32 m0, s18, 122880
    s_lshl_b32 s11, s12, 4
    buffer_load_dwordx4 v7, s[52:55], s11 offen lds
    s_add_u32 m0, s18, 123904
    s_add_u32 s11, s11, 8192
    buffer_load_dwordx4 v7, s[52:55], s11 offen lds
    s_waitcnt vmcnt(12)
    s_barrier
    s_waitcnt vmcnt(4)
    s_barrier
    s_waitcnt vmcnt(0)
    s_barrier
    s_endpgm
.p2align 6
L_exit:
    s_endpgm
L_groupAB:
    s_cmp_lt_u32 s3, 10
    s_cbranch_scc1 L_cpf_107
    s_getpc_b64 s[12:13]
L_pc0:
    s_sub_u32 s12, s12, L_pc0-gated_mix__linear_kernel_hedgehog__dense_activation_relu__prompt_kernel
    s_subb_u32 s13, s13, 0
    s_lshr_b32 s11, s2, 3
    s_lshl_b32 s11, s11, 1
    s_add_u32 s11, s11, s3
    s_sub_u32 s11, s11, 10
    s_lshl_b32 s11, s11, 10
    s_min_u32 s11, s11, L_code_end-gated_mix__linear_kernel_hedgehog__dense_activation_relu__prompt_kernel-1024
    v_lshl_add_u32 v2, v0, 4, s11
    global_load_dwordx4 v[144:147], v2, s[12:13]
    s_nop 0
L_cpf_107:
    s_mul_i32 s11, s6, 224
    s_bitcmp1_b32 s6, 0
    s_cselect_b32 s84, 32, 0
    s_cselect_b32 s86, 0, 192
    s_add_u32 s84, s84, s11
    s_add_u32 s85, s84, 128
    s_add_u32 s86, s86, s11
    v_lshlrev_b32 v6, 4, v0
    s_mov_b32 s38, 0x3fb8aa3b
    s_mov_b32 s39, 0x3fb8aa3b
    s_waitcnt lgkmcnt(0)
    s_mov_b64 s[56:57], s[36:37]
    s_mov_b32 s58, 13631488
    s_mov_b32 s59, 0x20000
    s_mov_b64 s[64:65], s[28:29]
    s_mov_b64 s[66:67], s[22:23]
    s_mov_b32 s29, 0
    s_lshr_b32 s11, s3, 3
    s_lshl1_add_u32 s11, s11, s5
    s_cmp_eq_u32 s11, 0
    s_cbranch_scc1 L_A_attn
    s_cmp_eq_u32 s11, 3
    s_cbranch_scc1 L_B_attn
    s_cmp_eq_u32 s11, 2
    s_cbranch_scc1 L_B_ffn
L_A_ffn:
    v_and_b32 v8, 31, v0
    v_lshrrev_b32 v9, 5, v0
    v_bfe_u32 v10, v0, 1, 3
    v_xor_b32 v10, v10, v9
    v_lshlrev_b32 v10, 4, v10
    v_lshl_or_b32 v21, v8, 7, v10
    v_xor_b32 v22, 32, v21
    v_xor_b32 v23, 64, v21
    v_xor_b32 v24, 96, v21
    v_lshrrev_b32 v9, 5, v0
    v_bfe_u32 v8, v0, 2, 2
    v_lshl_or_b32 v8, v9, 3, v8
    v_and_b32 v12, 1, v0
    v_bfe_u32 v13, v0, 1, 1
    v_lshlrev_b32 v9, 4, v12
    v_lshl_or_b32 v9, v13, 3, v9
    v_bfe_u32 v10, v0, 4, 1
    v_bfe_u32 v11, v0, 3, 1
    v_lshlrev_b32 v11, 6, v11
    s_and_b32 s11, s10, 1
    s_lshl_b32 s11, s11, 6
    s_lshr_b32 s12, s10, 1
    s_lshl_b32 s13, s12, 5
    s_xor_b32 s11, s11, s13
    s_lshl_b32 s12, s12, 12
    s_add_u32 s12, s12, 131072
    v_lshl_or_b32 v14, v10, 5, v9
    v_xor_b32 v14, v14, v11
    v_xor_b32 v14, s11, v14
    v_lshl_add_u32 v14, v8, 7, v14
    v_add_u32 v25, s12, v14
    s_lshr_b32 s13, s10, 1
    s_lshl_b32 s12, s13, 12
    v_add_u32 v29, s12, v6
    v_add_u32 v26, 0x10000, v29
    v_add_u32 v27, 0x20000, v29
    v_lshlrev_b32 v14, 5, v12
    v_lshl_or_b32 v14, v10, 4, v14
    v_lshl_or_b32 v14, v13, 3, v14
    v_xor_b32 v14, v14, v11
    s_and_b32 s101, s10, 1
    s_lshl_b32 s101, s101, 6
    v_xor_b32 v14, s101, v14
    v_lshl_add_u32 v28, v8, 7, v14
    v_add_u32 v20, 0x10000, v28
    v_add_u32 v1, 0x20000, v28
    v_and_b32 v14, 31, v0
    v_and_b32 v15, 32, v0
    v_lshl_or_b32 v18, v14, 10, v15
    s_lshl_b32 s12, s8, 1
    s_add_u32 s12, s12, s13
    s_lshl_b32 s13, s12, 15
    s_lshl_b32 s14, s9, 7
    s_add_u32 s13, s13, s14
    s_add_u32 s13, s13, s101
    v_add_u32 v18, s13, v18
    s_lshr_b32 s13, s12, 2
    s_lshl_b32 s13, s13, 12
    s_and_b32 s14, s12, 3
    s_lshl_b32 s14, s14, 7
    s_add_u32 s13, s13, s14
    s_add_u32 s13, s13, 10092544
    v_lshl_add_u32 v19, v14, 2, s13
    s_mov_b64 s[44:45], s[32:33]
    s_mov_b32 s46, 2097152
    s_mov_b32 s47, 0x20000
    s_mul_i32 s12, s4, 4352
    s_lshl_b32 s13, s6, 4
    s_lshl_b32 s14, s10, 2
    s_add_u32 s12, s12, s13
    s_add_u32 s12, s12, s14
    s_add_u32 s25, s12, 10485760
    s_mul_i32 s101, s4, 589824
    s_lshl_b32 s12, s10, 5
    s_add_u32 s12, s12, s84
    s_lshl_b32 s12, s12, 6
    s_add_u32 s26, s12, s101
    s_barrier
    ds_read_b128 v[96:99], v21 offset:0
    ds_read_b128 v[100:103], v21 offset:4096
    ds_read_b128 v[104:107], v21 offset:8192
    ds_read_b128 v[108:111], v21 offset:12288
    ds_read_b64_tr_b16 v[112:113], v25 offset:0
    ds_read_b64_tr_b16 v[114:115], v25 offset:512
    ds_read_b128 v[116:119], v22 offset:0
    ds_read_b128 v[120:123], v22 offset:4096
    ds_read_b128 v[124:127], v22 offset:8192
    ds_read_b128 v[128:131], v22 offset:12288
    ds_read_b64_tr_b16 v[132:133], v25 offset:2048
    ds_read_b64_tr_b16 v[134:135], v25 offset:2560
    s_waitcnt lgkmcnt(0)
    s_barrier
    v_mfma_f32_32x32x16_bf16 v[32:47], v[112:115], v[96:99], 0
    ds_read_b128 v[136:139], v23 offset:0
    ds_read_b128 v[140:143], v23 offset:4096
    ds_read_b64_tr_b16 v[152:153], v25 offset:8192
    v_mfma_f32_32x32x16_bf16 v[48:63], v[112:115], v[100:103], 0
    ds_read_b128 v[144:147], v23 offset:8192
    ds_read_b128 v[148:151], v23 offset:12288
    ds_read_b64_tr_b16 v[154:155], v25 offset:8704
    v_mfma_f32_32x32x16_bf16 v[64:79], v[112:115], v[104:107], 0
    ds_read_b128 v[96:99], v24 offset:0
    ds_read_b128 v[100:103], v24 offset:4096
    v_mfma_f32_32x32x16_bf16 v[80:95], v[112:115], v[108:111], 0
    ds_read_b128 v[104:107], v24 offset:8192
    ds_read_b128 v[108:111], v24 offset:12288
    ds_read_b64_tr_b16 v[112:113], v25 offset:10240
    ds_read_b64_tr_b16 v[114:115], v25 offset:10752
    v_mfma_f32_32x32x16_bf16 v[32:47], v[132:135], v[116:119], v[32:47]
    v_mfma_f32_32x32x16_bf16 v[48:63], v[132:135], v[120:123], v[48:63]
    v_mfma_f32_32x32x16_bf16 v[64:79], v[132:135], v[124:127], v[64:79]
    v_mfma_f32_32x32x16_bf16 v[80:95], v[132:135], v[128:131], v[80:95]
    s_waitcnt lgkmcnt(0)
    s_barrier
    v_mfma_f32_32x32x16_bf16 v[32:47], v[152:155], v[136:139], v[32:47]
    ds_read_b128 v[116:119], v21 offset:16384
    ds_read_b128 v[120:123], v21 offset:20480
    ds_read_b64_tr_b16 v[132:133], v25 offset:16384
    v_mfma_f32_32x32x16_bf16 v[48:63], v[152:155], v[140:143], v[48:63]
    ds_read_b128 v[124:127], v21 offset:24576
    ds_read_b128 v[128:131], v21 offset:28672
    ds_read_b64_tr_b16 v[134:135], v25 offset:16896
    v_mfma_f32_32x32x16_bf16 v[64:79], v[152:155], v[144:147], v[64:79]
    ds_read_b128 v[136:139], v22 offset:16384
    ds_read_b128 v[140:143], v22 offset:20480
    v_mfma_f32_32x32x16_bf16 v[80:95], v[152:155], v[148:151], v[80:95]
    ds_read_b128 v[144:147], v22 offset:24576
    ds_read_b128 v[148:151], v22 offset:28672
    ds_read_b64_tr_b16 v[152:153], v25 offset:18432
    ds_read_b64_tr_b16 v[154:155], v25 offset:18944
    v_mfma_f32_32x32x16_bf16 v[32:47], v[112:115], v[96:99], v[32:47]
    v_mfma_f32_32x32x16_bf16 v[48:63], v[112:115], v[100:103], v[48:63]
    v_mfma_f32_32x32x16_bf16 v[64:79], v[112:115], v[104:107], v[64:79]
    v_mfma_f32_32x32x16_bf16 v[80:95], v[112:115], v[108:111], v[80:95]
    s_waitcnt lgkmcnt(0)
    s_barrier
    v_mfma_f32_32x32x16_bf16 v[32:47], v[132:135], v[116:119], v[32:47]
    ds_read_b128 v[96:99], v23 offset:16384
    ds_read_b128 v[100:103], v23 offset:20480
    ds_read_b64_tr_b16 v[112:113], v25 offset:24576
    v_mfma_f32_32x32x16_bf16 v[48:63], v[132:135], v[120:123], v[48:63]
    ds_read_b128 v[104:107], v23 offset:24576
    ds_read_b128 v[108:111], v23 offset:28672
    ds_read_b64_tr_b16 v[114:115], v25 offset:25088
    v_mfma_f32_32x32x16_bf16 v[64:79], v[132:135], v[124:127], v[64:79]
    ds_read_b128 v[116:119], v24 offset:16384
    ds_read_b128 v[120:123], v24 offset:20480
    v_mfma_f32_32x32x16_bf16 v[80:95], v[132:135], v[128:131], v[80:95]
    ds_read_b128 v[124:127], v24 offset:24576
    ds_read_b128 v[128:131], v24 offset:28672
    ds_read_b64_tr_b16 v[132:133], v25 offset:26624
    ds_read_b64_tr_b16 v[134:135], v25 offset:27136
    v_mfma_f32_32x32x16_bf16 v[32:47], v[152:155], v[136:139], v[32:47]
    v_mfma_f32_32x32x16_bf16 v[48:63], v[152:155], v[140:143], v[48:63]
    v_mfma_f32_32x32x16_bf16 v[64:79], v[152:155], v[144:147], v[64:79]
    v_mfma_f32_32x32x16_bf16 v[80:95], v[152:155], v[148:151], v[80:95]
    s_waitcnt lgkmcnt(0)
    s_barrier
    v_mfma_f32_32x32x16_bf16 v[32:47], v[112:115], v[96:99], v[32:47]
    ds_read_b128 v[136:139], v21 offset:32768
    ds_read_b128 v[140:143], v21 offset:36864
    ds_read_b64_tr_b16 v[152:153], v25 offset:0
    v_mfma_f32_32x32x16_bf16 v[48:63], v[112:115], v[100:103], v[48:63]
    ds_read_b128 v[144:147], v21 offset:40960
    ds_read_b128 v[148:151], v21 offset:45056
    ds_read_b64_tr_b16 v[154:155], v25 offset:512
    v_mfma_f32_32x32x16_bf16 v[64:79], v[112:115], v[104:107], v[64:79]
    ds_read_b128 v[96:99], v22 offset:32768
    ds_read_b128 v[100:103], v22 offset:36864
    v_mfma_f32_32x32x16_bf16 v[80:95], v[112:115], v[108:111], v[80:95]
    ds_read_b128 v[104:107], v22 offset:40960
    ds_read_b128 v[108:111], v22 offset:45056
    ds_read_b64_tr_b16 v[112:113], v25 offset:2048
    ds_read_b64_tr_b16 v[114:115], v25 offset:2560
    v_mfma_f32_32x32x16_bf16 v[32:47], v[132:135], v[116:119], v[32:47]
    v_mfma_f32_32x32x16_bf16 v[48:63], v[132:135], v[120:123], v[48:63]
    v_mfma_f32_32x32x16_bf16 v[64:79], v[132:135], v[124:127], v[64:79]
    v_mfma_f32_32x32x16_bf16 v[80:95], v[132:135], v[128:131], v[80:95]
    s_waitcnt lgkmcnt(0)
    s_barrier
    v_mfma_f32_32x32x16_bf16 v[32:47], v[152:155], v[136:139], v[32:47]
    ds_read_b128 v[116:119], v23 offset:32768
    ds_read_b128 v[120:123], v23 offset:36864
    ds_read_b64_tr_b16 v[132:133], v25 offset:8192
    v_mfma_f32_32x32x16_bf16 v[48:63], v[152:155], v[140:143], v[48:63]
    ds_read_b128 v[124:127], v23 offset:40960
    ds_read_b128 v[128:131], v23 offset:45056
    ds_read_b64_tr_b16 v[134:135], v25 offset:8704
    v_mfma_f32_32x32x16_bf16 v[64:79], v[152:155], v[144:147], v[64:79]
    ds_read_b128 v[136:139], v24 offset:32768
    ds_read_b128 v[140:143], v24 offset:36864
    v_mfma_f32_32x32x16_bf16 v[80:95], v[152:155], v[148:151], v[80:95]
    ds_read_b128 v[144:147], v24 offset:40960
    ds_read_b128 v[148:151], v24 offset:45056
    ds_read_b64_tr_b16 v[152:153], v25 offset:10240
    ds_read_b64_tr_b16 v[154:155], v25 offset:10752
    v_mfma_f32_32x32x16_bf16 v[32:47], v[112:115], v[96:99], v[32:47]
    v_mfma_f32_32x32x16_bf16 v[48:63], v[112:115], v[100:103], v[48:63]
    v_mfma_f32_32x32x16_bf16 v[64:79], v[112:115], v[104:107], v[64:79]
    v_mfma_f32_32x32x16_bf16 v[80:95], v[112:115], v[108:111], v[80:95]
    s_waitcnt lgkmcnt(0)
    s_barrier
    v_mfma_f32_32x32x16_bf16 v[32:47], v[132:135], v[116:119], v[32:47]
    ds_read_b128 v[96:99], v21 offset:49152
    ds_read_b128 v[100:103], v21 offset:53248
    ds_read_b64_tr_b16 v[112:113], v25 offset:16384
    v_mfma_f32_32x32x16_bf16 v[48:63], v[132:135], v[120:123], v[48:63]
    ds_read_b128 v[104:107], v21 offset:57344
    ds_read_b128 v[108:111], v21 offset:61440
    ds_read_b64_tr_b16 v[114:115], v25 offset:16896
    v_mfma_f32_32x32x16_bf16 v[64:79], v[132:135], v[124:127], v[64:79]
    ds_read_b128 v[116:119], v22 offset:49152
    ds_read_b128 v[120:123], v22 offset:53248
    v_mfma_f32_32x32x16_bf16 v[80:95], v[132:135], v[128:131], v[80:95]
    ds_read_b128 v[124:127], v22 offset:57344
    ds_read_b128 v[128:131], v22 offset:61440
    ds_read_b64_tr_b16 v[132:133], v25 offset:18432
    ds_read_b64_tr_b16 v[134:135], v25 offset:18944
    v_mfma_f32_32x32x16_bf16 v[32:47], v[152:155], v[136:139], v[32:47]
    v_mfma_f32_32x32x16_bf16 v[48:63], v[152:155], v[140:143], v[48:63]
    v_mfma_f32_32x32x16_bf16 v[64:79], v[152:155], v[144:147], v[64:79]
    v_mfma_f32_32x32x16_bf16 v[80:95], v[152:155], v[148:151], v[80:95]
    s_waitcnt lgkmcnt(0)
    s_barrier
    v_mfma_f32_32x32x16_bf16 v[32:47], v[112:115], v[96:99], v[32:47]
    ds_read_b128 v[136:139], v23 offset:49152
    ds_read_b128 v[140:143], v23 offset:53248
    ds_read_b64_tr_b16 v[152:153], v25 offset:24576
    v_mfma_f32_32x32x16_bf16 v[48:63], v[112:115], v[100:103], v[48:63]
    ds_read_b128 v[144:147], v23 offset:57344
    ds_read_b128 v[148:151], v23 offset:61440
    ds_read_b64_tr_b16 v[154:155], v25 offset:25088
    v_mfma_f32_32x32x16_bf16 v[64:79], v[112:115], v[104:107], v[64:79]
    ds_read_b128 v[96:99], v24 offset:49152
    ds_read_b128 v[100:103], v24 offset:53248
    v_mfma_f32_32x32x16_bf16 v[80:95], v[112:115], v[108:111], v[80:95]
    ds_read_b128 v[104:107], v24 offset:57344
    ds_read_b128 v[108:111], v24 offset:61440
    ds_read_b64_tr_b16 v[112:113], v25 offset:26624
    ds_read_b64_tr_b16 v[114:115], v25 offset:27136
    v_mfma_f32_32x32x16_bf16 v[32:47], v[132:135], v[116:119], v[32:47]
    v_mfma_f32_32x32x16_bf16 v[48:63], v[132:135], v[120:123], v[48:63]
    v_mfma_f32_32x32x16_bf16 v[64:79], v[132:135], v[124:127], v[64:79]
    v_mfma_f32_32x32x16_bf16 v[80:95], v[132:135], v[128:131], v[80:95]
    s_waitcnt lgkmcnt(0)
    s_barrier
    v_add_u32 v21, 0x10000, v21
    v_add_u32 v22, 0x10000, v22
    v_add_u32 v23, 0x10000, v23
    v_add_u32 v24, 0x10000, v24
    v_mfma_f32_32x32x16_bf16 v[32:47], v[152:155], v[136:139], v[32:47]
    ds_read_b128 v[116:119], v21 offset:0
    ds_read_b128 v[120:123], v21 offset:4096
    ds_read_b64_tr_b16 v[132:133], v25 offset:0
    v_mfma_f32_32x32x16_bf16 v[48:63], v[152:155], v[140:143], v[48:63]
    ds_read_b128 v[124:127], v21 offset:8192
    ds_read_b128 v[128:131], v21 offset:12288
    ds_read_b64_tr_b16 v[134:135], v25 offset:512
    v_mfma_f32_32x32x16_bf16 v[64:79], v[152:155], v[144:147], v[64:79]
    ds_read_b128 v[136:139], v22 offset:0
    ds_read_b128 v[140:143], v22 offset:4096
    v_mfma_f32_32x32x16_bf16 v[80:95], v[152:155], v[148:151], v[80:95]
    ds_read_b128 v[144:147], v22 offset:8192
    ds_read_b128 v[148:151], v22 offset:12288
    ds_read_b64_tr_b16 v[152:153], v25 offset:2048
    ds_read_b64_tr_b16 v[154:155], v25 offset:2560
    v_mfma_f32_32x32x16_bf16 v[32:47], v[112:115], v[96:99], v[32:47]
    v_mfma_f32_32x32x16_bf16 v[48:63], v[112:115], v[100:103], v[48:63]
    v_mfma_f32_32x32x16_bf16 v[64:79], v[112:115], v[104:107], v[64:79]
    v_mfma_f32_32x32x16_bf16 v[80:95], v[112:115], v[108:111], v[80:95]
    s_waitcnt lgkmcnt(0)
    s_barrier
    v_mfma_f32_32x32x16_bf16 v[32:47], v[132:135], v[116:119], v[32:47]
    ds_read_b128 v[96:99], v23 offset:0
    ds_read_b128 v[100:103], v23 offset:4096
    ds_read_b64_tr_b16 v[112:113], v25 offset:8192
    v_mfma_f32_32x32x16_bf16 v[48:63], v[132:135], v[120:123], v[48:63]
    ds_read_b128 v[104:107], v23 offset:8192
    ds_read_b128 v[108:111], v23 offset:12288
    ds_read_b64_tr_b16 v[114:115], v25 offset:8704
    v_mfma_f32_32x32x16_bf16 v[64:79], v[132:135], v[124:127], v[64:79]
    ds_read_b128 v[116:119], v24 offset:0
    ds_read_b128 v[120:123], v24 offset:4096
    v_mfma_f32_32x32x16_bf16 v[80:95], v[132:135], v[128:131], v[80:95]
    ds_read_b128 v[124:127], v24 offset:8192
    ds_read_b128 v[128:131], v24 offset:12288
    ds_read_b64_tr_b16 v[132:133], v25 offset:10240
    ds_read_b64_tr_b16 v[134:135], v25 offset:10752
    v_mfma_f32_32x32x16_bf16 v[32:47], v[152:155], v[136:139], v[32:47]
    v_mfma_f32_32x32x16_bf16 v[48:63], v[152:155], v[140:143], v[48:63]
    v_mfma_f32_32x32x16_bf16 v[64:79], v[152:155], v[144:147], v[64:79]
    v_mfma_f32_32x32x16_bf16 v[80:95], v[152:155], v[148:151], v[80:95]
    s_waitcnt lgkmcnt(0)
    s_barrier
    v_mfma_f32_32x32x16_bf16 v[32:47], v[112:115], v[96:99], v[32:47]
    ds_read_b128 v[136:139], v21 offset:16384
    ds_read_b128 v[140:143], v21 offset:20480
    ds_read_b64_tr_b16 v[152:153], v25 offset:16384
    v_mfma_f32_32x32x16_bf16 v[48:63], v[112:115], v[100:103], v[48:63]
    ds_read_b128 v[144:147], v21 offset:24576
    ds_read_b128 v[148:151], v21 offset:28672
    ds_read_b64_tr_b16 v[154:155], v25 offset:16896
    v_mfma_f32_32x32x16_bf16 v[64:79], v[112:115], v[104:107], v[64:79]
    ds_read_b128 v[96:99], v22 offset:16384
    ds_read_b128 v[100:103], v22 offset:20480
    v_mfma_f32_32x32x16_bf16 v[80:95], v[112:115], v[108:111], v[80:95]
    ds_read_b128 v[104:107], v22 offset:24576
    ds_read_b128 v[108:111], v22 offset:28672
    ds_read_b64_tr_b16 v[112:113], v25 offset:18432
    ds_read_b64_tr_b16 v[114:115], v25 offset:18944
    v_mfma_f32_32x32x16_bf16 v[32:47], v[132:135], v[116:119], v[32:47]
    v_mfma_f32_32x32x16_bf16 v[48:63], v[132:135], v[120:123], v[48:63]
    v_mfma_f32_32x32x16_bf16 v[64:79], v[132:135], v[124:127], v[64:79]
    v_mfma_f32_32x32x16_bf16 v[80:95], v[132:135], v[128:131], v[80:95]
    s_waitcnt lgkmcnt(0)
    s_barrier
    v_mfma_f32_32x32x16_bf16 v[32:47], v[152:155], v[136:139], v[32:47]
    ds_read_b128 v[116:119], v23 offset:16384
    ds_read_b128 v[120:123], v23 offset:20480
    ds_read_b64_tr_b16 v[132:133], v25 offset:24576
    v_mfma_f32_32x32x16_bf16 v[48:63], v[152:155], v[140:143], v[48:63]
    ds_read_b128 v[124:127], v23 offset:24576
    ds_read_b128 v[128:131], v23 offset:28672
    ds_read_b64_tr_b16 v[134:135], v25 offset:25088
    v_mfma_f32_32x32x16_bf16 v[64:79], v[152:155], v[144:147], v[64:79]
    ds_read_b128 v[136:139], v24 offset:16384
    ds_read_b128 v[140:143], v24 offset:20480
    v_mfma_f32_32x32x16_bf16 v[80:95], v[152:155], v[148:151], v[80:95]
    ds_read_b128 v[144:147], v24 offset:24576
    ds_read_b128 v[148:151], v24 offset:28672
    ds_read_b64_tr_b16 v[152:153], v25 offset:26624
    ds_read_b64_tr_b16 v[154:155], v25 offset:27136
    v_mfma_f32_32x32x16_bf16 v[32:47], v[112:115], v[96:99], v[32:47]
    v_mfma_f32_32x32x16_bf16 v[48:63], v[112:115], v[100:103], v[48:63]
    v_mfma_f32_32x32x16_bf16 v[64:79], v[112:115], v[104:107], v[64:79]
    v_mfma_f32_32x32x16_bf16 v[80:95], v[112:115], v[108:111], v[80:95]
    s_waitcnt lgkmcnt(0)
    s_barrier
    v_mfma_f32_32x32x16_bf16 v[32:47], v[132:135], v[116:119], v[32:47]
    ds_read_b128 v[96:99], v21 offset:32768
    ds_read_b128 v[100:103], v21 offset:36864
    ds_read_b64_tr_b16 v[112:113], v25 offset:0
    v_mfma_f32_32x32x16_bf16 v[48:63], v[132:135], v[120:123], v[48:63]
    ds_read_b128 v[104:107], v21 offset:40960
    ds_read_b128 v[108:111], v21 offset:45056
    ds_read_b64_tr_b16 v[114:115], v25 offset:512
    v_mfma_f32_32x32x16_bf16 v[64:79], v[132:135], v[124:127], v[64:79]
    ds_read_b128 v[116:119], v22 offset:32768
    ds_read_b128 v[120:123], v22 offset:36864
    v_mfma_f32_32x32x16_bf16 v[80:95], v[132:135], v[128:131], v[80:95]
    ds_read_b128 v[124:127], v22 offset:40960
    ds_read_b128 v[128:131], v22 offset:45056
    ds_read_b64_tr_b16 v[132:133], v25 offset:2048
    ds_read_b64_tr_b16 v[134:135], v25 offset:2560
    v_mfma_f32_32x32x16_bf16 v[32:47], v[152:155], v[136:139], v[32:47]
    v_mfma_f32_32x32x16_bf16 v[48:63], v[152:155], v[140:143], v[48:63]
    v_mfma_f32_32x32x16_bf16 v[64:79], v[152:155], v[144:147], v[64:79]
    v_mfma_f32_32x32x16_bf16 v[80:95], v[152:155], v[148:151], v[80:95]
    s_waitcnt lgkmcnt(0)
    s_barrier
    v_mfma_f32_32x32x16_bf16 v[32:47], v[112:115], v[96:99], v[32:47]
    ds_read_b128 v[136:139], v23 offset:32768
    ds_read_b128 v[140:143], v23 offset:36864
    ds_read_b64_tr_b16 v[152:153], v25 offset:8192
    v_mfma_f32_32x32x16_bf16 v[48:63], v[112:115], v[100:103], v[48:63]
    ds_read_b128 v[144:147], v23 offset:40960
    ds_read_b128 v[148:151], v23 offset:45056
    ds_read_b64_tr_b16 v[154:155], v25 offset:8704
    v_mfma_f32_32x32x16_bf16 v[64:79], v[112:115], v[104:107], v[64:79]
    ds_read_b128 v[96:99], v24 offset:32768
    ds_read_b128 v[100:103], v24 offset:36864
    v_mfma_f32_32x32x16_bf16 v[80:95], v[112:115], v[108:111], v[80:95]
    ds_read_b128 v[104:107], v24 offset:40960
    ds_read_b128 v[108:111], v24 offset:45056
    ds_read_b64_tr_b16 v[112:113], v25 offset:10240
    ds_read_b64_tr_b16 v[114:115], v25 offset:10752
    v_mfma_f32_32x32x16_bf16 v[32:47], v[132:135], v[116:119], v[32:47]
    v_mfma_f32_32x32x16_bf16 v[48:63], v[132:135], v[120:123], v[48:63]
    v_mfma_f32_32x32x16_bf16 v[64:79], v[132:135], v[124:127], v[64:79]
    v_mfma_f32_32x32x16_bf16 v[80:95], v[132:135], v[128:131], v[80:95]
    s_waitcnt lgkmcnt(0)
    s_barrier
    v_mfma_f32_32x32x16_bf16 v[32:47], v[152:155], v[136:139], v[32:47]
    ds_read_b128 v[116:119], v21 offset:49152
    ds_read_b128 v[120:123], v21 offset:53248
    ds_read_b64_tr_b16 v[132:133], v25 offset:16384
    v_mfma_f32_32x32x16_bf16 v[48:63], v[152:155], v[140:143], v[48:63]
    ds_read_b128 v[124:127], v21 offset:57344
    ds_read_b128 v[128:131], v21 offset:61440
    ds_read_b64_tr_b16 v[134:135], v25 offset:16896
    v_mfma_f32_32x32x16_bf16 v[64:79], v[152:155], v[144:147], v[64:79]
    ds_read_b128 v[136:139], v22 offset:49152
    ds_read_b128 v[140:143], v22 offset:53248
    v_mfma_f32_32x32x16_bf16 v[80:95], v[152:155], v[148:151], v[80:95]
    ds_read_b128 v[144:147], v22 offset:57344
    ds_read_b128 v[148:151], v22 offset:61440
    ds_read_b64_tr_b16 v[152:153], v25 offset:18432
    ds_read_b64_tr_b16 v[154:155], v25 offset:18944
    v_mfma_f32_32x32x16_bf16 v[32:47], v[112:115], v[96:99], v[32:47]
    v_mfma_f32_32x32x16_bf16 v[48:63], v[112:115], v[100:103], v[48:63]
    v_mfma_f32_32x32x16_bf16 v[64:79], v[112:115], v[104:107], v[64:79]
    v_mfma_f32_32x32x16_bf16 v[80:95], v[112:115], v[108:111], v[80:95]
    s_waitcnt lgkmcnt(0)
    s_barrier
    v_mfma_f32_32x32x16_bf16 v[32:47], v[132:135], v[116:119], v[32:47]
    ds_read_b128 v[96:99], v23 offset:49152
    ds_read_b128 v[100:103], v23 offset:53248
    ds_read_b64_tr_b16 v[112:113], v25 offset:24576
    v_mfma_f32_32x32x16_bf16 v[48:63], v[132:135], v[120:123], v[48:63]
    ds_read_b128 v[104:107], v23 offset:57344
    ds_read_b128 v[108:111], v23 offset:61440
    ds_read_b64_tr_b16 v[114:115], v25 offset:25088
    v_mfma_f32_32x32x16_bf16 v[64:79], v[132:135], v[124:127], v[64:79]
    ds_read_b128 v[116:119], v24 offset:49152
    ds_read_b128 v[120:123], v24 offset:53248
    v_mfma_f32_32x32x16_bf16 v[80:95], v[132:135], v[128:131], v[80:95]
    ds_read_b128 v[124:127], v24 offset:57344
    ds_read_b128 v[128:131], v24 offset:61440
    ds_read_b64_tr_b16 v[132:133], v25 offset:26624
    ds_read_b64_tr_b16 v[134:135], v25 offset:27136
    v_mfma_f32_32x32x16_bf16 v[32:47], v[152:155], v[136:139], v[32:47]
    v_mfma_f32_32x32x16_bf16 v[48:63], v[152:155], v[140:143], v[48:63]
    v_mfma_f32_32x32x16_bf16 v[64:79], v[152:155], v[144:147], v[64:79]
    v_mfma_f32_32x32x16_bf16 v[80:95], v[152:155], v[148:151], v[80:95]
    s_waitcnt lgkmcnt(0)
    s_load_dword s15, s[34:35], 0
    s_barrier
    v_mfma_f32_32x32x16_bf16 v[32:47], v[112:115], v[96:99], v[32:47]
    v_mfma_f32_32x32x16_bf16 v[32:47], v[132:135], v[116:119], v[32:47]
    v_mfma_f32_32x32x16_bf16 v[48:63], v[112:115], v[100:103], v[48:63]
    v_mfma_f32_32x32x16_bf16 v[48:63], v[132:135], v[120:123], v[48:63]
    v_mfma_f32_32x32x16_bf16 v[64:79], v[112:115], v[104:107], v[64:79]
    v_mfma_f32_32x32x16_bf16 v[64:79], v[132:135], v[124:127], v[64:79]
    v_mfma_f32_32x32x16_bf16 v[80:95], v[112:115], v[108:111], v[80:95]
    v_mfma_f32_32x32x16_bf16 v[80:95], v[132:135], v[128:131], v[80:95]
    s_nop 5
    v_cvt_pk_bf16_f32 v32, v32, v33
    v_cvt_pk_bf16_f32 v33, v34, v35
    v_cvt_pk_bf16_f32 v34, v36, v37
    v_cvt_pk_bf16_f32 v35, v38, v39
    v_cvt_pk_bf16_f32 v36, v40, v41
    v_cvt_pk_bf16_f32 v37, v42, v43
    v_cvt_pk_bf16_f32 v38, v44, v45
    v_cvt_pk_bf16_f32 v39, v46, v47
    v_pk_max_i16 v32, v32, 0
    v_pk_max_i16 v33, v33, 0
    v_pk_max_i16 v34, v34, 0
    v_pk_max_i16 v35, v35, 0
    v_pk_max_i16 v36, v36, 0
    v_pk_max_i16 v37, v37, 0
    v_pk_max_i16 v38, v38, 0
    v_pk_max_i16 v39, v39, 0
    buffer_store_dwordx4 v[32:35], v6, s[56:59], s26 offen offset:0 sc1
    buffer_store_dwordx4 v[36:39], v6, s[56:59], s26 offen offset:1024 sc1
    s_add_u32 s26, s26, 147456
    v_cvt_pk_bf16_f32 v48, v48, v49
    v_cvt_pk_bf16_f32 v49, v50, v51
    v_cvt_pk_bf16_f32 v50, v52, v53
    v_cvt_pk_bf16_f32 v51, v54, v55
    v_cvt_pk_bf16_f32 v52, v56, v57
    v_cvt_pk_bf16_f32 v53, v58, v59
    v_cvt_pk_bf16_f32 v54, v60, v61
    v_cvt_pk_bf16_f32 v55, v62, v63
    v_pk_max_i16 v48, v48, 0
    v_pk_max_i16 v49, v49, 0
    v_pk_max_i16 v50, v50, 0
    v_pk_max_i16 v51, v51, 0
    v_pk_max_i16 v52, v52, 0
    v_pk_max_i16 v53, v53, 0
    v_pk_max_i16 v54, v54, 0
    v_pk_max_i16 v55, v55, 0
    buffer_store_dwordx4 v[48:51], v6, s[56:59], s26 offen offset:0 sc1
    buffer_store_dwordx4 v[52:55], v6, s[56:59], s26 offen offset:1024 sc1
    s_add_u32 s26, s26, 147456
    v_cvt_pk_bf16_f32 v64, v64, v65
    v_cvt_pk_bf16_f32 v65, v66, v67
    v_cvt_pk_bf16_f32 v66, v68, v69
    v_cvt_pk_bf16_f32 v67, v70, v71
    v_cvt_pk_bf16_f32 v68, v72, v73
    v_cvt_pk_bf16_f32 v69, v74, v75
    v_cvt_pk_bf16_f32 v70, v76, v77
    v_cvt_pk_bf16_f32 v71, v78, v79
    v_pk_max_i16 v64, v64, 0
    v_pk_max_i16 v65, v65, 0
    v_pk_max_i16 v66, v66, 0
    v_pk_max_i16 v67, v67, 0
    v_pk_max_i16 v68, v68, 0
    v_pk_max_i16 v69, v69, 0
    v_pk_max_i16 v70, v70, 0
    v_pk_max_i16 v71, v71, 0
    buffer_store_dwordx4 v[64:67], v6, s[56:59], s26 offen offset:0 sc1
    buffer_store_dwordx4 v[68:71], v6, s[56:59], s26 offen offset:1024 sc1
    s_add_u32 s26, s26, 147456
    v_cvt_pk_bf16_f32 v80, v80, v81
    v_cvt_pk_bf16_f32 v81, v82, v83
    v_cvt_pk_bf16_f32 v82, v84, v85
    v_cvt_pk_bf16_f32 v83, v86, v87
    v_cvt_pk_bf16_f32 v84, v88, v89
    v_cvt_pk_bf16_f32 v85, v90, v91
    v_cvt_pk_bf16_f32 v86, v92, v93
    v_cvt_pk_bf16_f32 v87, v94, v95
    s_barrier
    v_pk_max_i16 v80, v80, 0
    v_pk_max_i16 v81, v81, 0
    v_pk_max_i16 v82, v82, 0
    v_pk_max_i16 v83, v83, 0
    v_pk_max_i16 v84, v84, 0
    v_pk_max_i16 v85, v85, 0
    v_pk_max_i16 v86, v86, 0
    v_pk_max_i16 v87, v87, 0
    buffer_store_dwordx4 v[80:83], v6, s[56:59], s26 offen offset:0 sc1
    buffer_store_dwordx4 v[84:87], v6, s[56:59], s26 offen offset:1024 sc1
    s_waitcnt lgkmcnt(0)
    s_cmp_lg_u32 s15, 0
    s_cbranch_scc1 L_nok_108
    s_mov_b32 s100, 0
L_nlp_109:
    s_sleep 16
    v_mov_b32 v17, 0
    global_load_dword v17, v17, s[34:35] sc1
    s_waitcnt vmcnt(0)
    s_nop 0
    v_readfirstlane_b32 s15, v17
    s_add_u32 s100, s100, 1
    s_cmp_ge_u32 s100, 20000
    s_cbranch_scc1 L_nok_108
    s_cmp_eq_u32 s15, 0
    s_cbranch_scc1 L_nlp_109
L_nok_108:
    v_mov_b32 v17, s15
    s_barrier
    s_getreg_b32 s11, hwreg(HW_REG_IB_STS, 0, 4)
    s_getreg_b32 s12, hwreg(HW_REG_IB_STS, 22, 2)
    s_or_b32 s11, s11, s29
    s_lshl4_add_u32 s11, s12, s11
    s_cmp_gt_u32 s11, 0
    s_cbranch_scc1 L_fl_110
    s_waitcnt vmcnt(0)
    s_mov_b64 exec, 1
    buffer_store_dword v17, off, s[56:59], s25 sc1
    s_mov_b64 exec, -1
    s_movk_i32 s29, 0x100
L_fl_110:
    s_barrier
    s_getreg_b32 s11, hwreg(HW_REG_IB_STS, 0, 4)
    s_getreg_b32 s12, hwreg(HW_REG_IB_STS, 22, 2)
    s_or_b32 s11, s11, s29
    s_lshl4_add_u32 s11, s12, s11
    s_cmp_gt_u32 s11, 0
    s_cbranch_scc1 L_fl_111
    s_waitcnt vmcnt(0)
    s_mov_b64 exec, 1
    buffer_store_dword v17, off, s[56:59], s25 sc1
    s_mov_b64 exec, -1
    s_movk_i32 s29, 0x100
L_fl_111:
    s_barrier
    s_getreg_b32 s11, hwreg(HW_REG_IB_STS, 0, 4)
    s_getreg_b32 s12, hwreg(HW_REG_IB_STS, 22, 2)
    s_or_b32 s11, s11, s29
    s_lshl4_add_u32 s11, s12, s11
    s_cmp_gt_u32 s11, 0
    s_cbranch_scc1 L_fl_112
    s_waitcnt vmcnt(0)
    s_mov_b64 exec, 1
    buffer_store_dword v17, off, s[56:59], s25 sc1
    s_mov_b64 exec, -1
    s_movk_i32 s29, 0x100
L_fl_112:
    s_barrier
    s_getreg_b32 s11, hwreg(HW_REG_IB_STS, 0, 4)
    s_getreg_b32 s12, hwreg(HW_REG_IB_STS, 22, 2)
    s_or_b32 s11, s11, s29
    s_lshl4_add_u32 s11, s12, s11
    s_cmp_gt_u32 s11, 0
    s_cbranch_scc1 L_fl_113
    s_waitcnt vmcnt(0)
    s_mov_b64 exec, 1
    buffer_store_dword v17, off, s[56:59], s25 sc1
    s_mov_b64 exec, -1
    s_movk_i32 s29, 0x100
L_fl_113:
    s_barrier
    s_getreg_b32 s11, hwreg(HW_REG_IB_STS, 0, 4)
    s_getreg_b32 s12, hwreg(HW_REG_IB_STS, 22, 2)
    s_or_b32 s11, s11, s29
    s_lshl4_add_u32 s11, s12, s11
    s_cmp_gt_u32 s11, 0
    s_cbranch_scc1 L_fl_114
    s_waitcnt vmcnt(0)
    s_mov_b64 exec, 1
    buffer_store_dword v17, off, s[56:59], s25 sc1
    s_mov_b64 exec, -1
    s_movk_i32 s29, 0x100
L_fl_114:
    s_barrier
    s_getreg_b32 s11, hwreg(HW_REG_IB_STS, 0, 4)
    s_getreg_b32 s12, hwreg(HW_REG_IB_STS, 22, 2)
    s_or_b32 s11, s11, s29
    s_lshl4_add_u32 s11, s12, s11
    s_cmp_gt_u32 s11, 0
    s_cbranch_scc1 L_fl_115
    s_waitcnt vmcnt(0)
    s_mov_b64 exec, 1
    buffer_store_dword v17, off, s[56:59], s25 sc1
    s_mov_b64 exec, -1
    s_movk_i32 s29, 0x100
L_fl_115:
    s_barrier
    s_getreg_b32 s11, hwreg(HW_REG_IB_STS, 0, 4)
    s_getreg_b32 s12, hwreg(HW_REG_IB_STS, 22, 2)
    s_or_b32 s11, s11, s29
    s_lshl4_add_u32 s11, s12, s11
    s_cmp_gt_u32 s11, 0
    s_cbranch_scc1 L_fl_116
    s_waitcnt vmcnt(0)
    s_mov_b64 exec, 1
    buffer_store_dword v17, off, s[56:59], s25 sc1
    s_mov_b64 exec, -1
    s_movk_i32 s29, 0x100
L_fl_116:
    s_barrier
    s_waitcnt vmcnt(0)
    s_cmp_lg_u32 s29, 0
    s_cbranch_scc1 L_fl_117
    s_waitcnt vmcnt(0)
    s_mov_b64 exec, 1
    buffer_store_dword v17, off, s[56:59], s25 sc1
    s_mov_b64 exec, -1
    s_movk_i32 s29, 0x100
L_fl_117:
    s_lshl_b32 s12, s10, 2
    s_add_u32 s12, s12, 24608
    v_mov_b32 v8, s12
    v_lshlrev_b32 v9, 2, v0
    v_add_u32 v9, 25600, v9
    v_cmp_eq_u32 vcc, 0, v0
    v_mov_b32 v16, 24576
    s_mov_b32 s95, 0
    v_cndmask_b32 v7, v9, v8, vcc
    s_cmp_ge_u32 s95, 1
    s_cbranch_scc1 L_cs_119
    s_mov_b32 s100, 0
L_cl_118:
    ds_read_b128 v[12:15], v16 offset:0
    s_add_u32 s100, s100, 1
    s_waitcnt lgkmcnt(0)
    v_min3_u32 v12, v12, v13, v14
    v_min_u32 v12, v12, v15
    s_nop 0
    v_readfirstlane_b32 s95, v12
    s_cmp_ge_u32 s100, 0x40000
    s_cbranch_scc1 L_cs_119
    s_cmp_lt_u32 s95, 1
    s_cbranch_scc1 L_cl_118
L_cs_119:
    ds_read_b128 v[96:99], v26 offset:24576
    ds_read_b64_tr_b16 v[100:101], v28 offset:16384
    ds_read_b64_tr_b16 v[102:103], v28 offset:16896
    ds_read_b128 v[104:107], v26 offset:25600
    ds_read_b64_tr_b16 v[108:109], v28 offset:18432
    ds_read_b64_tr_b16 v[110:111], v28 offset:18944
    s_waitcnt lgkmcnt(3)
    v_mfma_f32_32x32x16_bf16 v[32:47], v[100:103], v[96:99], 0
    ds_read_b128 v[112:115], v26 offset:26624
    ds_read_b64_tr_b16 v[116:117], v28 offset:20480
    ds_read_b64_tr_b16 v[118:119], v28 offset:20992
    ds_read_b128 v[120:123], v26 offset:27648
    ds_read_b64_tr_b16 v[124:125], v28 offset:22528
    ds_read_b64_tr_b16 v[126:127], v28 offset:23040
    s_waitcnt lgkmcnt(6)
    v_mfma_f32_32x32x16_bf16 v[32:47], v[108:111], v[104:107], v[32:47]
    ds_read_b128 v[128:131], v29 offset:0
    ds_read_b64_tr_b16 v[132:133], v28 offset:32768
    ds_read_b64_tr_b16 v[134:135], v28 offset:33280
    ds_read_b128 v[136:139], v29 offset:1024
    ds_read_b64_tr_b16 v[140:141], v28 offset:34816
    ds_read_b64_tr_b16 v[142:143], v28 offset:35328
    s_waitcnt lgkmcnt(9)
    v_mfma_f32_32x32x16_bf16 v[32:47], v[116:119], v[112:115], v[32:47]
    ds_read_b128 v[144:147], v29 offset:2048
    ds_read_b64_tr_b16 v[148:149], v28 offset:36864
    ds_read_b64_tr_b16 v[150:151], v28 offset:37376
    ds_read_b128 v[152:155], v29 offset:3072
    ds_read_b64_tr_b16 v[156:157], v28 offset:38912
    ds_read_b64_tr_b16 v[158:159], v28 offset:39424
    s_waitcnt lgkmcnt(12)
    v_mfma_f32_32x32x16_bf16 v[32:47], v[124:127], v[120:123], v[32:47]
    ds_read_b128 v[96:99], v26 offset:32768
    ds_read_b64_tr_b16 v[100:101], v28 offset:40960
    ds_read_b64_tr_b16 v[102:103], v28 offset:41472
    s_waitcnt lgkmcnt(12)
    v_mfma_f32_32x32x16_bf16 v[32:47], v[132:135], v[128:131], v[32:47]
    ds_read_b128 v[104:107], v26 offset:33792
    ds_read_b64_tr_b16 v[108:109], v28 offset:43008
    ds_read_b64_tr_b16 v[110:111], v28 offset:43520
    s_waitcnt lgkmcnt(12)
    v_mfma_f32_32x32x16_bf16 v[32:47], v[140:143], v[136:139], v[32:47]
    ds_read_b128 v[112:115], v26 offset:34816
    ds_read_b64_tr_b16 v[116:117], v28 offset:45056
    ds_read_b64_tr_b16 v[118:119], v28 offset:45568
    s_waitcnt lgkmcnt(12)
    v_mfma_f32_32x32x16_bf16 v[32:47], v[148:151], v[144:147], v[32:47]
    ds_read_b128 v[120:123], v26 offset:35840
    ds_read_b64_tr_b16 v[124:125], v28 offset:47104
    ds_read_b64_tr_b16 v[126:127], v28 offset:47616
    s_waitcnt lgkmcnt(12)
    v_mfma_f32_32x32x16_bf16 v[32:47], v[156:159], v[152:155], v[32:47]
    s_waitcnt lgkmcnt(9)
    v_mfma_f32_32x32x16_bf16 v[32:47], v[100:103], v[96:99], v[32:47]
    s_waitcnt lgkmcnt(6)
    v_mfma_f32_32x32x16_bf16 v[32:47], v[108:111], v[104:107], v[32:47]
    ds_read_b128 v[12:15], v16 offset:0
    s_waitcnt lgkmcnt(0)
    v_mov_b32 v11, 1
    ds_write_b32 v7, v11 offset:0
    v_min3_u32 v12, v12, v13, v14
    v_min_u32 v12, v12, v15
    s_nop 0
    v_readfirstlane_b32 s95, v12
    s_nop 0
    s_cmp_ge_u32 s95, 2
    s_cbranch_scc1 L_cs_121
    s_mov_b32 s100, 0
L_cl_120:
    ds_read_b128 v[12:15], v16 offset:0
    s_add_u32 s100, s100, 1
    s_waitcnt lgkmcnt(0)
    v_min3_u32 v12, v12, v13, v14
    v_min_u32 v12, v12, v15
    s_nop 0
    v_readfirstlane_b32 s95, v12
    s_cmp_ge_u32 s100, 0x40000
    s_cbranch_scc1 L_cs_121
    s_cmp_lt_u32 s95, 2
    s_cbranch_scc1 L_cl_120
L_cs_121:
    v_mfma_f32_32x32x16_bf16 v[32:47], v[116:119], v[112:115], v[32:47]
    ds_read_b128 v[128:131], v26 offset:40960
    ds_read_b64_tr_b16 v[132:133], v28 offset:49152
    ds_read_b64_tr_b16 v[134:135], v28 offset:49664
    ds_read_b128 v[136:139], v26 offset:41984
    ds_read_b64_tr_b16 v[140:141], v28 offset:51200
    ds_read_b64_tr_b16 v[142:143], v28 offset:51712
    v_mfma_f32_32x32x16_bf16 v[32:47], v[124:127], v[120:123], v[32:47]
    ds_read_b128 v[144:147], v26 offset:43008
    ds_read_b64_tr_b16 v[148:149], v28 offset:53248
    ds_read_b64_tr_b16 v[150:151], v28 offset:53760
    ds_read_b128 v[152:155], v26 offset:44032
    ds_read_b64_tr_b16 v[156:157], v28 offset:55296
    ds_read_b64_tr_b16 v[158:159], v28 offset:55808
    s_waitcnt lgkmcnt(9)
    v_mfma_f32_32x32x16_bf16 v[32:47], v[132:135], v[128:131], v[32:47]
    ds_read_b128 v[96:99], v29 offset:8192
    ds_read_b64_tr_b16 v[100:101], v28 offset:57344
    ds_read_b64_tr_b16 v[102:103], v28 offset:57856
    ds_read_b128 v[104:107], v29 offset:9216
    ds_read_b64_tr_b16 v[108:109], v28 offset:59392
    ds_read_b64_tr_b16 v[110:111], v28 offset:59904
    s_waitcnt lgkmcnt(12)
    v_mfma_f32_32x32x16_bf16 v[32:47], v[140:143], v[136:139], v[32:47]
    ds_read_b128 v[112:115], v29 offset:10240
    ds_read_b64_tr_b16 v[116:117], v28 offset:61440
    ds_read_b64_tr_b16 v[118:119], v28 offset:61952
    s_waitcnt lgkmcnt(12)
    v_mfma_f32_32x32x16_bf16 v[32:47], v[148:151], v[144:147], v[32:47]
    ds_read_b128 v[120:123], v29 offset:11264
    ds_read_b64_tr_b16 v[124:125], v28 offset:63488
    ds_read_b64_tr_b16 v[126:127], v28 offset:64000
    s_waitcnt lgkmcnt(12)
    v_mfma_f32_32x32x16_bf16 v[32:47], v[156:159], v[152:155], v[32:47]
    ds_read_b128 v[128:131], v26 offset:49152
    ds_read_b64_tr_b16 v[132:133], v1 offset:24576
    ds_read_b64_tr_b16 v[134:135], v1 offset:25088
    s_waitcnt lgkmcnt(12)
    v_mfma_f32_32x32x16_bf16 v[32:47], v[100:103], v[96:99], v[32:47]
    ds_read_b128 v[136:139], v26 offset:50176
    ds_read_b64_tr_b16 v[140:141], v1 offset:26624
    ds_read_b64_tr_b16 v[142:143], v1 offset:27136
    s_waitcnt lgkmcnt(12)
    v_mfma_f32_32x32x16_bf16 v[32:47], v[108:111], v[104:107], v[32:47]
    ds_read_b128 v[144:147], v26 offset:51200
    ds_read_b64_tr_b16 v[148:149], v1 offset:28672
    ds_read_b64_tr_b16 v[150:151], v1 offset:29184
    s_waitcnt lgkmcnt(12)
    v_mfma_f32_32x32x16_bf16 v[32:47], v[116:119], v[112:115], v[32:47]
    ds_read_b128 v[152:155], v26 offset:52224
    ds_read_b64_tr_b16 v[156:157], v1 offset:30720
    ds_read_b64_tr_b16 v[158:159], v1 offset:31232
    s_waitcnt lgkmcnt(12)
    v_mfma_f32_32x32x16_bf16 v[32:47], v[124:127], v[120:123], v[32:47]
    s_waitcnt lgkmcnt(9)
    v_mfma_f32_32x32x16_bf16 v[32:47], v[132:135], v[128:131], v[32:47]
    s_waitcnt lgkmcnt(6)
    v_mfma_f32_32x32x16_bf16 v[32:47], v[140:143], v[136:139], v[32:47]
    ds_read_b128 v[12:15], v16 offset:0
    s_waitcnt lgkmcnt(0)
    v_mov_b32 v11, 2
    ds_write_b32 v7, v11 offset:0
    v_min3_u32 v12, v12, v13, v14
    v_min_u32 v12, v12, v15
    s_nop 0
    v_readfirstlane_b32 s95, v12
    s_nop 0
    s_cmp_ge_u32 s95, 3
    s_cbranch_scc1 L_cs_123
    s_mov_b32 s100, 0
L_cl_122:
    ds_read_b128 v[12:15], v16 offset:0
    s_add_u32 s100, s100, 1
    s_waitcnt lgkmcnt(0)
    v_min3_u32 v12, v12, v13, v14
    v_min_u32 v12, v12, v15
    s_nop 0
    v_readfirstlane_b32 s95, v12
    s_cmp_ge_u32 s100, 0x40000
    s_cbranch_scc1 L_cs_123
    s_cmp_lt_u32 s95, 3
    s_cbranch_scc1 L_cl_122
L_cs_123:
    v_mfma_f32_32x32x16_bf16 v[32:47], v[148:151], v[144:147], v[32:47]
    ds_read_b128 v[96:99], v26 offset:57344
    ds_read_b64_tr_b16 v[100:101], v20 offset:0
    ds_read_b64_tr_b16 v[102:103], v20 offset:512
    ds_read_b128 v[104:107], v26 offset:58368
    ds_read_b64_tr_b16 v[108:109], v20 offset:2048
    ds_read_b64_tr_b16 v[110:111], v20 offset:2560
    v_mfma_f32_32x32x16_bf16 v[32:47], v[156:159], v[152:155], v[32:47]
    ds_read_b128 v[112:115], v26 offset:59392
    ds_read_b64_tr_b16 v[116:117], v20 offset:4096
    ds_read_b64_tr_b16 v[118:119], v20 offset:4608
    ds_read_b128 v[120:123], v26 offset:60416
    ds_read_b64_tr_b16 v[124:125], v20 offset:6144
    ds_read_b64_tr_b16 v[126:127], v20 offset:6656
    s_waitcnt lgkmcnt(9)
    v_mfma_f32_32x32x16_bf16 v[32:47], v[100:103], v[96:99], v[32:47]
    ds_read_b128 v[128:131], v27 offset:8192
    ds_read_b64_tr_b16 v[132:133], v20 offset:8192
    ds_read_b64_tr_b16 v[134:135], v20 offset:8704
    ds_read_b128 v[136:139], v27 offset:9216
    ds_read_b64_tr_b16 v[140:141], v20 offset:10240
    ds_read_b64_tr_b16 v[142:143], v20 offset:10752
    s_waitcnt lgkmcnt(12)
    v_mfma_f32_32x32x16_bf16 v[32:47], v[108:111], v[104:107], v[32:47]
    ds_read_b128 v[144:147], v27 offset:10240
    ds_read_b64_tr_b16 v[148:149], v20 offset:12288
    ds_read_b64_tr_b16 v[150:151], v20 offset:12800
    s_waitcnt lgkmcnt(12)
    v_mfma_f32_32x32x16_bf16 v[32:47], v[116:119], v[112:115], v[32:47]
    ds_read_b128 v[152:155], v27 offset:11264
    ds_read_b64_tr_b16 v[156:157], v20 offset:14336
    ds_read_b64_tr_b16 v[158:159], v20 offset:14848
    s_waitcnt lgkmcnt(12)
    v_mfma_f32_32x32x16_bf16 v[32:47], v[124:127], v[120:123], v[32:47]
    ds_read_b128 v[96:99], v26 offset:24576
    ds_read_b64_tr_b16 v[100:101], v1 offset:0
    ds_read_b64_tr_b16 v[102:103], v1 offset:512
    s_waitcnt lgkmcnt(12)
    v_mfma_f32_32x32x16_bf16 v[32:47], v[132:135], v[128:131], v[32:47]
    ds_read_b128 v[104:107], v26 offset:25600
    ds_read_b64_tr_b16 v[108:109], v1 offset:2048
    ds_read_b64_tr_b16 v[110:111], v1 offset:2560
    s_waitcnt lgkmcnt(12)
    v_mfma_f32_32x32x16_bf16 v[32:47], v[140:143], v[136:139], v[32:47]
    ds_read_b128 v[112:115], v26 offset:26624
    ds_read_b64_tr_b16 v[116:117], v1 offset:4096
    ds_read_b64_tr_b16 v[118:119], v1 offset:4608
    s_waitcnt lgkmcnt(12)
    v_mfma_f32_32x32x16_bf16 v[32:47], v[148:151], v[144:147], v[32:47]
    ds_read_b128 v[120:123], v26 offset:27648
    ds_read_b64_tr_b16 v[124:125], v1 offset:6144
    ds_read_b64_tr_b16 v[126:127], v1 offset:6656
    s_waitcnt lgkmcnt(12)
    v_mfma_f32_32x32x16_bf16 v[32:47], v[156:159], v[152:155], v[32:47]
    s_waitcnt lgkmcnt(9)
    v_mfma_f32_32x32x16_bf16 v[32:47], v[100:103], v[96:99], v[32:47]
    s_waitcnt lgkmcnt(6)
    v_mfma_f32_32x32x16_bf16 v[32:47], v[108:111], v[104:107], v[32:47]
    ds_read_b128 v[12:15], v16 offset:0
    s_waitcnt lgkmcnt(0)
    v_mov_b32 v11, 3
    ds_write_b32 v7, v11 offset:0
    v_min3_u32 v12, v12, v13, v14
    v_min_u32 v12, v12, v15
    s_nop 0
    v_readfirstlane_b32 s95, v12
    s_nop 0
    s_cmp_ge_u32 s95, 4
    s_cbranch_scc1 L_cs_125
    s_mov_b32 s100, 0
L_cl_124:
    ds_read_b128 v[12:15], v16 offset:0
    s_add_u32 s100, s100, 1
    s_waitcnt lgkmcnt(0)
    v_min3_u32 v12, v12, v13, v14
    v_min_u32 v12, v12, v15
    s_nop 0
    v_readfirstlane_b32 s95, v12
    s_cmp_ge_u32 s100, 0x40000
    s_cbranch_scc1 L_cs_125
    s_cmp_lt_u32 s95, 4
    s_cbranch_scc1 L_cl_124
L_cs_125:
    v_mfma_f32_32x32x16_bf16 v[32:47], v[116:119], v[112:115], v[32:47]
    ds_read_b128 v[128:131], v29 offset:16384
    ds_read_b64_tr_b16 v[132:133], v20 offset:16384
    ds_read_b64_tr_b16 v[134:135], v20 offset:16896
    ds_read_b128 v[136:139], v29 offset:17408
    ds_read_b64_tr_b16 v[140:141], v20 offset:18432
    ds_read_b64_tr_b16 v[142:143], v20 offset:18944
    v_mfma_f32_32x32x16_bf16 v[32:47], v[124:127], v[120:123], v[32:47]
    ds_read_b128 v[144:147], v29 offset:18432
    ds_read_b64_tr_b16 v[148:149], v20 offset:20480
    ds_read_b64_tr_b16 v[150:151], v20 offset:20992
    ds_read_b128 v[152:155], v29 offset:19456
    ds_read_b64_tr_b16 v[156:157], v20 offset:22528
    ds_read_b64_tr_b16 v[158:159], v20 offset:23040
    s_waitcnt lgkmcnt(9)
    v_mfma_f32_32x32x16_bf16 v[32:47], v[132:135], v[128:131], v[32:47]
    ds_read_b128 v[96:99], v29 offset:0
    ds_read_b64_tr_b16 v[100:101], v28 offset:32768
    ds_read_b64_tr_b16 v[102:103], v28 offset:33280
    ds_read_b128 v[104:107], v29 offset:1024
    ds_read_b64_tr_b16 v[108:109], v28 offset:34816
    ds_read_b64_tr_b16 v[110:111], v28 offset:35328
    s_waitcnt lgkmcnt(12)
    v_mfma_f32_32x32x16_bf16 v[32:47], v[140:143], v[136:139], v[32:47]
    ds_read_b128 v[112:115], v29 offset:2048
    ds_read_b64_tr_b16 v[116:117], v28 offset:36864
    ds_read_b64_tr_b16 v[118:119], v28 offset:37376
    s_waitcnt lgkmcnt(12)
    v_mfma_f32_32x32x16_bf16 v[32:47], v[148:151], v[144:147], v[32:47]
    ds_read_b128 v[120:123], v29 offset:3072
    ds_read_b64_tr_b16 v[124:125], v28 offset:38912
    ds_read_b64_tr_b16 v[126:127], v28 offset:39424
    s_waitcnt lgkmcnt(12)
    v_mfma_f32_32x32x16_bf16 v[32:47], v[156:159], v[152:155], v[32:47]
    ds_read_b128 v[128:131], v26 offset:40960
    ds_read_b64_tr_b16 v[132:133], v20 offset:32768
    ds_read_b64_tr_b16 v[134:135], v20 offset:33280
    s_waitcnt lgkmcnt(12)
    v_mfma_f32_32x32x16_bf16 v[32:47], v[100:103], v[96:99], v[32:47]
    ds_read_b128 v[136:139], v26 offset:41984
    ds_read_b64_tr_b16 v[140:141], v20 offset:34816
    ds_read_b64_tr_b16 v[142:143], v20 offset:35328
    s_waitcnt lgkmcnt(12)
    v_mfma_f32_32x32x16_bf16 v[32:47], v[108:111], v[104:107], v[32:47]
    ds_read_b128 v[144:147], v26 offset:43008
    ds_read_b64_tr_b16 v[148:149], v20 offset:36864
    ds_read_b64_tr_b16 v[150:151], v20 offset:37376
    s_waitcnt lgkmcnt(12)
    v_mfma_f32_32x32x16_bf16 v[32:47], v[116:119], v[112:115], v[32:47]
    ds_read_b128 v[152:155], v26 offset:44032
    ds_read_b64_tr_b16 v[156:157], v20 offset:38912
    ds_read_b64_tr_b16 v[158:159], v20 offset:39424
    s_waitcnt lgkmcnt(12)
    v_mfma_f32_32x32x16_bf16 v[32:47], v[124:127], v[120:123], v[32:47]
    s_waitcnt lgkmcnt(9)
    v_mfma_f32_32x32x16_bf16 v[32:47], v[132:135], v[128:131], v[32:47]
    s_waitcnt lgkmcnt(6)
    v_mfma_f32_32x32x16_bf16 v[32:47], v[140:143], v[136:139], v[32:47]
    s_waitcnt lgkmcnt(0)
    s_barrier
    v_mfma_f32_32x32x16_bf16 v[32:47], v[148:151], v[144:147], v[32:47]
    ds_read_b128 v[96:99], v29 offset:49152
    ds_read_b64_tr_b16 v[100:101], v28 offset:40960
    ds_read_b64_tr_b16 v[102:103], v28 offset:41472
    ds_read_b128 v[104:107], v29 offset:50176
    ds_read_b64_tr_b16 v[108:109], v28 offset:43008
    ds_read_b64_tr_b16 v[110:111], v28 offset:43520
    v_mfma_f32_32x32x16_bf16 v[32:47], v[156:159], v[152:155], v[32:47]
    ds_read_b128 v[112:115], v29 offset:51200
    ds_read_b64_tr_b16 v[116:117], v28 offset:45056
    ds_read_b64_tr_b16 v[118:119], v28 offset:45568
    ds_read_b128 v[120:123], v29 offset:52224
    ds_read_b64_tr_b16 v[124:125], v28 offset:47104
    ds_read_b64_tr_b16 v[126:127], v28 offset:47616
    s_waitcnt lgkmcnt(9)
    v_mfma_f32_32x32x16_bf16 v[32:47], v[100:103], v[96:99], v[32:47]
    ds_read_b128 v[128:131], v29 offset:8192
    ds_read_b64_tr_b16 v[132:133], v28 offset:57344
    ds_read_b64_tr_b16 v[134:135], v28 offset:57856
    ds_read_b128 v[136:139], v29 offset:9216
    ds_read_b64_tr_b16 v[140:141], v28 offset:59392
    ds_read_b64_tr_b16 v[142:143], v28 offset:59904
    s_waitcnt lgkmcnt(12)
    v_mfma_f32_32x32x16_bf16 v[32:47], v[108:111], v[104:107], v[32:47]
    ds_read_b128 v[144:147], v29 offset:10240
    ds_read_b64_tr_b16 v[148:149], v28 offset:61440
    ds_read_b64_tr_b16 v[150:151], v28 offset:61952
    s_waitcnt lgkmcnt(12)
    v_mfma_f32_32x32x16_bf16 v[32:47], v[116:119], v[112:115], v[32:47]
    ds_read_b128 v[152:155], v29 offset:11264
    ds_read_b64_tr_b16 v[156:157], v28 offset:63488
    ds_read_b64_tr_b16 v[158:159], v28 offset:64000
    s_waitcnt lgkmcnt(12)
    v_mfma_f32_32x32x16_bf16 v[32:47], v[124:127], v[120:123], v[32:47]
    ds_read_b128 v[96:99], v26 offset:57344
    ds_read_b64_tr_b16 v[100:101], v20 offset:49152
    ds_read_b64_tr_b16 v[102:103], v20 offset:49664
    s_waitcnt lgkmcnt(12)
    v_mfma_f32_32x32x16_bf16 v[32:47], v[132:135], v[128:131], v[32:47]
    ds_read_b128 v[104:107], v26 offset:58368
    ds_read_b64_tr_b16 v[108:109], v20 offset:51200
    ds_read_b64_tr_b16 v[110:111], v20 offset:51712
    s_waitcnt lgkmcnt(12)
    v_mfma_f32_32x32x16_bf16 v[32:47], v[140:143], v[136:139], v[32:47]
    ds_read_b128 v[112:115], v26 offset:59392
    ds_read_b64_tr_b16 v[116:117], v20 offset:53248
    ds_read_b64_tr_b16 v[118:119], v20 offset:53760
    s_waitcnt lgkmcnt(12)
    v_mfma_f32_32x32x16_bf16 v[32:47], v[148:151], v[144:147], v[32:47]
    ds_read_b128 v[120:123], v26 offset:60416
    ds_read_b64_tr_b16 v[124:125], v20 offset:55296
    ds_read_b64_tr_b16 v[126:127], v20 offset:55808
    s_waitcnt lgkmcnt(12)
    v_mfma_f32_32x32x16_bf16 v[32:47], v[156:159], v[152:155], v[32:47]
    s_waitcnt lgkmcnt(9)
    v_mfma_f32_32x32x16_bf16 v[32:47], v[100:103], v[96:99], v[32:47]
    s_waitcnt lgkmcnt(6)
    v_mfma_f32_32x32x16_bf16 v[32:47], v[108:111], v[104:107], v[32:47]
    s_waitcnt lgkmcnt(0)
    s_barrier
    v_mfma_f32_32x32x16_bf16 v[32:47], v[116:119], v[112:115], v[32:47]
    ds_read_b128 v[128:131], v26 offset:0
    ds_read_b64_tr_b16 v[132:133], v1 offset:24576
    ds_read_b64_tr_b16 v[134:135], v1 offset:25088
    ds_read_b128 v[136:139], v26 offset:1024
    ds_read_b64_tr_b16 v[140:141], v1 offset:26624
    ds_read_b64_tr_b16 v[142:143], v1 offset:27136
    v_mfma_f32_32x32x16_bf16 v[32:47], v[124:127], v[120:123], v[32:47]
    ds_read_b128 v[144:147], v26 offset:2048
    ds_read_b64_tr_b16 v[148:149], v1 offset:28672
    ds_read_b64_tr_b16 v[150:151], v1 offset:29184
    ds_read_b128 v[152:155], v26 offset:3072
    ds_read_b64_tr_b16 v[156:157], v1 offset:30720
    ds_read_b64_tr_b16 v[158:159], v1 offset:31232
    s_waitcnt lgkmcnt(9)
    v_mfma_f32_32x32x16_bf16 v[32:47], v[132:135], v[128:131], v[32:47]
    ds_read_b128 v[96:99], v27 offset:8192
    ds_read_b64_tr_b16 v[100:101], v20 offset:8192
    ds_read_b64_tr_b16 v[102:103], v20 offset:8704
    ds_read_b128 v[104:107], v27 offset:9216
    ds_read_b64_tr_b16 v[108:109], v20 offset:10240
    ds_read_b64_tr_b16 v[110:111], v20 offset:10752
    s_waitcnt lgkmcnt(12)
    v_mfma_f32_32x32x16_bf16 v[32:47], v[140:143], v[136:139], v[32:47]
    ds_read_b128 v[112:115], v27 offset:10240
    ds_read_b64_tr_b16 v[116:117], v20 offset:12288
    ds_read_b64_tr_b16 v[118:119], v20 offset:12800
    s_waitcnt lgkmcnt(12)
    v_mfma_f32_32x32x16_bf16 v[32:47], v[148:151], v[144:147], v[32:47]
    ds_read_b128 v[120:123], v27 offset:11264
    ds_read_b64_tr_b16 v[124:125], v20 offset:14336
    ds_read_b64_tr_b16 v[126:127], v20 offset:14848
    s_waitcnt lgkmcnt(12)
    v_mfma_f32_32x32x16_bf16 v[32:47], v[156:159], v[152:155], v[32:47]
    ds_read_b128 v[128:131], v29 offset:16384
    ds_read_b64_tr_b16 v[132:133], v20 offset:24576
    ds_read_b64_tr_b16 v[134:135], v20 offset:25088
    s_waitcnt lgkmcnt(12)
    v_mfma_f32_32x32x16_bf16 v[32:47], v[100:103], v[96:99], v[32:47]
    ds_read_b128 v[136:139], v29 offset:17408
    ds_read_b64_tr_b16 v[140:141], v20 offset:26624
    ds_read_b64_tr_b16 v[142:143], v20 offset:27136
    s_waitcnt lgkmcnt(12)
    v_mfma_f32_32x32x16_bf16 v[32:47], v[108:111], v[104:107], v[32:47]
    ds_read_b128 v[144:147], v29 offset:18432
    ds_read_b64_tr_b16 v[148:149], v20 offset:28672
    ds_read_b64_tr_b16 v[150:151], v20 offset:29184
    s_waitcnt lgkmcnt(12)
    v_mfma_f32_32x32x16_bf16 v[32:47], v[116:119], v[112:115], v[32:47]
    ds_read_b128 v[152:155], v29 offset:19456
    ds_read_b64_tr_b16 v[156:157], v20 offset:30720
    ds_read_b64_tr_b16 v[158:159], v20 offset:31232
    s_waitcnt lgkmcnt(12)
    v_mfma_f32_32x32x16_bf16 v[32:47], v[124:127], v[120:123], v[32:47]
    s_waitcnt lgkmcnt(9)
    v_mfma_f32_32x32x16_bf16 v[32:47], v[132:135], v[128:131], v[32:47]
    s_waitcnt lgkmcnt(6)
    v_mfma_f32_32x32x16_bf16 v[32:47], v[140:143], v[136:139], v[32:47]
    s_waitcnt lgkmcnt(0)
    s_barrier
    v_mfma_f32_32x32x16_bf16 v[32:47], v[148:151], v[144:147], v[32:47]
    ds_read_b128 v[96:99], v26 offset:16384
    ds_read_b64_tr_b16 v[100:101], v1 offset:0
    ds_read_b64_tr_b16 v[102:103], v1 offset:512
    ds_read_b128 v[104:107], v26 offset:17408
    ds_read_b64_tr_b16 v[108:109], v1 offset:2048
    ds_read_b64_tr_b16 v[110:111], v1 offset:2560
    v_mfma_f32_32x32x16_bf16 v[32:47], v[156:159], v[152:155], v[32:47]
    ds_read_b128 v[112:115], v26 offset:18432
    ds_read_b64_tr_b16 v[116:117], v1 offset:4096
    ds_read_b64_tr_b16 v[118:119], v1 offset:4608
    ds_read_b128 v[120:123], v26 offset:19456
    ds_read_b64_tr_b16 v[124:125], v1 offset:6144
    ds_read_b64_tr_b16 v[126:127], v1 offset:6656
    s_waitcnt lgkmcnt(9)
    v_mfma_f32_32x32x16_bf16 v[32:47], v[100:103], v[96:99], v[32:47]
    ds_read_b128 v[128:131], v29 offset:0
    ds_read_b64_tr_b16 v[132:133], v28 offset:32768
    ds_read_b64_tr_b16 v[134:135], v28 offset:33280
    ds_read_b128 v[136:139], v29 offset:1024
    ds_read_b64_tr_b16 v[140:141], v28 offset:34816
    ds_read_b64_tr_b16 v[142:143], v28 offset:35328
    s_waitcnt lgkmcnt(12)
    v_mfma_f32_32x32x16_bf16 v[32:47], v[108:111], v[104:107], v[32:47]
    ds_read_b128 v[144:147], v29 offset:2048
    ds_read_b64_tr_b16 v[148:149], v28 offset:36864
    ds_read_b64_tr_b16 v[150:151], v28 offset:37376
    s_waitcnt lgkmcnt(12)
    v_mfma_f32_32x32x16_bf16 v[32:47], v[116:119], v[112:115], v[32:47]
    ds_read_b128 v[152:155], v29 offset:3072
    ds_read_b64_tr_b16 v[156:157], v28 offset:38912
    ds_read_b64_tr_b16 v[158:159], v28 offset:39424
    s_waitcnt lgkmcnt(12)
    v_mfma_f32_32x32x16_bf16 v[32:47], v[124:127], v[120:123], v[32:47]
    ds_read_b128 v[96:99], v29 offset:49152
    ds_read_b64_tr_b16 v[100:101], v20 offset:40960
    ds_read_b64_tr_b16 v[102:103], v20 offset:41472
    s_waitcnt lgkmcnt(12)
    v_mfma_f32_32x32x16_bf16 v[32:47], v[132:135], v[128:131], v[32:47]
    ds_read_b128 v[104:107], v29 offset:50176
    ds_read_b64_tr_b16 v[108:109], v20 offset:43008
    ds_read_b64_tr_b16 v[110:111], v20 offset:43520
    s_waitcnt lgkmcnt(12)
    v_mfma_f32_32x32x16_bf16 v[32:47], v[140:143], v[136:139], v[32:47]
    ds_read_b128 v[112:115], v29 offset:51200
    ds_read_b64_tr_b16 v[116:117], v20 offset:45056
    ds_read_b64_tr_b16 v[118:119], v20 offset:45568
    s_waitcnt lgkmcnt(12)
    v_mfma_f32_32x32x16_bf16 v[32:47], v[148:151], v[144:147], v[32:47]
    ds_read_b128 v[120:123], v29 offset:52224
    ds_read_b64_tr_b16 v[124:125], v20 offset:47104
    ds_read_b64_tr_b16 v[126:127], v20 offset:47616
    s_waitcnt lgkmcnt(12)
    v_mfma_f32_32x32x16_bf16 v[32:47], v[156:159], v[152:155], v[32:47]
    s_waitcnt lgkmcnt(9)
    v_mfma_f32_32x32x16_bf16 v[32:47], v[100:103], v[96:99], v[32:47]
    s_waitcnt lgkmcnt(6)
    v_mfma_f32_32x32x16_bf16 v[32:47], v[108:111], v[104:107], v[32:47]
    s_waitcnt lgkmcnt(0)
    s_barrier
    v_mfma_f32_32x32x16_bf16 v[32:47], v[116:119], v[112:115], v[32:47]
    ds_read_b128 v[128:131], v29 offset:40960
    ds_read_b64_tr_b16 v[132:133], v20 offset:32768
    ds_read_b64_tr_b16 v[134:135], v20 offset:33280
    ds_read_b128 v[136:139], v29 offset:41984
    ds_read_b64_tr_b16 v[140:141], v20 offset:34816
    ds_read_b64_tr_b16 v[142:143], v20 offset:35328
    v_mfma_f32_32x32x16_bf16 v[32:47], v[124:127], v[120:123], v[32:47]
    ds_read_b128 v[144:147], v29 offset:43008
    ds_read_b64_tr_b16 v[148:149], v20 offset:36864
    ds_read_b64_tr_b16 v[150:151], v20 offset:37376
    ds_read_b128 v[152:155], v29 offset:44032
    ds_read_b64_tr_b16 v[156:157], v20 offset:38912
    ds_read_b64_tr_b16 v[158:159], v20 offset:39424
    s_waitcnt lgkmcnt(9)
    v_mfma_f32_32x32x16_bf16 v[32:47], v[132:135], v[128:131], v[32:47]
    ds_read_b128 v[96:99], v29 offset:8192
    ds_read_b64_tr_b16 v[100:101], v28 offset:57344
    ds_read_b64_tr_b16 v[102:103], v28 offset:57856
    ds_read_b128 v[104:107], v29 offset:9216
    ds_read_b64_tr_b16 v[108:109], v28 offset:59392
    ds_read_b64_tr_b16 v[110:111], v28 offset:59904
    s_waitcnt lgkmcnt(12)
    v_mfma_f32_32x32x16_bf16 v[32:47], v[140:143], v[136:139], v[32:47]
    ds_read_b128 v[112:115], v29 offset:10240
    ds_read_b64_tr_b16 v[116:117], v28 offset:61440
    ds_read_b64_tr_b16 v[118:119], v28 offset:61952
    s_waitcnt lgkmcnt(12)
    v_mfma_f32_32x32x16_bf16 v[32:47], v[148:151], v[144:147], v[32:47]
    ds_read_b128 v[120:123], v29 offset:11264
    ds_read_b64_tr_b16 v[124:125], v28 offset:63488
    ds_read_b64_tr_b16 v[126:127], v28 offset:64000
    s_waitcnt lgkmcnt(12)
    v_mfma_f32_32x32x16_bf16 v[32:47], v[156:159], v[152:155], v[32:47]
    ds_read_b128 v[128:131], v26 offset:0
    ds_read_b64_tr_b16 v[132:133], v20 offset:57344
    ds_read_b64_tr_b16 v[134:135], v20 offset:57856
    s_waitcnt lgkmcnt(12)
    v_mfma_f32_32x32x16_bf16 v[32:47], v[100:103], v[96:99], v[32:47]
    ds_read_b128 v[136:139], v26 offset:1024
    ds_read_b64_tr_b16 v[140:141], v20 offset:59392
    ds_read_b64_tr_b16 v[142:143], v20 offset:59904
    s_waitcnt lgkmcnt(12)
    v_mfma_f32_32x32x16_bf16 v[32:47], v[108:111], v[104:107], v[32:47]
    ds_read_b128 v[144:147], v26 offset:2048
    ds_read_b64_tr_b16 v[148:149], v20 offset:61440
    ds_read_b64_tr_b16 v[150:151], v20 offset:61952
    s_waitcnt lgkmcnt(12)
    v_mfma_f32_32x32x16_bf16 v[32:47], v[116:119], v[112:115], v[32:47]
    ds_read_b128 v[152:155], v26 offset:3072
    ds_read_b64_tr_b16 v[156:157], v20 offset:63488
    ds_read_b64_tr_b16 v[158:159], v20 offset:64000
    s_waitcnt lgkmcnt(12)
    v_mfma_f32_32x32x16_bf16 v[32:47], v[124:127], v[120:123], v[32:47]
    s_waitcnt lgkmcnt(9)
    v_mfma_f32_32x32x16_bf16 v[32:47], v[132:135], v[128:131], v[32:47]
    s_waitcnt lgkmcnt(6)
    v_mfma_f32_32x32x16_bf16 v[32:47], v[140:143], v[136:139], v[32:47]
    s_waitcnt lgkmcnt(0)
    s_barrier
    v_mfma_f32_32x32x16_bf16 v[32:47], v[148:151], v[144:147], v[32:47]
    ds_read_b128 v[96:99], v27 offset:24576
    ds_read_b64_tr_b16 v[100:101], v20 offset:49152
    ds_read_b64_tr_b16 v[102:103], v20 offset:49664
    ds_read_b128 v[104:107], v27 offset:25600
    ds_read_b64_tr_b16 v[108:109], v20 offset:51200
    ds_read_b64_tr_b16 v[110:111], v20 offset:51712
    v_mfma_f32_32x32x16_bf16 v[32:47], v[156:159], v[152:155], v[32:47]
    ds_read_b128 v[112:115], v27 offset:26624
    ds_read_b64_tr_b16 v[116:117], v20 offset:53248
    ds_read_b64_tr_b16 v[118:119], v20 offset:53760
    ds_read_b128 v[120:123], v27 offset:27648
    ds_read_b64_tr_b16 v[124:125], v20 offset:55296
    ds_read_b64_tr_b16 v[126:127], v20 offset:55808
    s_waitcnt lgkmcnt(9)
    v_mfma_f32_32x32x16_bf16 v[32:47], v[100:103], v[96:99], v[32:47]
    ds_read_b128 v[128:131], v27 offset:8192
    ds_read_b64_tr_b16 v[132:133], v20 offset:8192
    ds_read_b64_tr_b16 v[134:135], v20 offset:8704
    ds_read_b128 v[136:139], v27 offset:9216
    ds_read_b64_tr_b16 v[140:141], v20 offset:10240
    ds_read_b64_tr_b16 v[142:143], v20 offset:10752
    s_waitcnt lgkmcnt(12)
    v_mfma_f32_32x32x16_bf16 v[32:47], v[108:111], v[104:107], v[32:47]
    ds_read_b128 v[144:147], v27 offset:10240
    ds_read_b64_tr_b16 v[148:149], v20 offset:12288
    ds_read_b64_tr_b16 v[150:151], v20 offset:12800
    s_waitcnt lgkmcnt(12)
    v_mfma_f32_32x32x16_bf16 v[32:47], v[116:119], v[112:115], v[32:47]
    ds_read_b128 v[152:155], v27 offset:11264
    ds_read_b64_tr_b16 v[156:157], v20 offset:14336
    ds_read_b64_tr_b16 v[158:159], v20 offset:14848
    s_waitcnt lgkmcnt(12)
    v_mfma_f32_32x32x16_bf16 v[32:47], v[124:127], v[120:123], v[32:47]
    ds_read_b128 v[96:99], v26 offset:16384
    ds_read_b64_tr_b16 v[100:101], v28 offset:16384
    ds_read_b64_tr_b16 v[102:103], v28 offset:16896
    s_waitcnt lgkmcnt(12)
    v_mfma_f32_32x32x16_bf16 v[32:47], v[132:135], v[128:131], v[32:47]
    ds_read_b128 v[104:107], v26 offset:17408
    ds_read_b64_tr_b16 v[108:109], v28 offset:18432
    ds_read_b64_tr_b16 v[110:111], v28 offset:18944
    s_waitcnt lgkmcnt(12)
    v_mfma_f32_32x32x16_bf16 v[32:47], v[140:143], v[136:139], v[32:47]
    ds_read_b128 v[112:115], v26 offset:18432
    ds_read_b64_tr_b16 v[116:117], v28 offset:20480
    ds_read_b64_tr_b16 v[118:119], v28 offset:20992
    s_waitcnt lgkmcnt(12)
    v_mfma_f32_32x32x16_bf16 v[32:47], v[148:151], v[144:147], v[32:47]
    ds_read_b128 v[120:123], v26 offset:19456
    ds_read_b64_tr_b16 v[124:125], v28 offset:22528
    ds_read_b64_tr_b16 v[126:127], v28 offset:23040
    s_waitcnt lgkmcnt(12)
    v_mfma_f32_32x32x16_bf16 v[32:47], v[156:159], v[152:155], v[32:47]
    s_waitcnt lgkmcnt(9)
    v_mfma_f32_32x32x16_bf16 v[32:47], v[100:103], v[96:99], v[32:47]
    s_waitcnt lgkmcnt(6)
    v_mfma_f32_32x32x16_bf16 v[32:47], v[108:111], v[104:107], v[32:47]
    s_waitcnt lgkmcnt(0)
    s_barrier
    v_mfma_f32_32x32x16_bf16 v[32:47], v[116:119], v[112:115], v[32:47]
    ds_read_b128 v[128:131], v27 offset:0
    ds_read_b64_tr_b16 v[132:133], v20 offset:24576
    ds_read_b64_tr_b16 v[134:135], v20 offset:25088
    ds_read_b128 v[136:139], v27 offset:1024
    ds_read_b64_tr_b16 v[140:141], v20 offset:26624
    ds_read_b64_tr_b16 v[142:143], v20 offset:27136
    v_mfma_f32_32x32x16_bf16 v[32:47], v[124:127], v[120:123], v[32:47]
    ds_read_b128 v[144:147], v27 offset:2048
    ds_read_b64_tr_b16 v[148:149], v20 offset:28672
    ds_read_b64_tr_b16 v[150:151], v20 offset:29184
    ds_read_b128 v[152:155], v27 offset:3072
    ds_read_b64_tr_b16 v[156:157], v20 offset:30720
    ds_read_b64_tr_b16 v[158:159], v20 offset:31232
    s_waitcnt lgkmcnt(9)
    v_mfma_f32_32x32x16_bf16 v[32:47], v[132:135], v[128:131], v[32:47]
    ds_read_b128 v[96:99], v29 offset:0
    ds_read_b64_tr_b16 v[100:101], v28 offset:49152
    ds_read_b64_tr_b16 v[102:103], v28 offset:49664
    ds_read_b128 v[104:107], v29 offset:1024
    ds_read_b64_tr_b16 v[108:109], v28 offset:51200
    ds_read_b64_tr_b16 v[110:111], v28 offset:51712
    s_waitcnt lgkmcnt(12)
    v_mfma_f32_32x32x16_bf16 v[32:47], v[140:143], v[136:139], v[32:47]
    ds_read_b128 v[112:115], v29 offset:2048
    ds_read_b64_tr_b16 v[116:117], v28 offset:53248
    ds_read_b64_tr_b16 v[118:119], v28 offset:53760
    s_waitcnt lgkmcnt(12)
    v_mfma_f32_32x32x16_bf16 v[32:47], v[148:151], v[144:147], v[32:47]
    ds_read_b128 v[120:123], v29 offset:3072
    ds_read_b64_tr_b16 v[124:125], v28 offset:55296
    ds_read_b64_tr_b16 v[126:127], v28 offset:55808
    s_waitcnt lgkmcnt(12)
    v_mfma_f32_32x32x16_bf16 v[32:47], v[156:159], v[152:155], v[32:47]
    ds_read_b128 v[128:131], v29 offset:32768
    ds_read_b64_tr_b16 v[132:133], v20 offset:40960
    ds_read_b64_tr_b16 v[134:135], v20 offset:41472
    s_waitcnt lgkmcnt(12)
    v_mfma_f32_32x32x16_bf16 v[48:63], v[100:103], v[96:99], 0
    ds_read_b128 v[136:139], v29 offset:33792
    ds_read_b64_tr_b16 v[140:141], v20 offset:43008
    ds_read_b64_tr_b16 v[142:143], v20 offset:43520
    s_waitcnt lgkmcnt(12)
    v_mfma_f32_32x32x16_bf16 v[48:63], v[108:111], v[104:107], v[48:63]
    ds_read_b128 v[144:147], v29 offset:34816
    ds_read_b64_tr_b16 v[148:149], v20 offset:45056
    ds_read_b64_tr_b16 v[150:151], v20 offset:45568
    s_waitcnt lgkmcnt(12)
    v_mfma_f32_32x32x16_bf16 v[48:63], v[116:119], v[112:115], v[48:63]
    ds_read_b128 v[152:155], v29 offset:35840
    ds_read_b64_tr_b16 v[156:157], v20 offset:47104
    ds_read_b64_tr_b16 v[158:159], v20 offset:47616
    s_waitcnt lgkmcnt(12)
    v_mfma_f32_32x32x16_bf16 v[48:63], v[124:127], v[120:123], v[48:63]
    v_and_b32 v92, 31, v0
    v_lshrrev_b32 v93, 5, v0
    s_and_b32 s11, s10, 1
    s_lshl_b32 s11, s11, 2
    v_lshl_or_b32 v93, v93, 1, s11
    s_waitcnt lgkmcnt(9)
    v_mfma_f32_32x32x16_bf16 v[48:63], v[132:135], v[128:131], v[48:63]
    v_and_b32 v94, 7, v0
    v_xor_b32 v93, v93, v94
    v_lshlrev_b32 v93, 4, v93
    v_lshl_or_b32 v88, v92, 7, v93
    s_lshr_b32 s11, s10, 1
    s_waitcnt lgkmcnt(6)
    v_mfma_f32_32x32x16_bf16 v[48:63], v[140:143], v[136:139], v[48:63]
    s_lshl_b32 s11, s11, 12
    s_add_u32 s11, s11, 114688
    v_add_u32 v88, s11, v88
    v_xor_b32 v89, 16, v88
    v_lshrrev_b32 v92, 3, v0
    s_waitcnt lgkmcnt(0)
    s_barrier
    v_mfma_f32_32x32x16_bf16 v[48:63], v[148:151], v[144:147], v[48:63]
    ds_read_b128 v[96:99], v29 offset:40960
    ds_read_b64_tr_b16 v[100:101], v28 offset:57344
    ds_read_b64_tr_b16 v[102:103], v28 offset:57856
    ds_read_b128 v[104:107], v29 offset:41984
    ds_read_b64_tr_b16 v[108:109], v28 offset:59392
    ds_read_b64_tr_b16 v[110:111], v28 offset:59904
    v_xor_b32 v93, v94, v92
    v_lshlrev_b32 v93, 4, v93
    v_lshl_or_b32 v90, v92, 7, v93
    v_mfma_f32_32x32x16_bf16 v[48:63], v[156:159], v[152:155], v[48:63]
    ds_read_b128 v[112:115], v29 offset:43008
    ds_read_b64_tr_b16 v[116:117], v28 offset:61440
    ds_read_b64_tr_b16 v[118:119], v28 offset:61952
    ds_read_b128 v[120:123], v29 offset:44032
    ds_read_b64_tr_b16 v[124:125], v28 offset:63488
    ds_read_b64_tr_b16 v[126:127], v28 offset:64000
    s_lshl_b32 s11, s10, 11
    s_add_u32 s11, s11, 114688
    v_add_u32 v90, s11, v90
    s_waitcnt lgkmcnt(9)
    v_mfma_f32_32x32x16_bf16 v[48:63], v[100:103], v[96:99], v[48:63]
    ds_read_b128 v[128:131], v26 offset:32768
    ds_read_b64_tr_b16 v[132:133], v20 offset:0
    ds_read_b64_tr_b16 v[134:135], v20 offset:512
    ds_read_b128 v[136:139], v26 offset:33792
    ds_read_b64_tr_b16 v[140:141], v20 offset:2048
    ds_read_b64_tr_b16 v[142:143], v20 offset:2560
    v_lshlrev_b32 v94, 4, v94
    v_lshl_or_b32 v91, v92, 10, v94
    s_lshl_b32 s11, s8, 16
    s_waitcnt lgkmcnt(12)
    v_mfma_f32_32x32x16_bf16 v[48:63], v[108:111], v[104:107], v[48:63]
    ds_read_b128 v[144:147], v26 offset:34816
    ds_read_b64_tr_b16 v[148:149], v20 offset:4096
    ds_read_b64_tr_b16 v[150:151], v20 offset:4608
    s_lshl_b32 s12, s10, 14
    s_add_u32 s11, s11, s12
    s_lshl_b32 s12, s9, 7
    s_waitcnt lgkmcnt(12)
    v_mfma_f32_32x32x16_bf16 v[48:63], v[116:119], v[112:115], v[48:63]
    ds_read_b128 v[152:155], v26 offset:35840
    ds_read_b64_tr_b16 v[156:157], v20 offset:6144
    ds_read_b64_tr_b16 v[158:159], v20 offset:6656
    s_add_u32 s11, s11, s12
    v_add_u32 v91, s11, v91
    s_mov_b32 s11, 8192
    s_waitcnt lgkmcnt(12)
    v_mfma_f32_32x32x16_bf16 v[48:63], v[124:127], v[120:123], v[48:63]
    ds_read_b128 v[96:99], v29 offset:8192
    ds_read_b64_tr_b16 v[100:101], v20 offset:57344
    ds_read_b64_tr_b16 v[102:103], v20 offset:57856
    buffer_load_dword v64, v19, s[56:59], 0 offen offset:0 sc1
    s_waitcnt lgkmcnt(12)
    v_mfma_f32_32x32x16_bf16 v[48:63], v[132:135], v[128:131], v[48:63]
    ds_read_b128 v[104:107], v29 offset:9216
    ds_read_b64_tr_b16 v[108:109], v20 offset:59392
    ds_read_b64_tr_b16 v[110:111], v20 offset:59904
    buffer_load_dword v65, v19, s[56:59], 0 offen offset:512 sc1
    s_waitcnt lgkmcnt(12)
    v_mfma_f32_32x32x16_bf16 v[48:63], v[140:143], v[136:139], v[48:63]
    ds_read_b128 v[112:115], v29 offset:10240
    ds_read_b64_tr_b16 v[116:117], v20 offset:61440
    ds_read_b64_tr_b16 v[118:119], v20 offset:61952
    buffer_load_dword v66, v19, s[56:59], 0 offen offset:1024 sc1
    s_waitcnt lgkmcnt(12)
    v_mfma_f32_32x32x16_bf16 v[48:63], v[148:151], v[144:147], v[48:63]
    ds_read_b128 v[120:123], v29 offset:11264
    ds_read_b64_tr_b16 v[124:125], v20 offset:63488
    ds_read_b64_tr_b16 v[126:127], v20 offset:64000
    buffer_load_dword v67, v19, s[56:59], 0 offen offset:1536 sc1
    s_waitcnt lgkmcnt(12)
    v_mfma_f32_32x32x16_bf16 v[48:63], v[156:159], v[152:155], v[48:63]
    buffer_load_dword v68, v19, s[56:59], 0 offen offset:2048 sc1
    s_waitcnt lgkmcnt(9)
    v_mfma_f32_32x32x16_bf16 v[48:63], v[100:103], v[96:99], v[48:63]
    buffer_load_dword v69, v19, s[56:59], 0 offen offset:2560 sc1
    s_waitcnt lgkmcnt(6)
    v_mfma_f32_32x32x16_bf16 v[48:63], v[108:111], v[104:107], v[48:63]
    buffer_load_dword v70, v19, s[56:59], 0 offen offset:3072 sc1
    s_waitcnt lgkmcnt(0)
    s_barrier
    v_mfma_f32_32x32x16_bf16 v[48:63], v[116:119], v[112:115], v[48:63]
    ds_read_b128 v[128:131], v27 offset:24576
    ds_read_b64_tr_b16 v[132:133], v20 offset:8192
    ds_read_b64_tr_b16 v[134:135], v20 offset:8704
    ds_read_b128 v[136:139], v27 offset:25600
    ds_read_b64_tr_b16 v[140:141], v20 offset:10240
    ds_read_b64_tr_b16 v[142:143], v20 offset:10752
    buffer_load_dword v71, v19, s[56:59], 0 offen offset:3584 sc1
    v_mfma_f32_32x32x16_bf16 v[48:63], v[124:127], v[120:123], v[48:63]
    ds_read_b128 v[144:147], v27 offset:26624
    ds_read_b64_tr_b16 v[148:149], v20 offset:12288
    ds_read_b64_tr_b16 v[150:151], v20 offset:12800
    ds_read_b128 v[152:155], v27 offset:27648
    ds_read_b64_tr_b16 v[156:157], v20 offset:14336
    ds_read_b64_tr_b16 v[158:159], v20 offset:14848
    s_waitcnt lgkmcnt(9)
    v_mfma_f32_32x32x16_bf16 v[48:63], v[132:135], v[128:131], v[48:63]
    ds_read_b128 v[96:99], v26 offset:49152
    ds_read_b64_tr_b16 v[100:101], v20 offset:16384
    ds_read_b64_tr_b16 v[102:103], v20 offset:16896
    ds_read_b128 v[104:107], v26 offset:50176
    ds_read_b64_tr_b16 v[108:109], v20 offset:18432
    ds_read_b64_tr_b16 v[110:111], v20 offset:18944
    s_waitcnt lgkmcnt(12)
    v_mfma_f32_32x32x16_bf16 v[48:63], v[140:143], v[136:139], v[48:63]
    ds_read_b128 v[112:115], v26 offset:51200
    ds_read_b64_tr_b16 v[116:117], v20 offset:20480
    ds_read_b64_tr_b16 v[118:119], v20 offset:20992
    s_waitcnt lgkmcnt(12)
    v_mfma_f32_32x32x16_bf16 v[48:63], v[148:151], v[144:147], v[48:63]
    ds_read_b128 v[120:123], v26 offset:52224
    ds_read_b64_tr_b16 v[124:125], v20 offset:22528
    ds_read_b64_tr_b16 v[126:127], v20 offset:23040
    s_waitcnt lgkmcnt(12)
    v_mfma_f32_32x32x16_bf16 v[48:63], v[156:159], v[152:155], v[48:63]
    s_waitcnt vmcnt(0)
    v_add_f32 v64, v64, v68
    v_add_f32 v65, v65, v69
    v_add_f32 v66, v66, v70
    v_add_f32 v67, v67, v71
    s_waitcnt lgkmcnt(9)
    v_mfma_f32_32x32x16_bf16 v[48:63], v[100:103], v[96:99], v[48:63]
    v_add_f32 v64, v64, v65
    v_add_f32 v66, v66, v67
    v_add_f32 v64, v64, v66
    v_mul_f32 v64, 0xbfb8aa3b, v64
    v_exp_f32 v64, v64
    s_waitcnt lgkmcnt(6)
    v_mfma_f32_32x32x16_bf16 v[48:63], v[108:111], v[104:107], v[48:63]
    v_add_f32 v64, 1.0, v64
    v_rcp_f32 v64, v64
    s_nop 0
    v_sub_f32 v66, 1.0, v64
    v_pk_mul_f32 v[32:33], v[32:33], v[66:67] op_sel_hi:[1,0]
    s_waitcnt lgkmcnt(0)
    s_barrier
    v_mfma_f32_32x32x16_bf16 v[48:63], v[116:119], v[112:115], v[48:63]
    ds_read_b128 v[128:131], v27 offset:8192
    ds_read_b64_tr_b16 v[132:133], v28 offset:16384
    ds_read_b64_tr_b16 v[134:135], v28 offset:16896
    ds_read_b128 v[136:139], v27 offset:9216
    ds_read_b64_tr_b16 v[140:141], v28 offset:18432
    ds_read_b64_tr_b16 v[142:143], v28 offset:18944
    v_pk_mul_f32 v[34:35], v[34:35], v[66:67] op_sel_hi:[1,0]
    v_pk_mul_f32 v[36:37], v[36:37], v[66:67] op_sel_hi:[1,0]
    v_pk_mul_f32 v[38:39], v[38:39], v[66:67] op_sel_hi:[1,0]
    v_mfma_f32_32x32x16_bf16 v[48:63], v[124:127], v[120:123], v[48:63]
    ds_read_b128 v[144:147], v27 offset:10240
    ds_read_b64_tr_b16 v[148:149], v28 offset:20480
    ds_read_b64_tr_b16 v[150:151], v28 offset:20992
    ds_read_b128 v[152:155], v27 offset:11264
    ds_read_b64_tr_b16 v[156:157], v28 offset:22528
    ds_read_b64_tr_b16 v[158:159], v28 offset:23040
    v_pk_mul_f32 v[40:41], v[40:41], v[66:67] op_sel_hi:[1,0]
    v_pk_mul_f32 v[42:43], v[42:43], v[66:67] op_sel_hi:[1,0]
    v_pk_mul_f32 v[44:45], v[44:45], v[66:67] op_sel_hi:[1,0]
    s_waitcnt lgkmcnt(9)
    v_mfma_f32_32x32x16_bf16 v[48:63], v[132:135], v[128:131], v[48:63]
    v_pk_mul_f32 v[46:47], v[46:47], v[66:67] op_sel_hi:[1,0]
    s_waitcnt lgkmcnt(6)
    v_mfma_f32_32x32x16_bf16 v[48:63], v[140:143], v[136:139], v[48:63]
    s_waitcnt lgkmcnt(3)
    v_mfma_f32_32x32x16_bf16 v[48:63], v[148:151], v[144:147], v[48:63]
    s_waitcnt lgkmcnt(0)
    v_mfma_f32_32x32x16_bf16 v[48:63], v[156:159], v[152:155], v[48:63]
    s_nop 11
    v_pk_fma_f32 v[32:33], v[48:49], v[64:65], v[32:33] op_sel_hi:[1,0,1]
    v_pk_fma_f32 v[34:35], v[50:51], v[64:65], v[34:35] op_sel_hi:[1,0,1]
    v_pk_fma_f32 v[36:37], v[52:53], v[64:65], v[36:37] op_sel_hi:[1,0,1]
    v_pk_fma_f32 v[38:39], v[54:55], v[64:65], v[38:39] op_sel_hi:[1,0,1]
    v_pk_fma_f32 v[40:41], v[56:57], v[64:65], v[40:41] op_sel_hi:[1,0,1]
    v_pk_fma_f32 v[42:43], v[58:59], v[64:65], v[42:43] op_sel_hi:[1,0,1]
    v_pk_fma_f32 v[44:45], v[60:61], v[64:65], v[44:45] op_sel_hi:[1,0,1]
    v_pk_fma_f32 v[46:47], v[62:63], v[64:65], v[46:47] op_sel_hi:[1,0,1]
    v_cvt_pk_bf16_f32 v80, v32, v33
    v_cvt_pk_bf16_f32 v81, v34, v35
    v_cvt_pk_bf16_f32 v82, v36, v37
    v_cvt_pk_bf16_f32 v83, v38, v39
    ds_write_b128 v88, v[80:83]
    v_cvt_pk_bf16_f32 v84, v40, v41
    v_cvt_pk_bf16_f32 v85, v42, v43
    v_cvt_pk_bf16_f32 v86, v44, v45
    v_cvt_pk_bf16_f32 v87, v46, v47
    ds_write_b128 v89, v[84:87]
    s_waitcnt lgkmcnt(0)
    s_barrier
    ds_read_b128 v[80:83], v90
    ds_read_b128 v[84:87], v90 offset:1024
    s_waitcnt lgkmcnt(1)
    buffer_store_dwordx4 v[80:83], v91, s[44:47], 0 offen sc1
    s_waitcnt lgkmcnt(0)
    buffer_store_dwordx4 v[84:87], v91, s[44:47], s11 offen sc1
    s_endpgm
.p2align 6
L_A_attn:
    v_and_b32 v8, 31, v0
    v_lshrrev_b32 v9, 5, v0
    v_bfe_u32 v10, v0, 1, 3
    v_xor_b32 v10, v10, v9
    v_lshlrev_b32 v10, 4, v10
    v_lshl_or_b32 v21, v8, 7, v10
    v_xor_b32 v22, 32, v21
    v_xor_b32 v23, 64, v21
    v_xor_b32 v24, 96, v21
    v_lshrrev_b32 v9, 5, v0
    v_bfe_u32 v8, v0, 2, 2
    v_lshl_or_b32 v8, v9, 3, v8
    v_and_b32 v12, 1, v0
    v_bfe_u32 v13, v0, 1, 1
    v_lshlrev_b32 v9, 4, v12
    v_lshl_or_b32 v9, v13, 3, v9
    v_bfe_u32 v10, v0, 4, 1
    v_bfe_u32 v11, v0, 3, 1
    v_lshlrev_b32 v11, 6, v11
    s_lshl_b32 s11, s10, 5
    v_add_u32 v14, s11, v9
    v_lshl_or_b32 v15, v10, 5, v11
    v_xor_b32 v14, v14, v15
    v_lshl_or_b32 v14, v10, 12, v14
    v_lshl_add_u32 v14, v8, 7, v14
    v_add_u32 v25, 131072, v14
    s_lshr_b32 s13, s10, 1
    s_lshl_b32 s12, s13, 12
    v_add_u32 v29, s12, v6
    v_add_u32 v26, 0x10000, v29
    v_add_u32 v27, 0x20000, v29
    v_lshlrev_b32 v14, 5, v12
    v_lshl_or_b32 v14, v10, 4, v14
    v_lshl_or_b32 v14, v13, 3, v14
    v_xor_b32 v14, v14, v11
    s_and_b32 s101, s10, 1
    s_lshl_b32 s101, s101, 6
    v_xor_b32 v14, s101, v14
    v_lshl_add_u32 v28, v8, 7, v14
    v_add_u32 v20, 0x10000, v28
    v_add_u32 v1, 0x20000, v28
    v_and_b32 v14, 31, v0
    v_and_b32 v15, 32, v0
    v_lshl_or_b32 v18, v14, 10, v15
    s_lshl_b32 s12, s8, 1
    s_add_u32 s12, s12, s13
    s_lshl_b32 s13, s12, 15
    s_lshl_b32 s14, s9, 7
    s_add_u32 s13, s13, s14
    s_add_u32 s13, s13, s101
    v_add_u32 v18, s13, v18
    s_lshr_b32 s13, s12, 2
    s_lshl_b32 s13, s13, 12
    s_and_b32 s14, s12, 3
    s_lshl_b32 s14, s14, 7
    s_add_u32 s13, s13, s14
    s_add_u32 s13, s13, 10092544
    v_lshl_add_u32 v19, v14, 2, s13
    s_mov_b64 s[44:45], s[32:33]
    s_mov_b32 s46, 2097152
    s_mov_b32 s47, 0x20000
    s_lshl_b32 s12, s6, 2
    s_add_u32 s12, s12, s10
    s_mul_i32 s13, s12, 4352
    s_lshl_b32 s14, s4, 2
    s_add_u32 s13, s13, s14
    s_add_u32 s25, s13, 10833920
    s_mul_i32 s12, s12, 17408
    s_add_u32 s26, s12, 9437184
    s_lshl_b32 s12, s4, 10
    v_add_u32 v2, s12, v6
    v_add_u32 v3, 256, v2
    s_lshl_b32 s12, s4, 6
    s_add_u32 s12, s12, 16384
    v_add_u32 v14, s12, v15
    v_add_u32 v15, 16, v14
    v_cmp_eq_u32 vcc, 1, v10
    s_lshl_b32 s12, s10, 9
    s_nop 0
    v_cndmask_b32 v2, v2, v14, vcc
    v_cndmask_b32 v3, v3, v15, vcc
    v_cvt_f32_u32 v15, v10
    v_lshlrev_b32 v14, 4, v10
    v_lshl_or_b32 v14, v13, 3, v14
    v_lshl_add_u32 v14, v8, 5, v14
    v_add_u32 v4, 122880, v14
    v_bfe_u32 v14, v0, 2, 1
    v_sub_u32 v14, 0, v14
    v_and_b32 v5, 0x80008000, v14
    v_add_u32 v4, s12, v4
    v_and_b32 v12, 1, v0
    v_lshlrev_b32 v12, 4, v12
    v_mov_b32 v13, 0x3f80
    v_lshlrev_b32 v12, v12, v13
    v_bfe_u32 v13, v0, 2, 1
    v_lshrrev_b32 v14, 5, v0
    v_cmp_eq_u32 vcc, v13, v14
    v_bfe_u32 v13, v0, 3, 2
    v_bfe_u32 v14, v0, 1, 1
    v_cndmask_b32 v12, 0, v12, vcc
    v_lshl_or_b32 v13, v13, 1, v14
    v_cmp_eq_u32 vcc, 0, v13
    s_nop 1
    v_cndmask_b32 v160, 0, v12, vcc
    v_cmp_eq_u32 vcc, 1, v13
    s_nop 1
    v_cndmask_b32 v161, 0, v12, vcc
    v_cmp_eq_u32 vcc, 2, v13
    s_nop 1
    v_cndmask_b32 v162, 0, v12, vcc
    v_cmp_eq_u32 vcc, 3, v13
    s_nop 1
    v_cndmask_b32 v163, 0, v12, vcc
    v_cmp_eq_u32 vcc, 4, v13
    s_nop 1
    v_cndmask_b32 v164, 0, v12, vcc
    v_cmp_eq_u32 vcc, 5, v13
    s_nop 1
    v_cndmask_b32 v165, 0, v12, vcc
    v_cmp_eq_u32 vcc, 6, v13
    s_nop 1
    v_cndmask_b32 v166, 0, v12, vcc
    v_cmp_eq_u32 vcc, 7, v13
    s_nop 1
    v_cndmask_b32 v167, 0, v12, vcc
    s_barrier
    ds_read_b128 v[96:99], v21 offset:0
    ds_read_b128 v[100:103], v21 offset:4096
    ds_read_b128 v[104:107], v21 offset:8192
    ds_read_b128 v[108:111], v21 offset:12288
    ds_read_b64_tr_b16 v[112:113], v25 offset:0
    ds_read_b64_tr_b16 v[114:115], v25 offset:512
    ds_read_b128 v[116:119], v22 offset:0
    ds_read_b128 v[120:123], v22 offset:4096
    ds_read_b128 v[124:127], v22 offset:8192
    ds_read_b128 v[128:131], v22 offset:12288
    ds_read_b64_tr_b16 v[132:133], v25 offset:2048
    ds_read_b64_tr_b16 v[134:135], v25 offset:2560
    s_waitcnt lgkmcnt(0)
    s_barrier
    v_mfma_f32_32x32x16_bf16 v[32:47], v[112:115], v[96:99], 0
    ds_read_b128 v[136:139], v23 offset:0
    ds_read_b128 v[140:143], v23 offset:4096
    ds_read_b64_tr_b16 v[152:153], v25 offset:8192
    v_mfma_f32_32x32x16_bf16 v[48:63], v[112:115], v[100:103], 0
    ds_read_b128 v[144:147], v23 offset:8192
    ds_read_b128 v[148:151], v23 offset:12288
    ds_read_b64_tr_b16 v[154:155], v25 offset:8704
    v_mfma_f32_32x32x16_bf16 v[64:79], v[112:115], v[104:107], 0
    ds_read_b128 v[96:99], v24 offset:0
    ds_read_b128 v[100:103], v24 offset:4096
    v_mfma_f32_32x32x16_bf16 v[80:95], v[112:115], v[108:111], 0
    ds_read_b128 v[104:107], v24 offset:8192
    ds_read_b128 v[108:111], v24 offset:12288
    ds_read_b64_tr_b16 v[112:113], v25 offset:10240
    ds_read_b64_tr_b16 v[114:115], v25 offset:10752
    v_mfma_f32_32x32x16_bf16 v[32:47], v[132:135], v[116:119], v[32:47]
    v_mfma_f32_32x32x16_bf16 v[48:63], v[132:135], v[120:123], v[48:63]
    v_mfma_f32_32x32x16_bf16 v[64:79], v[132:135], v[124:127], v[64:79]
    v_mfma_f32_32x32x16_bf16 v[80:95], v[132:135], v[128:131], v[80:95]
    s_waitcnt lgkmcnt(0)
    s_barrier
    v_mfma_f32_32x32x16_bf16 v[32:47], v[152:155], v[136:139], v[32:47]
    ds_read_b128 v[116:119], v21 offset:16384
    ds_read_b128 v[120:123], v21 offset:20480
    ds_read_b64_tr_b16 v[132:133], v25 offset:16384
    v_mfma_f32_32x32x16_bf16 v[48:63], v[152:155], v[140:143], v[48:63]
    ds_read_b128 v[124:127], v21 offset:24576
    ds_read_b128 v[128:131], v21 offset:28672
    ds_read_b64_tr_b16 v[134:135], v25 offset:16896
    v_mfma_f32_32x32x16_bf16 v[64:79], v[152:155], v[144:147], v[64:79]
    ds_read_b128 v[136:139], v22 offset:16384
    ds_read_b128 v[140:143], v22 offset:20480
    v_mfma_f32_32x32x16_bf16 v[80:95], v[152:155], v[148:151], v[80:95]
    ds_read_b128 v[144:147], v22 offset:24576
    ds_read_b128 v[148:151], v22 offset:28672
    ds_read_b64_tr_b16 v[152:153], v25 offset:18432
    ds_read_b64_tr_b16 v[154:155], v25 offset:18944
    v_mfma_f32_32x32x16_bf16 v[32:47], v[112:115], v[96:99], v[32:47]
    ds_read_b64_tr_b16 v[156:157], v4 offset:0
    ds_read_b64_tr_b16 v[158:159], v4 offset:128
    v_mfma_f32_32x32x16_bf16 v[48:63], v[112:115], v[100:103], v[48:63]
    v_mfma_f32_32x32x16_bf16 v[64:79], v[112:115], v[104:107], v[64:79]
    v_mfma_f32_32x32x16_bf16 v[80:95], v[112:115], v[108:111], v[80:95]
    s_waitcnt lgkmcnt(0)
    s_barrier
    v_mfma_f32_32x32x16_bf16 v[32:47], v[132:135], v[116:119], v[32:47]
    ds_read_b128 v[96:99], v23 offset:16384
    ds_read_b128 v[100:103], v23 offset:20480
    ds_read_b64_tr_b16 v[112:113], v25 offset:24576
    v_mfma_f32_32x32x16_bf16 v[48:63], v[132:135], v[120:123], v[48:63]
    ds_read_b128 v[104:107], v23 offset:24576
    ds_read_b128 v[108:111], v23 offset:28672
    ds_read_b64_tr_b16 v[114:115], v25 offset:25088
    v_mfma_f32_32x32x16_bf16 v[64:79], v[132:135], v[124:127], v[64:79]
    ds_read_b128 v[116:119], v24 offset:16384
    ds_read_b128 v[120:123], v24 offset:20480
    v_mfma_f32_32x32x16_bf16 v[80:95], v[132:135], v[128:131], v[80:95]
    ds_read_b128 v[124:127], v24 offset:24576
    ds_read_b128 v[128:131], v24 offset:28672
    ds_read_b64_tr_b16 v[132:133], v25 offset:26624
    ds_read_b64_tr_b16 v[134:135], v25 offset:27136
    v_mfma_f32_32x32x16_bf16 v[32:47], v[152:155], v[136:139], v[32:47]
    v_xor_b32 v156, v156, v5
    v_xor_b32 v157, v157, v5
    v_xor_b32 v158, v158, v5
    v_xor_b32 v159, v159, v5
    v_mfma_f32_32x32x16_bf16 v[48:63], v[152:155], v[140:143], v[48:63]
    v_mfma_f32_32x32x16_bf16 v[64:79], v[152:155], v[144:147], v[64:79]
    v_mfma_f32_32x32x16_bf16 v[80:95], v[152:155], v[148:151], v[80:95]
    s_waitcnt lgkmcnt(0)
    s_barrier
    v_mfma_f32_32x32x16_bf16 v[32:47], v[112:115], v[96:99], v[32:47]
    ds_read_b128 v[136:139], v21 offset:32768
    ds_read_b128 v[140:143], v21 offset:36864
    ds_read_b64_tr_b16 v[152:153], v25 offset:0
    v_mfma_f32_32x32x16_bf16 v[48:63], v[112:115], v[100:103], v[48:63]
    ds_read_b128 v[144:147], v21 offset:40960
    ds_read_b128 v[148:151], v21 offset:45056
    ds_read_b64_tr_b16 v[154:155], v25 offset:512
    v_mfma_f32_32x32x16_bf16 v[64:79], v[112:115], v[104:107], v[64:79]
    ds_read_b128 v[96:99], v22 offset:32768
    ds_read_b128 v[100:103], v22 offset:36864
    v_mfma_f32_32x32x16_bf16 v[80:95], v[112:115], v[108:111], v[80:95]
    ds_read_b128 v[104:107], v22 offset:40960
    ds_read_b128 v[108:111], v22 offset:45056
    ds_read_b64_tr_b16 v[112:113], v25 offset:2048
    ds_read_b64_tr_b16 v[114:115], v25 offset:2560
    v_mfma_f32_32x32x16_bf16 v[32:47], v[132:135], v[116:119], v[32:47]
    v_mfma_f32_32x32x16_bf16 v[48:63], v[132:135], v[120:123], v[48:63]
    v_mfma_f32_32x32x16_bf16 v[64:79], v[132:135], v[124:127], v[64:79]
    v_mfma_f32_32x32x16_bf16 v[80:95], v[132:135], v[128:131], v[80:95]
    s_waitcnt lgkmcnt(0)
    s_barrier
    v_mfma_f32_32x32x16_bf16 v[32:47], v[152:155], v[136:139], v[32:47]
    ds_read_b128 v[116:119], v23 offset:32768
    ds_read_b128 v[120:123], v23 offset:36864
    ds_read_b64_tr_b16 v[132:133], v25 offset:8192
    v_mfma_f32_32x32x16_bf16 v[48:63], v[152:155], v[140:143], v[48:63]
    ds_read_b128 v[124:127], v23 offset:40960
    ds_read_b128 v[128:131], v23 offset:45056
    ds_read_b64_tr_b16 v[134:135], v25 offset:8704
    v_mfma_f32_32x32x16_bf16 v[64:79], v[152:155], v[144:147], v[64:79]
    ds_read_b128 v[136:139], v24 offset:32768
    ds_read_b128 v[140:143], v24 offset:36864
    v_mfma_f32_32x32x16_bf16 v[80:95], v[152:155], v[148:151], v[80:95]
    ds_read_b128 v[144:147], v24 offset:40960
    ds_read_b128 v[148:151], v24 offset:45056
    ds_read_b64_tr_b16 v[152:153], v25 offset:10240
    ds_read_b64_tr_b16 v[154:155], v25 offset:10752
    v_mfma_f32_32x32x16_bf16 v[32:47], v[112:115], v[96:99], v[32:47]
    v_mfma_f32_32x32x16_bf16 v[48:63], v[112:115], v[100:103], v[48:63]
    v_mfma_f32_32x32x16_bf16 v[64:79], v[112:115], v[104:107], v[64:79]
    v_mfma_f32_32x32x16_bf16 v[80:95], v[112:115], v[108:111], v[80:95]
    s_waitcnt lgkmcnt(0)
    s_barrier
    v_mfma_f32_32x32x16_bf16 v[32:47], v[132:135], v[116:119], v[32:47]
    ds_read_b128 v[96:99], v21 offset:49152
    ds_read_b128 v[100:103], v21 offset:53248
    ds_read_b64_tr_b16 v[112:113], v25 offset:16384
    v_mfma_f32_32x32x16_bf16 v[48:63], v[132:135], v[120:123], v[48:63]
    ds_read_b128 v[104:107], v21 offset:57344
    ds_read_b128 v[108:111], v21 offset:61440
    ds_read_b64_tr_b16 v[114:115], v25 offset:16896
    v_mfma_f32_32x32x16_bf16 v[64:79], v[132:135], v[124:127], v[64:79]
    ds_read_b128 v[116:119], v22 offset:49152
    ds_read_b128 v[120:123], v22 offset:53248
    v_mfma_f32_32x32x16_bf16 v[80:95], v[132:135], v[128:131], v[80:95]
    ds_read_b128 v[124:127], v22 offset:57344
    ds_read_b128 v[128:131], v22 offset:61440
    ds_read_b64_tr_b16 v[132:133], v25 offset:18432
    ds_read_b64_tr_b16 v[134:135], v25 offset:18944
    v_mfma_f32_32x32x16_bf16 v[32:47], v[152:155], v[136:139], v[32:47]
    v_mfma_f32_32x32x16_bf16 v[48:63], v[152:155], v[140:143], v[48:63]
    v_mfma_f32_32x32x16_bf16 v[64:79], v[152:155], v[144:147], v[64:79]
    v_mfma_f32_32x32x16_bf16 v[80:95], v[152:155], v[148:151], v[80:95]
    s_waitcnt lgkmcnt(0)
    s_barrier
    v_mfma_f32_32x32x16_bf16 v[32:47], v[112:115], v[96:99], v[32:47]
    ds_read_b128 v[136:139], v23 offset:49152
    ds_read_b128 v[140:143], v23 offset:53248
    ds_read_b64_tr_b16 v[152:153], v25 offset:24576
    v_mfma_f32_32x32x16_bf16 v[48:63], v[112:115], v[100:103], v[48:63]
    ds_read_b128 v[144:147], v23 offset:57344
    ds_read_b128 v[148:151], v23 offset:61440
    ds_read_b64_tr_b16 v[154:155], v25 offset:25088
    v_mfma_f32_32x32x16_bf16 v[64:79], v[112:115], v[104:107], v[64:79]
    ds_read_b128 v[96:99], v24 offset:49152
    ds_read_b128 v[100:103], v24 offset:53248
    v_mfma_f32_32x32x16_bf16 v[80:95], v[112:115], v[108:111], v[80:95]
    ds_read_b128 v[104:107], v24 offset:57344
    ds_read_b128 v[108:111], v24 offset:61440
    ds_read_b64_tr_b16 v[112:113], v25 offset:26624
    ds_read_b64_tr_b16 v[114:115], v25 offset:27136
    v_mfma_f32_32x32x16_bf16 v[32:47], v[132:135], v[116:119], v[32:47]
    v_mfma_f32_32x32x16_bf16 v[48:63], v[132:135], v[120:123], v[48:63]
    v_mfma_f32_32x32x16_bf16 v[64:79], v[132:135], v[124:127], v[64:79]
    v_mfma_f32_32x32x16_bf16 v[80:95], v[132:135], v[128:131], v[80:95]
    s_waitcnt lgkmcnt(0)
    s_barrier
    v_add_u32 v21, 0x10000, v21
    v_add_u32 v22, 0x10000, v22
    v_add_u32 v23, 0x10000, v23
    v_add_u32 v24, 0x10000, v24
    v_mfma_f32_32x32x16_bf16 v[32:47], v[152:155], v[136:139], v[32:47]
    ds_read_b128 v[116:119], v21 offset:0
    ds_read_b128 v[120:123], v21 offset:4096
    ds_read_b64_tr_b16 v[132:133], v25 offset:0
    v_mfma_f32_32x32x16_bf16 v[48:63], v[152:155], v[140:143], v[48:63]
    ds_read_b128 v[124:127], v21 offset:8192
    ds_read_b128 v[128:131], v21 offset:12288
    ds_read_b64_tr_b16 v[134:135], v25 offset:512
    v_mfma_f32_32x32x16_bf16 v[64:79], v[152:155], v[144:147], v[64:79]
    ds_read_b128 v[136:139], v22 offset:0
    ds_read_b128 v[140:143], v22 offset:4096
    v_mfma_f32_32x32x16_bf16 v[80:95], v[152:155], v[148:151], v[80:95]
    ds_read_b128 v[144:147], v22 offset:8192
    ds_read_b128 v[148:151], v22 offset:12288
    ds_read_b64_tr_b16 v[152:153], v25 offset:2048
    ds_read_b64_tr_b16 v[154:155], v25 offset:2560
    v_mfma_f32_32x32x16_bf16 v[32:47], v[112:115], v[96:99], v[32:47]
    v_mfma_f32_32x32x16_bf16 v[48:63], v[112:115], v[100:103], v[48:63]
    v_mfma_f32_32x32x16_bf16 v[64:79], v[112:115], v[104:107], v[64:79]
    v_mfma_f32_32x32x16_bf16 v[80:95], v[112:115], v[108:111], v[80:95]
    s_waitcnt lgkmcnt(0)
    s_barrier
    v_mfma_f32_32x32x16_bf16 v[32:47], v[132:135], v[116:119], v[32:47]
    ds_read_b128 v[96:99], v23 offset:0
    ds_read_b128 v[100:103], v23 offset:4096
    ds_read_b64_tr_b16 v[112:113], v25 offset:8192
    v_mfma_f32_32x32x16_bf16 v[48:63], v[132:135], v[120:123], v[48:63]
    ds_read_b128 v[104:107], v23 offset:8192
    ds_read_b128 v[108:111], v23 offset:12288
    ds_read_b64_tr_b16 v[114:115], v25 offset:8704
    v_mfma_f32_32x32x16_bf16 v[64:79], v[132:135], v[124:127], v[64:79]
    ds_read_b128 v[116:119], v24 offset:0
    ds_read_b128 v[120:123], v24 offset:4096
    v_mfma_f32_32x32x16_bf16 v[80:95], v[132:135], v[128:131], v[80:95]
    ds_read_b128 v[124:127], v24 offset:8192
    ds_read_b128 v[128:131], v24 offset:12288
    ds_read_b64_tr_b16 v[132:133], v25 offset:10240
    ds_read_b64_tr_b16 v[134:135], v25 offset:10752
    v_mfma_f32_32x32x16_bf16 v[32:47], v[152:155], v[136:139], v[32:47]
    v_mfma_f32_32x32x16_bf16 v[48:63], v[152:155], v[140:143], v[48:63]
    v_mfma_f32_32x32x16_bf16 v[64:79], v[152:155], v[144:147], v[64:79]
    v_mfma_f32_32x32x16_bf16 v[80:95], v[152:155], v[148:151], v[80:95]
    s_waitcnt lgkmcnt(0)
    s_barrier
    v_mfma_f32_32x32x16_bf16 v[32:47], v[112:115], v[96:99], v[32:47]
    ds_read_b128 v[136:139], v21 offset:16384
    ds_read_b128 v[140:143], v21 offset:20480
    ds_read_b64_tr_b16 v[152:153], v25 offset:16384
    v_mfma_f32_32x32x16_bf16 v[48:63], v[112:115], v[100:103], v[48:63]
    ds_read_b128 v[144:147], v21 offset:24576
    ds_read_b128 v[148:151], v21 offset:28672
    ds_read_b64_tr_b16 v[154:155], v25 offset:16896
    v_mfma_f32_32x32x16_bf16 v[64:79], v[112:115], v[104:107], v[64:79]
    ds_read_b128 v[96:99], v22 offset:16384
    ds_read_b128 v[100:103], v22 offset:20480
    v_mfma_f32_32x32x16_bf16 v[80:95], v[112:115], v[108:111], v[80:95]
    ds_read_b128 v[104:107], v22 offset:24576
    ds_read_b128 v[108:111], v22 offset:28672
    ds_read_b64_tr_b16 v[112:113], v25 offset:18432
    ds_read_b64_tr_b16 v[114:115], v25 offset:18944
    v_mfma_f32_32x32x16_bf16 v[32:47], v[132:135], v[116:119], v[32:47]
    v_mfma_f32_32x32x16_bf16 v[48:63], v[132:135], v[120:123], v[48:63]
    v_mfma_f32_32x32x16_bf16 v[64:79], v[132:135], v[124:127], v[64:79]
    v_mfma_f32_32x32x16_bf16 v[80:95], v[132:135], v[128:131], v[80:95]
    s_waitcnt lgkmcnt(0)
    s_barrier
    v_mfma_f32_32x32x16_bf16 v[32:47], v[152:155], v[136:139], v[32:47]
    ds_read_b128 v[116:119], v23 offset:16384
    ds_read_b128 v[120:123], v23 offset:20480
    ds_read_b64_tr_b16 v[132:133], v25 offset:24576
    v_mfma_f32_32x32x16_bf16 v[48:63], v[152:155], v[140:143], v[48:63]
    ds_read_b128 v[124:127], v23 offset:24576
    ds_read_b128 v[128:131], v23 offset:28672
    ds_read_b64_tr_b16 v[134:135], v25 offset:25088
    v_mfma_f32_32x32x16_bf16 v[64:79], v[152:155], v[144:147], v[64:79]
    ds_read_b128 v[136:139], v24 offset:16384
    ds_read_b128 v[140:143], v24 offset:20480
    v_mfma_f32_32x32x16_bf16 v[80:95], v[152:155], v[148:151], v[80:95]
    ds_read_b128 v[144:147], v24 offset:24576
    ds_read_b128 v[148:151], v24 offset:28672
    ds_read_b64_tr_b16 v[152:153], v25 offset:26624
    ds_read_b64_tr_b16 v[154:155], v25 offset:27136
    v_mfma_f32_32x32x16_bf16 v[32:47], v[112:115], v[96:99], v[32:47]
    v_mfma_f32_32x32x16_bf16 v[48:63], v[112:115], v[100:103], v[48:63]
    v_mfma_f32_32x32x16_bf16 v[64:79], v[112:115], v[104:107], v[64:79]
    v_mfma_f32_32x32x16_bf16 v[80:95], v[112:115], v[108:111], v[80:95]
    s_waitcnt lgkmcnt(0)
    s_barrier
    v_mfma_f32_32x32x16_bf16 v[32:47], v[132:135], v[116:119], v[32:47]
    ds_read_b128 v[96:99], v21 offset:32768
    ds_read_b128 v[100:103], v21 offset:36864
    ds_read_b64_tr_b16 v[112:113], v25 offset:0
    v_mfma_f32_32x32x16_bf16 v[48:63], v[132:135], v[120:123], v[48:63]
    ds_read_b128 v[104:107], v21 offset:40960
    ds_read_b128 v[108:111], v21 offset:45056
    ds_read_b64_tr_b16 v[114:115], v25 offset:512
    v_mfma_f32_32x32x16_bf16 v[64:79], v[132:135], v[124:127], v[64:79]
    ds_read_b128 v[116:119], v22 offset:32768
    ds_read_b128 v[120:123], v22 offset:36864
    v_mfma_f32_32x32x16_bf16 v[80:95], v[132:135], v[128:131], v[80:95]
    ds_read_b128 v[124:127], v22 offset:40960
    ds_read_b128 v[128:131], v22 offset:45056
    ds_read_b64_tr_b16 v[132:133], v25 offset:2048
    ds_read_b64_tr_b16 v[134:135], v25 offset:2560
    v_mfma_f32_32x32x16_bf16 v[32:47], v[152:155], v[136:139], v[32:47]
    v_mfma_f32_32x32x16_bf16 v[48:63], v[152:155], v[140:143], v[48:63]
    v_mfma_f32_32x32x16_bf16 v[64:79], v[152:155], v[144:147], v[64:79]
    v_mfma_f32_32x32x16_bf16 v[80:95], v[152:155], v[148:151], v[80:95]
    s_waitcnt lgkmcnt(0)
    s_barrier
    v_mfma_f32_32x32x16_bf16 v[32:47], v[112:115], v[96:99], v[32:47]
    ds_read_b128 v[136:139], v23 offset:32768
    ds_read_b128 v[140:143], v23 offset:36864
    ds_read_b64_tr_b16 v[152:153], v25 offset:8192
    v_mfma_f32_32x32x16_bf16 v[48:63], v[112:115], v[100:103], v[48:63]
    ds_read_b128 v[144:147], v23 offset:40960
    ds_read_b128 v[148:151], v23 offset:45056
    ds_read_b64_tr_b16 v[154:155], v25 offset:8704
    v_mfma_f32_32x32x16_bf16 v[64:79], v[112:115], v[104:107], v[64:79]
    ds_read_b128 v[96:99], v24 offset:32768
    ds_read_b128 v[100:103], v24 offset:36864
    v_mfma_f32_32x32x16_bf16 v[80:95], v[112:115], v[108:111], v[80:95]
    ds_read_b128 v[104:107], v24 offset:40960
    ds_read_b128 v[108:111], v24 offset:45056
    ds_read_b64_tr_b16 v[112:113], v25 offset:10240
    ds_read_b64_tr_b16 v[114:115], v25 offset:10752
    v_mfma_f32_32x32x16_bf16 v[32:47], v[132:135], v[116:119], v[32:47]
    v_mfma_f32_32x32x16_bf16 v[48:63], v[132:135], v[120:123], v[48:63]
    v_mfma_f32_32x32x16_bf16 v[64:79], v[132:135], v[124:127], v[64:79]
    v_mfma_f32_32x32x16_bf16 v[80:95], v[132:135], v[128:131], v[80:95]
    s_waitcnt lgkmcnt(0)
    s_barrier
    v_mfma_f32_32x32x16_bf16 v[32:47], v[152:155], v[136:139], v[32:47]
    ds_read_b128 v[116:119], v21 offset:49152
    ds_read_b128 v[120:123], v21 offset:53248
    ds_read_b64_tr_b16 v[132:133], v25 offset:16384
    v_mfma_f32_32x32x16_bf16 v[48:63], v[152:155], v[140:143], v[48:63]
    ds_read_b128 v[124:127], v21 offset:57344
    ds_read_b128 v[128:131], v21 offset:61440
    ds_read_b64_tr_b16 v[134:135], v25 offset:16896
    v_mfma_f32_32x32x16_bf16 v[64:79], v[152:155], v[144:147], v[64:79]
    ds_read_b128 v[136:139], v22 offset:49152
    ds_read_b128 v[140:143], v22 offset:53248
    v_mfma_f32_32x32x16_bf16 v[80:95], v[152:155], v[148:151], v[80:95]
    ds_read_b128 v[144:147], v22 offset:57344
    ds_read_b128 v[148:151], v22 offset:61440
    ds_read_b64_tr_b16 v[152:153], v25 offset:18432
    ds_read_b64_tr_b16 v[154:155], v25 offset:18944
    v_mfma_f32_32x32x16_bf16 v[32:47], v[112:115], v[96:99], v[32:47]
    v_mfma_f32_32x32x16_bf16 v[48:63], v[112:115], v[100:103], v[48:63]
    v_mfma_f32_32x32x16_bf16 v[64:79], v[112:115], v[104:107], v[64:79]
    v_mfma_f32_32x32x16_bf16 v[80:95], v[112:115], v[108:111], v[80:95]
    s_waitcnt lgkmcnt(0)
    s_barrier
    v_mfma_f32_32x32x16_bf16 v[32:47], v[132:135], v[116:119], v[32:47]
    ds_read_b128 v[96:99], v23 offset:49152
    ds_read_b128 v[100:103], v23 offset:53248
    ds_read_b64_tr_b16 v[112:113], v25 offset:24576
    v_mfma_f32_32x32x16_bf16 v[48:63], v[132:135], v[120:123], v[48:63]
    ds_read_b128 v[104:107], v23 offset:57344
    ds_read_b128 v[108:111], v23 offset:61440
    ds_read_b64_tr_b16 v[114:115], v25 offset:25088
    v_mfma_f32_32x32x16_bf16 v[64:79], v[132:135], v[124:127], v[64:79]
    ds_read_b128 v[116:119], v24 offset:49152
    ds_read_b128 v[120:123], v24 offset:53248
    v_mfma_f32_32x32x16_bf16 v[80:95], v[132:135], v[128:131], v[80:95]
    ds_read_b128 v[124:127], v24 offset:57344
    ds_read_b128 v[128:131], v24 offset:61440
    ds_read_b64_tr_b16 v[132:133], v25 offset:26624
    ds_read_b64_tr_b16 v[134:135], v25 offset:27136
    v_mfma_f32_32x32x16_bf16 v[32:47], v[152:155], v[136:139], v[32:47]
    v_mfma_f32_32x32x16_bf16 v[48:63], v[152:155], v[140:143], v[48:63]
    v_mfma_f32_32x32x16_bf16 v[64:79], v[152:155], v[144:147], v[64:79]
    v_mfma_f32_32x32x16_bf16 v[80:95], v[152:155], v[148:151], v[80:95]
    s_waitcnt lgkmcnt(0)
    s_load_dword s15, s[34:35], 0
    s_setprio 2
    s_barrier
    v_mfma_f32_32x32x16_bf16 v[32:47], v[112:115], v[96:99], v[32:47]
    v_mov_b32 v136, v15
    v_mov_b32 v137, v15
    v_mov_b32 v138, v15
    v_mfma_f32_32x32x16_bf16 v[48:63], v[112:115], v[100:103], v[48:63]
    v_mov_b32 v139, v15
    v_mov_b32 v140, v15
    v_mov_b32 v141, v15
    v_mfma_f32_32x32x16_bf16 v[32:47], v[132:135], v[116:119], v[32:47]
    v_mov_b32 v142, v15
    v_mov_b32 v143, v15
    v_mov_b32 v144, v15
    v_mfma_f32_32x32x16_bf16 v[48:63], v[132:135], v[120:123], v[48:63]
    v_mov_b32 v145, v15
    v_mov_b32 v146, v15
    v_mov_b32 v147, v15
    v_mfma_f32_32x32x16_bf16 v[64:79], v[112:115], v[104:107], v[64:79]
    v_mov_b32 v148, v15
    v_mov_b32 v149, v15
    v_mov_b32 v150, v15
    v_mfma_f32_32x32x16_bf16 v[80:95], v[112:115], v[108:111], v[80:95]
    v_mov_b32 v151, v15
    v_mfma_f32_32x32x16_bf16 v[64:79], v[132:135], v[124:127], v[64:79]
    v_mfma_f32_32x32x16_bf16 v[80:95], v[132:135], v[128:131], v[80:95]
    v_cvt_pk_bf16_f32 v32, v32, v33
    v_cvt_pk_bf16_f32 v33, v34, v35
    v_cvt_pk_bf16_f32 v34, v36, v37
    v_cvt_pk_bf16_f32 v35, v38, v39
    v_cvt_pk_bf16_f32 v36, v40, v41
    v_cvt_pk_bf16_f32 v37, v42, v43
    v_cvt_pk_bf16_f32 v38, v44, v45
    v_cvt_pk_bf16_f32 v39, v46, v47
    v_cvt_pk_bf16_f32 v40, v48, v49
    v_cvt_pk_bf16_f32 v41, v50, v51
    v_cvt_pk_bf16_f32 v42, v52, v53
    v_cvt_pk_bf16_f32 v43, v54, v55
    v_cvt_pk_bf16_f32 v44, v56, v57
    v_cvt_pk_bf16_f32 v45, v58, v59
    v_cvt_pk_bf16_f32 v46, v60, v61
    v_cvt_pk_bf16_f32 v47, v62, v63
    v_mfma_f32_32x32x16_bf16 v[96:111], v[156:159], v[32:35], 0
    v_mfma_f32_32x32x16_bf16 v[112:127], v[156:159], v[40:43], 0
    v_cvt_pk_bf16_f32 v48, v64, v65
    v_cvt_pk_bf16_f32 v49, v66, v67
    v_cvt_pk_bf16_f32 v50, v68, v69
    v_cvt_pk_bf16_f32 v51, v70, v71
    v_cvt_pk_bf16_f32 v52, v72, v73
    v_cvt_pk_bf16_f32 v53, v74, v75
    v_cvt_pk_bf16_f32 v54, v76, v77
    v_cvt_pk_bf16_f32 v55, v78, v79
    v_cvt_pk_bf16_f32 v56, v80, v81
    v_cvt_pk_bf16_f32 v57, v82, v83
    v_cvt_pk_bf16_f32 v58, v84, v85
    v_cvt_pk_bf16_f32 v59, v86, v87
    v_cvt_pk_bf16_f32 v60, v88, v89
    v_cvt_pk_bf16_f32 v61, v90, v91
    v_cvt_pk_bf16_f32 v62, v92, v93
    v_cvt_pk_bf16_f32 v63, v94, v95
    v_mfma_f32_32x32x16_bf16 v[64:79], v[36:39], v[160:163], v[136:151]
    v_max3_f32 v8, v96, v97, v98
    v_max3_f32 v9, v99, v100, v101
    v_max3_f32 v10, v102, v103, v104
    v_max3_f32 v11, v105, v106, v107
    v_max3_f32 v8, v8, v108, v109
    v_max3_f32 v9, v9, v110, v111
    v_max3_f32 v8, v8, v10, v11
    v_max_f32 v8, v8, v9
    v_mul_f32 v8, 0xbfb8aa3b, v8
    v_pk_fma_f32 v[96:97], v[96:97], s[38:39], v[8:9] op_sel_hi:[1,1,0]
    v_pk_fma_f32 v[98:99], v[98:99], s[38:39], v[8:9] op_sel_hi:[1,1,0]
    v_pk_fma_f32 v[100:101], v[100:101], s[38:39], v[8:9] op_sel_hi:[1,1,0]
    v_pk_fma_f32 v[102:103], v[102:103], s[38:39], v[8:9] op_sel_hi:[1,1,0]
    v_pk_fma_f32 v[104:105], v[104:105], s[38:39], v[8:9] op_sel_hi:[1,1,0]
    v_pk_fma_f32 v[106:107], v[106:107], s[38:39], v[8:9] op_sel_hi:[1,1,0]
    v_pk_fma_f32 v[108:109], v[108:109], s[38:39], v[8:9] op_sel_hi:[1,1,0]
    v_pk_fma_f32 v[110:111], v[110:111], s[38:39], v[8:9] op_sel_hi:[1,1,0]
    v_exp_f32 v96, v96
    v_exp_f32 v97, v97
    v_exp_f32 v98, v98
    v_exp_f32 v99, v99
    v_exp_f32 v100, v100
    v_exp_f32 v101, v101
    v_exp_f32 v102, v102
    v_exp_f32 v103, v103
    v_exp_f32 v104, v104
    v_exp_f32 v105, v105
    v_exp_f32 v106, v106
    v_exp_f32 v107, v107
    v_exp_f32 v108, v108
    v_exp_f32 v109, v109
    v_exp_f32 v110, v110
    v_exp_f32 v111, v111
    v_pk_add_f32 v[8:9], v[96:97], v[98:99]
    v_pk_add_f32 v[10:11], v[100:101], v[102:103]
    v_pk_add_f32 v[8:9], v[8:9], v[104:105]
    v_pk_add_f32 v[10:11], v[10:11], v[106:107]
    v_pk_add_f32 v[8:9], v[8:9], v[108:109]
    v_pk_add_f32 v[10:11], v[10:11], v[110:111]
    v_pk_add_f32 v[8:9], v[8:9], v[10:11]
    v_add_f32 v8, v8, v9
    v_rcp_f32 v8, v8
    s_nop 0
    v_pk_mul_f32 v[96:97], v[96:97], v[8:9] op_sel_hi:[1,0]
    v_pk_mul_f32 v[98:99], v[98:99], v[8:9] op_sel_hi:[1,0]
    s_barrier
    v_pk_mul_f32 v[100:101], v[100:101], v[8:9] op_sel_hi:[1,0]
    v_pk_mul_f32 v[102:103], v[102:103], v[8:9] op_sel_hi:[1,0]
    v_pk_mul_f32 v[104:105], v[104:105], v[8:9] op_sel_hi:[1,0]
    v_pk_mul_f32 v[106:107], v[106:107], v[8:9] op_sel_hi:[1,0]
    v_pk_mul_f32 v[108:109], v[108:109], v[8:9] op_sel_hi:[1,0]
    v_pk_mul_f32 v[110:111], v[110:111], v[8:9] op_sel_hi:[1,0]
    v_cvt_pk_bf16_f32 v128, v96, v97
    v_cvt_pk_bf16_f32 v129, v98, v99
    v_cvt_pk_bf16_f32 v130, v100, v101
    v_cvt_pk_bf16_f32 v131, v102, v103
    v_cvt_pk_bf16_f32 v132, v104, v105
    v_cvt_pk_bf16_f32 v133, v106, v107
    v_cvt_pk_bf16_f32 v134, v108, v109
    v_cvt_pk_bf16_f32 v135, v110, v111
    v_mfma_f32_32x32x16_bf16 v[96:111], v[128:131], v[160:163], 0
    s_nop 0
    v_mfma_f32_32x32x16_bf16 v[96:111], v[132:135], v[164:167], v[96:111]
    v_cvt_pk_bf16_f32 v64, v64, v65
    v_cvt_pk_bf16_f32 v65, v66, v67
    v_cvt_pk_bf16_f32 v66, v68, v69
    v_cvt_pk_bf16_f32 v67, v70, v71
    v_cvt_pk_bf16_f32 v68, v72, v73
    v_cvt_pk_bf16_f32 v69, v74, v75
    v_cvt_pk_bf16_f32 v70, v76, v77
    v_cvt_pk_bf16_f32 v71, v78, v79
    v_max3_f32 v8, v112, v113, v114
    v_max3_f32 v9, v115, v116, v117
    v_max3_f32 v10, v118, v119, v120
    v_max3_f32 v11, v121, v122, v123
    v_max3_f32 v8, v8, v124, v125
    v_max3_f32 v9, v9, v126, v127
    v_max3_f32 v8, v8, v10, v11
    v_max_f32 v8, v8, v9
    v_mul_f32 v8, 0xbfb8aa3b, v8
    v_pk_fma_f32 v[112:113], v[112:113], s[38:39], v[8:9] op_sel_hi:[1,1,0]
    v_pk_fma_f32 v[114:115], v[114:115], s[38:39], v[8:9] op_sel_hi:[1,1,0]
    v_pk_fma_f32 v[116:117], v[116:117], s[38:39], v[8:9] op_sel_hi:[1,1,0]
    v_pk_fma_f32 v[118:119], v[118:119], s[38:39], v[8:9] op_sel_hi:[1,1,0]
    v_pk_fma_f32 v[120:121], v[120:121], s[38:39], v[8:9] op_sel_hi:[1,1,0]
    v_pk_fma_f32 v[122:123], v[122:123], s[38:39], v[8:9] op_sel_hi:[1,1,0]
    v_pk_fma_f32 v[124:125], v[124:125], s[38:39], v[8:9] op_sel_hi:[1,1,0]
    v_pk_fma_f32 v[126:127], v[126:127], s[38:39], v[8:9] op_sel_hi:[1,1,0]
    v_cvt_pk_bf16_f32 v96, v96, v97
    v_cvt_pk_bf16_f32 v97, v98, v99
    v_cvt_pk_bf16_f32 v98, v100, v101
    v_cvt_pk_bf16_f32 v99, v102, v103
    v_cvt_pk_bf16_f32 v100, v104, v105
    v_cvt_pk_bf16_f32 v101, v106, v107
    v_cvt_pk_bf16_f32 v102, v108, v109
    v_cvt_pk_bf16_f32 v103, v110, v111
    v_mfma_f32_32x32x16_bf16 v[80:95], v[96:99], v[64:67], 0
    s_nop 0
    v_mfma_f32_32x32x16_bf16 v[80:95], v[100:103], v[68:71], v[80:95]
    v_mfma_f32_32x32x16_bf16 v[64:79], v[44:47], v[160:163], v[136:151]
    v_mfma_f32_32x32x16_bf16 v[96:111], v[156:159], v[48:51], 0
    v_exp_f32 v112, v112
    v_exp_f32 v113, v113
    v_exp_f32 v114, v114
    v_exp_f32 v115, v115
    v_exp_f32 v116, v116
    v_exp_f32 v117, v117
    v_exp_f32 v118, v118
    v_exp_f32 v119, v119
    v_exp_f32 v120, v120
    v_exp_f32 v121, v121
    v_exp_f32 v122, v122
    v_exp_f32 v123, v123
    v_exp_f32 v124, v124
    v_exp_f32 v125, v125
    v_exp_f32 v126, v126
    v_exp_f32 v127, v127
    v_pk_add_f32 v[8:9], v[112:113], v[114:115]
    v_pk_add_f32 v[10:11], v[116:117], v[118:119]
    v_pk_add_f32 v[8:9], v[8:9], v[120:121]
    v_pk_add_f32 v[10:11], v[10:11], v[122:123]
    v_pk_add_f32 v[8:9], v[8:9], v[124:125]
    v_pk_add_f32 v[10:11], v[10:11], v[126:127]
    v_pk_add_f32 v[8:9], v[8:9], v[10:11]
    v_add_f32 v8, v8, v9
    v_rcp_f32 v8, v8
    s_nop 0
    v_pk_mul_f32 v[112:113], v[112:113], v[8:9] op_sel_hi:[1,0]
    v_pk_mul_f32 v[114:115], v[114:115], v[8:9] op_sel_hi:[1,0]
    v_pk_mul_f32 v[116:117], v[116:117], v[8:9] op_sel_hi:[1,0]
    v_pk_mul_f32 v[118:119], v[118:119], v[8:9] op_sel_hi:[1,0]
    v_pk_mul_f32 v[120:121], v[120:121], v[8:9] op_sel_hi:[1,0]
    v_pk_mul_f32 v[122:123], v[122:123], v[8:9] op_sel_hi:[1,0]
    v_pk_mul_f32 v[124:125], v[124:125], v[8:9] op_sel_hi:[1,0]
    v_pk_mul_f32 v[126:127], v[126:127], v[8:9] op_sel_hi:[1,0]
    v_cvt_pk_bf16_f32 v128, v112, v113
    v_cvt_pk_bf16_f32 v129, v114, v115
    v_cvt_pk_bf16_f32 v130, v116, v117
    v_cvt_pk_bf16_f32 v131, v118, v119
    v_cvt_pk_bf16_f32 v132, v120, v121
    v_cvt_pk_bf16_f32 v133, v122, v123
    v_cvt_pk_bf16_f32 v134, v124, v125
    v_cvt_pk_bf16_f32 v135, v126, v127
    v_mfma_f32_32x32x16_bf16 v[112:127], v[128:131], v[160:163], 0
    s_nop 0
    v_mfma_f32_32x32x16_bf16 v[112:127], v[132:135], v[164:167], v[112:127]
    v_cvt_pk_bf16_f32 v64, v64, v65
    v_cvt_pk_bf16_f32 v65, v66, v67
    v_cvt_pk_bf16_f32 v66, v68, v69
    v_cvt_pk_bf16_f32 v67, v70, v71
    v_cvt_pk_bf16_f32 v68, v72, v73
    v_cvt_pk_bf16_f32 v69, v74, v75
    v_cvt_pk_bf16_f32 v70, v76, v77
    v_cvt_pk_bf16_f32 v71, v78, v79
    v_max3_f32 v8, v96, v97, v98
    v_max3_f32 v9, v99, v100, v101
    v_max3_f32 v10, v102, v103, v104
    v_max3_f32 v11, v105, v106, v107
    v_max3_f32 v8, v8, v108, v109
    s_barrier
    v_max3_f32 v9, v9, v110, v111
    v_max3_f32 v8, v8, v10, v11
    v_max_f32 v8, v8, v9
    v_mul_f32 v8, 0xbfb8aa3b, v8
    v_pk_fma_f32 v[96:97], v[96:97], s[38:39], v[8:9] op_sel_hi:[1,1,0]
    v_pk_fma_f32 v[98:99], v[98:99], s[38:39], v[8:9] op_sel_hi:[1,1,0]
    v_pk_fma_f32 v[100:101], v[100:101], s[38:39], v[8:9] op_sel_hi:[1,1,0]
    v_pk_fma_f32 v[102:103], v[102:103], s[38:39], v[8:9] op_sel_hi:[1,1,0]
    v_pk_fma_f32 v[104:105], v[104:105], s[38:39], v[8:9] op_sel_hi:[1,1,0]
    v_pk_fma_f32 v[106:107], v[106:107], s[38:39], v[8:9] op_sel_hi:[1,1,0]
    v_pk_fma_f32 v[108:109], v[108:109], s[38:39], v[8:9] op_sel_hi:[1,1,0]
    v_pk_fma_f32 v[110:111], v[110:111], s[38:39], v[8:9] op_sel_hi:[1,1,0]
    v_cvt_pk_bf16_f32 v112, v112, v113
    v_cvt_pk_bf16_f32 v113, v114, v115
    v_cvt_pk_bf16_f32 v114, v116, v117
    v_cvt_pk_bf16_f32 v115, v118, v119
    v_cvt_pk_bf16_f32 v116, v120, v121
    v_cvt_pk_bf16_f32 v117, v122, v123
    v_cvt_pk_bf16_f32 v118, v124, v125
    v_cvt_pk_bf16_f32 v119, v126, v127
    v_mfma_f32_32x32x16_bf16 v[80:95], v[112:115], v[64:67], v[80:95]
    s_nop 0
    v_mfma_f32_32x32x16_bf16 v[80:95], v[116:119], v[68:71], v[80:95]
    v_mfma_f32_32x32x16_bf16 v[64:79], v[52:55], v[160:163], v[136:151]
    v_mfma_f32_32x32x16_bf16 v[112:127], v[156:159], v[56:59], 0
    v_exp_f32 v96, v96
    v_exp_f32 v97, v97
    v_exp_f32 v98, v98
    v_exp_f32 v99, v99
    v_exp_f32 v100, v100
    v_exp_f32 v101, v101
    v_exp_f32 v102, v102
    v_exp_f32 v103, v103
    v_exp_f32 v104, v104
    v_exp_f32 v105, v105
    v_exp_f32 v106, v106
    v_exp_f32 v107, v107
    v_exp_f32 v108, v108
    v_exp_f32 v109, v109
    v_exp_f32 v110, v110
    v_exp_f32 v111, v111
    v_pk_add_f32 v[8:9], v[96:97], v[98:99]
    v_pk_add_f32 v[10:11], v[100:101], v[102:103]
    v_pk_add_f32 v[8:9], v[8:9], v[104:105]
    v_pk_add_f32 v[10:11], v[10:11], v[106:107]
    v_pk_add_f32 v[8:9], v[8:9], v[108:109]
    v_pk_add_f32 v[10:11], v[10:11], v[110:111]
    v_pk_add_f32 v[8:9], v[8:9], v[10:11]
    v_add_f32 v8, v8, v9
    v_rcp_f32 v8, v8
    s_nop 0
    v_pk_mul_f32 v[96:97], v[96:97], v[8:9] op_sel_hi:[1,0]
    v_pk_mul_f32 v[98:99], v[98:99], v[8:9] op_sel_hi:[1,0]
    v_pk_mul_f32 v[100:101], v[100:101], v[8:9] op_sel_hi:[1,0]
    v_pk_mul_f32 v[102:103], v[102:103], v[8:9] op_sel_hi:[1,0]
    v_pk_mul_f32 v[104:105], v[104:105], v[8:9] op_sel_hi:[1,0]
    v_pk_mul_f32 v[106:107], v[106:107], v[8:9] op_sel_hi:[1,0]
    v_pk_mul_f32 v[108:109], v[108:109], v[8:9] op_sel_hi:[1,0]
    v_pk_mul_f32 v[110:111], v[110:111], v[8:9] op_sel_hi:[1,0]
    v_cvt_pk_bf16_f32 v128, v96, v97
    v_cvt_pk_bf16_f32 v129, v98, v99
    v_cvt_pk_bf16_f32 v130, v100, v101
    v_cvt_pk_bf16_f32 v131, v102, v103
    v_cvt_pk_bf16_f32 v132, v104, v105
    v_cvt_pk_bf16_f32 v133, v106, v107
    v_cvt_pk_bf16_f32 v134, v108, v109
    v_cvt_pk_bf16_f32 v135, v110, v111
    v_mfma_f32_32x32x16_bf16 v[96:111], v[128:131], v[160:163], 0
    s_nop 0
    v_mfma_f32_32x32x16_bf16 v[96:111], v[132:135], v[164:167], v[96:111]
    v_cvt_pk_bf16_f32 v64, v64, v65
    v_cvt_pk_bf16_f32 v65, v66, v67
    v_cvt_pk_bf16_f32 v66, v68, v69
    v_cvt_pk_bf16_f32 v67, v70, v71
    v_cvt_pk_bf16_f32 v68, v72, v73
    v_cvt_pk_bf16_f32 v69, v74, v75
    v_cvt_pk_bf16_f32 v70, v76, v77
    v_cvt_pk_bf16_f32 v71, v78, v79
    v_max3_f32 v8, v112, v113, v114
    v_max3_f32 v9, v115, v116, v117
    v_max3_f32 v10, v118, v119, v120
    v_max3_f32 v11, v121, v122, v123
    v_max3_f32 v8, v8, v124, v125
    v_max3_f32 v9, v9, v126, v127
    v_max3_f32 v8, v8, v10, v11
    v_max_f32 v8, v8, v9
    v_mul_f32 v8, 0xbfb8aa3b, v8
    v_pk_fma_f32 v[112:113], v[112:113], s[38:39], v[8:9] op_sel_hi:[1,1,0]
    v_pk_fma_f32 v[114:115], v[114:115], s[38:39], v[8:9] op_sel_hi:[1,1,0]
    v_pk_fma_f32 v[116:117], v[116:117], s[38:39], v[8:9] op_sel_hi:[1,1,0]
    v_pk_fma_f32 v[118:119], v[118:119], s[38:39], v[8:9] op_sel_hi:[1,1,0]
    v_pk_fma_f32 v[120:121], v[120:121], s[38:39], v[8:9] op_sel_hi:[1,1,0]
    v_pk_fma_f32 v[122:123], v[122:123], s[38:39], v[8:9] op_sel_hi:[1,1,0]
    v_pk_fma_f32 v[124:125], v[124:125], s[38:39], v[8:9] op_sel_hi:[1,1,0]
    v_pk_fma_f32 v[126:127], v[126:127], s[38:39], v[8:9] op_sel_hi:[1,1,0]
    v_cvt_pk_bf16_f32 v96, v96, v97
    v_cvt_pk_bf16_f32 v97, v98, v99
    v_cvt_pk_bf16_f32 v98, v100, v101
    v_cvt_pk_bf16_f32 v99, v102, v103
    v_cvt_pk_bf16_f32 v100, v104, v105
    v_cvt_pk_bf16_f32 v101, v106, v107
    v_cvt_pk_bf16_f32 v102, v108, v109
    v_cvt_pk_bf16_f32 v103, v110, v111
    v_mfma_f32_32x32x16_bf16 v[80:95], v[96:99], v[64:67], v[80:95]
    s_nop 0
    v_mfma_f32_32x32x16_bf16 v[80:95], v[100:103], v[68:71], v[80:95]
    v_mfma_f32_32x32x16_bf16 v[64:79], v[60:63], v[160:163], v[136:151]
    v_exp_f32 v112, v112
    v_exp_f32 v113, v113
    s_barrier
    v_exp_f32 v114, v114
    v_exp_f32 v115, v115
    v_exp_f32 v116, v116
    v_exp_f32 v117, v117
    v_exp_f32 v118, v118
    v_exp_f32 v119, v119
    v_exp_f32 v120, v120
    v_exp_f32 v121, v121
    v_exp_f32 v122, v122
    v_exp_f32 v123, v123
    v_exp_f32 v124, v124
    v_exp_f32 v125, v125
    v_exp_f32 v126, v126
    v_exp_f32 v127, v127
    v_pk_add_f32 v[8:9], v[112:113], v[114:115]
    v_pk_add_f32 v[10:11], v[116:117], v[118:119]
    v_pk_add_f32 v[8:9], v[8:9], v[120:121]
    v_pk_add_f32 v[10:11], v[10:11], v[122:123]
    v_pk_add_f32 v[8:9], v[8:9], v[124:125]
    v_pk_add_f32 v[10:11], v[10:11], v[126:127]
    v_pk_add_f32 v[8:9], v[8:9], v[10:11]
    v_add_f32 v8, v8, v9
    v_rcp_f32 v8, v8
    s_nop 0
    v_pk_mul_f32 v[112:113], v[112:113], v[8:9] op_sel_hi:[1,0]
    v_pk_mul_f32 v[114:115], v[114:115], v[8:9] op_sel_hi:[1,0]
    v_pk_mul_f32 v[116:117], v[116:117], v[8:9] op_sel_hi:[1,0]
    v_pk_mul_f32 v[118:119], v[118:119], v[8:9] op_sel_hi:[1,0]
    v_pk_mul_f32 v[120:121], v[120:121], v[8:9] op_sel_hi:[1,0]
    v_pk_mul_f32 v[122:123], v[122:123], v[8:9] op_sel_hi:[1,0]
    v_pk_mul_f32 v[124:125], v[124:125], v[8:9] op_sel_hi:[1,0]
    v_pk_mul_f32 v[126:127], v[126:127], v[8:9] op_sel_hi:[1,0]
    v_cvt_pk_bf16_f32 v128, v112, v113
    v_cvt_pk_bf16_f32 v129, v114, v115
    v_cvt_pk_bf16_f32 v130, v116, v117
    v_cvt_pk_bf16_f32 v131, v118, v119
    v_cvt_pk_bf16_f32 v132, v120, v121
    v_cvt_pk_bf16_f32 v133, v122, v123
    v_cvt_pk_bf16_f32 v134, v124, v125
    v_cvt_pk_bf16_f32 v135, v126, v127
    v_mfma_f32_32x32x16_bf16 v[112:127], v[128:131], v[160:163], 0
    s_nop 0
    v_mfma_f32_32x32x16_bf16 v[112:127], v[132:135], v[164:167], v[112:127]
    v_cvt_pk_bf16_f32 v64, v64, v65
    v_cvt_pk_bf16_f32 v65, v66, v67
    v_cvt_pk_bf16_f32 v66, v68, v69
    v_cvt_pk_bf16_f32 v67, v70, v71
    v_cvt_pk_bf16_f32 v68, v72, v73
    v_cvt_pk_bf16_f32 v69, v74, v75
    v_cvt_pk_bf16_f32 v70, v76, v77
    v_cvt_pk_bf16_f32 v71, v78, v79
    s_nop 3
    v_cvt_pk_bf16_f32 v112, v112, v113
    v_cvt_pk_bf16_f32 v113, v114, v115
    v_cvt_pk_bf16_f32 v114, v116, v117
    v_cvt_pk_bf16_f32 v115, v118, v119
    v_cvt_pk_bf16_f32 v116, v120, v121
    v_cvt_pk_bf16_f32 v117, v122, v123
    v_cvt_pk_bf16_f32 v118, v124, v125
    v_cvt_pk_bf16_f32 v119, v126, v127
    v_mfma_f32_32x32x16_bf16 v[80:95], v[112:115], v[64:67], v[80:95]
    s_nop 0
    v_mfma_f32_32x32x16_bf16 v[80:95], v[116:119], v[68:71], v[80:95]
    s_nop 11
    v_cvt_pk_bf16_f32 v80, v80, v81
    v_cvt_pk_bf16_f32 v81, v82, v83
    v_cvt_pk_bf16_f32 v82, v84, v85
    v_cvt_pk_bf16_f32 v83, v86, v87
    v_cvt_pk_bf16_f32 v84, v88, v89
    v_cvt_pk_bf16_f32 v85, v90, v91
    v_cvt_pk_bf16_f32 v86, v92, v93
    v_cvt_pk_bf16_f32 v87, v94, v95
    s_mov_b32 exec_lo, 0x1ffff
    s_mov_b32 exec_hi, 0x1ffff
    buffer_store_dwordx4 v[80:83], v2, s[56:59], s26 offen sc1
    buffer_store_dwordx4 v[84:87], v3, s[56:59], s26 offen sc1
    s_mov_b64 exec, -1
    s_waitcnt lgkmcnt(0)
    s_cmp_lg_u32 s15, 0
    s_cbranch_scc1 L_nok_126
    s_mov_b32 s100, 0
L_nlp_127:
    s_sleep 16
    v_mov_b32 v17, 0
    global_load_dword v17, v17, s[34:35] sc1
    s_waitcnt vmcnt(0)
    s_nop 0
    v_readfirstlane_b32 s15, v17
    s_add_u32 s100, s100, 1
    s_cmp_ge_u32 s100, 20000
    s_cbranch_scc1 L_nok_126
    s_cmp_eq_u32 s15, 0
    s_cbranch_scc1 L_nlp_127
L_nok_126:
    v_mov_b32 v17, s15
    s_setprio 0
    s_lshl_b32 s12, s10, 2
    s_add_u32 s12, s12, 161824
    v_mov_b32 v8, s12
    v_lshlrev_b32 v9, 2, v0
    v_add_u32 v9, 162816, v9
    v_cmp_eq_u32 vcc, 0, v0
    v_mov_b32 v16, 161792
    s_mov_b32 s95, 0
    v_cndmask_b32 v7, v9, v8, vcc
    s_barrier
    s_getreg_b32 s11, hwreg(HW_REG_IB_STS, 0, 4)
    s_getreg_b32 s12, hwreg(HW_REG_IB_STS, 22, 2)
    s_or_b32 s11, s11, s29
    s_lshl4_add_u32 s11, s12, s11
    s_cmp_gt_u32 s11, 0
    s_cbranch_scc1 L_fl_128
    s_waitcnt vmcnt(0)
    s_mov_b64 exec, 1
    buffer_store_dword v17, off, s[56:59], s25 sc1
    s_mov_b64 exec, -1
    s_movk_i32 s29, 0x100
L_fl_128:
    s_barrier
    s_getreg_b32 s11, hwreg(HW_REG_IB_STS, 0, 4)
    s_getreg_b32 s12, hwreg(HW_REG_IB_STS, 22, 2)
    s_or_b32 s11, s11, s29
    s_lshl4_add_u32 s11, s12, s11
    s_cmp_gt_u32 s11, 0
    s_cbranch_scc1 L_fl_129
    s_waitcnt vmcnt(0)
    s_mov_b64 exec, 1
    buffer_store_dword v17, off, s[56:59], s25 sc1
    s_mov_b64 exec, -1
    s_movk_i32 s29, 0x100
L_fl_129:
    s_barrier
    s_getreg_b32 s11, hwreg(HW_REG_IB_STS, 0, 4)
    s_getreg_b32 s12, hwreg(HW_REG_IB_STS, 22, 2)
    s_or_b32 s11, s11, s29
    s_lshl4_add_u32 s11, s12, s11
    s_cmp_gt_u32 s11, 0
    s_cbranch_scc1 L_fl_130
    s_waitcnt vmcnt(0)
    s_mov_b64 exec, 1
    buffer_store_dword v17, off, s[56:59], s25 sc1
    s_mov_b64 exec, -1
    s_movk_i32 s29, 0x100
L_fl_130:
    s_barrier
    s_getreg_b32 s11, hwreg(HW_REG_IB_STS, 0, 4)
    s_getreg_b32 s12, hwreg(HW_REG_IB_STS, 22, 2)
    s_or_b32 s11, s11, s29
    s_lshl4_add_u32 s11, s12, s11
    s_cmp_gt_u32 s11, 0
    s_cbranch_scc1 L_fl_131
    s_waitcnt vmcnt(0)
    s_mov_b64 exec, 1
    buffer_store_dword v17, off, s[56:59], s25 sc1
    s_mov_b64 exec, -1
    s_movk_i32 s29, 0x100
L_fl_131:
    s_barrier
    s_getreg_b32 s11, hwreg(HW_REG_IB_STS, 0, 4)
    s_getreg_b32 s12, hwreg(HW_REG_IB_STS, 22, 2)
    s_or_b32 s11, s11, s29
    s_lshl4_add_u32 s11, s12, s11
    s_cmp_gt_u32 s11, 0
    s_cbranch_scc1 L_fl_132
    s_waitcnt vmcnt(0)
    s_mov_b64 exec, 1
    buffer_store_dword v17, off, s[56:59], s25 sc1
    s_mov_b64 exec, -1
    s_movk_i32 s29, 0x100
L_fl_132:
    s_barrier
    s_getreg_b32 s11, hwreg(HW_REG_IB_STS, 0, 4)
    s_getreg_b32 s12, hwreg(HW_REG_IB_STS, 22, 2)
    s_or_b32 s11, s11, s29
    s_lshl4_add_u32 s11, s12, s11
    s_cmp_gt_u32 s11, 0
    s_cbranch_scc1 L_fl_133
    s_waitcnt vmcnt(0)
    s_mov_b64 exec, 1
    buffer_store_dword v17, off, s[56:59], s25 sc1
    s_mov_b64 exec, -1
    s_movk_i32 s29, 0x100
L_fl_133:
    s_barrier
    s_getreg_b32 s11, hwreg(HW_REG_IB_STS, 0, 4)
    s_getreg_b32 s12, hwreg(HW_REG_IB_STS, 22, 2)
    s_or_b32 s11, s11, s29
    s_lshl4_add_u32 s11, s12, s11
    s_cmp_gt_u32 s11, 0
    s_cbranch_scc1 L_fl_134
    s_waitcnt vmcnt(0)
    s_mov_b64 exec, 1
    buffer_store_dword v17, off, s[56:59], s25 sc1
    s_mov_b64 exec, -1
    s_movk_i32 s29, 0x100
L_fl_134:
    s_barrier
    s_getreg_b32 s11, hwreg(HW_REG_IB_STS, 0, 4)
    s_getreg_b32 s12, hwreg(HW_REG_IB_STS, 22, 2)
    s_or_b32 s11, s11, s29
    s_lshl4_add_u32 s11, s12, s11
    s_cmp_gt_u32 s11, 0
    s_cbranch_scc1 L_fl_135
    s_waitcnt vmcnt(0)
    s_mov_b64 exec, 1
    buffer_store_dword v17, off, s[56:59], s25 sc1
    s_mov_b64 exec, -1
    s_movk_i32 s29, 0x100
L_fl_135:
    s_barrier
    s_getreg_b32 s11, hwreg(HW_REG_IB_STS, 0, 4)
    s_getreg_b32 s12, hwreg(HW_REG_IB_STS, 22, 2)
    s_or_b32 s11, s11, s29
    s_lshl4_add_u32 s11, s12, s11
    s_cmp_gt_u32 s11, 0
    s_cbranch_scc1 L_fl_136
    s_waitcnt vmcnt(0)
    s_mov_b64 exec, 1
    buffer_store_dword v17, off, s[56:59], s25 sc1
    s_mov_b64 exec, -1
    s_movk_i32 s29, 0x100
L_fl_136:
    s_barrier
    s_getreg_b32 s11, hwreg(HW_REG_IB_STS, 0, 4)
    s_getreg_b32 s12, hwreg(HW_REG_IB_STS, 22, 2)
    s_or_b32 s11, s11, s29
    s_lshl4_add_u32 s11, s12, s11
    s_cmp_gt_u32 s11, 0
    s_cbranch_scc1 L_fl_137
    s_waitcnt vmcnt(0)
    s_mov_b64 exec, 1
    buffer_store_dword v17, off, s[56:59], s25 sc1
    s_mov_b64 exec, -1
    s_movk_i32 s29, 0x100
L_fl_137:
    s_barrier
    s_getreg_b32 s11, hwreg(HW_REG_IB_STS, 0, 4)
    s_getreg_b32 s12, hwreg(HW_REG_IB_STS, 22, 2)
    s_or_b32 s11, s11, s29
    s_lshl4_add_u32 s11, s12, s11
    s_cmp_gt_u32 s11, 0
    s_cbranch_scc1 L_fl_138
    s_waitcnt vmcnt(0)
    s_mov_b64 exec, 1
    buffer_store_dword v17, off, s[56:59], s25 sc1
    s_mov_b64 exec, -1
    s_movk_i32 s29, 0x100
L_fl_138:
    s_barrier
    s_getreg_b32 s11, hwreg(HW_REG_IB_STS, 0, 4)
    s_getreg_b32 s12, hwreg(HW_REG_IB_STS, 22, 2)
    s_or_b32 s11, s11, s29
    s_lshl4_add_u32 s11, s12, s11
    s_cmp_gt_u32 s11, 0
    s_cbranch_scc1 L_fl_139
    s_waitcnt vmcnt(0)
    s_mov_b64 exec, 1
    buffer_store_dword v17, off, s[56:59], s25 sc1
    s_mov_b64 exec, -1
    s_movk_i32 s29, 0x100
L_fl_139:
    s_barrier
    s_waitcnt vmcnt(0)
    s_cmp_lg_u32 s29, 0
    s_cbranch_scc1 L_fl_140
    s_waitcnt vmcnt(0)
    s_mov_b64 exec, 1
    buffer_store_dword v17, off, s[56:59], s25 sc1
    s_mov_b64 exec, -1
    s_movk_i32 s29, 0x100
L_fl_140:
    s_cmp_ge_u32 s95, 1
    s_cbranch_scc1 L_cs_142
    s_mov_b32 s100, 0
L_cl_141:
    ds_read_b128 v[12:15], v16 offset:0
    s_add_u32 s100, s100, 1
    s_waitcnt lgkmcnt(0)
    v_min3_u32 v12, v12, v13, v14
    v_min_u32 v12, v12, v15
    s_nop 0
    v_readfirstlane_b32 s95, v12
    s_cmp_ge_u32 s100, 0x40000
    s_cbranch_scc1 L_cs_142
    s_cmp_lt_u32 s95, 1
    s_cbranch_scc1 L_cl_141
L_cs_142:
    ds_read_b128 v[96:99], v26 offset:16384
    ds_read_b64_tr_b16 v[100:101], v28 offset:0
    ds_read_b64_tr_b16 v[102:103], v28 offset:512
    ds_read_b128 v[104:107], v26 offset:17408
    ds_read_b64_tr_b16 v[108:109], v28 offset:2048
    ds_read_b64_tr_b16 v[110:111], v28 offset:2560
    s_waitcnt lgkmcnt(3)
    v_mfma_f32_32x32x16_bf16 v[32:47], v[100:103], v[96:99], 0
    ds_read_b128 v[112:115], v26 offset:18432
    ds_read_b64_tr_b16 v[116:117], v28 offset:4096
    ds_read_b64_tr_b16 v[118:119], v28 offset:4608
    ds_read_b128 v[120:123], v26 offset:19456
    ds_read_b64_tr_b16 v[124:125], v28 offset:6144
    ds_read_b64_tr_b16 v[126:127], v28 offset:6656
    s_waitcnt lgkmcnt(6)
    v_mfma_f32_32x32x16_bf16 v[32:47], v[108:111], v[104:107], v[32:47]
    ds_read_b128 v[128:131], v26 offset:24576
    ds_read_b64_tr_b16 v[132:133], v28 offset:49152
    ds_read_b64_tr_b16 v[134:135], v28 offset:49664
    ds_read_b128 v[136:139], v26 offset:25600
    ds_read_b64_tr_b16 v[140:141], v28 offset:51200
    ds_read_b64_tr_b16 v[142:143], v28 offset:51712
    s_waitcnt lgkmcnt(9)
    v_mfma_f32_32x32x16_bf16 v[32:47], v[116:119], v[112:115], v[32:47]
    ds_read_b128 v[144:147], v26 offset:26624
    ds_read_b64_tr_b16 v[148:149], v28 offset:53248
    ds_read_b64_tr_b16 v[150:151], v28 offset:53760
    ds_read_b128 v[152:155], v26 offset:27648
    ds_read_b64_tr_b16 v[156:157], v28 offset:55296
    ds_read_b64_tr_b16 v[158:159], v28 offset:55808
    s_waitcnt lgkmcnt(12)
    v_mfma_f32_32x32x16_bf16 v[32:47], v[124:127], v[120:123], v[32:47]
    ds_read_b128 v[96:99], v29 offset:24576
    ds_read_b64_tr_b16 v[100:101], v28 offset:57344
    ds_read_b64_tr_b16 v[102:103], v28 offset:57856
    s_waitcnt lgkmcnt(12)
    v_mfma_f32_32x32x16_bf16 v[32:47], v[132:135], v[128:131], v[32:47]
    ds_read_b128 v[104:107], v29 offset:25600
    ds_read_b64_tr_b16 v[108:109], v28 offset:59392
    ds_read_b64_tr_b16 v[110:111], v28 offset:59904
    s_waitcnt lgkmcnt(12)
    v_mfma_f32_32x32x16_bf16 v[32:47], v[140:143], v[136:139], v[32:47]
    ds_read_b128 v[112:115], v29 offset:26624
    ds_read_b64_tr_b16 v[116:117], v28 offset:61440
    ds_read_b64_tr_b16 v[118:119], v28 offset:61952
    s_waitcnt lgkmcnt(12)
    v_mfma_f32_32x32x16_bf16 v[32:47], v[148:151], v[144:147], v[32:47]
    ds_read_b128 v[120:123], v29 offset:27648
    ds_read_b64_tr_b16 v[124:125], v28 offset:63488
    ds_read_b64_tr_b16 v[126:127], v28 offset:64000
    s_waitcnt lgkmcnt(12)
    v_mfma_f32_32x32x16_bf16 v[32:47], v[156:159], v[152:155], v[32:47]
    s_waitcnt lgkmcnt(9)
    v_mfma_f32_32x32x16_bf16 v[32:47], v[100:103], v[96:99], v[32:47]
    s_waitcnt lgkmcnt(6)
    v_mfma_f32_32x32x16_bf16 v[32:47], v[108:111], v[104:107], v[32:47]
    ds_read_b128 v[12:15], v16 offset:0
    s_waitcnt lgkmcnt(0)
    v_mov_b32 v11, 1
    ds_write_b32 v7, v11 offset:0
    v_min3_u32 v12, v12, v13, v14
    v_min_u32 v12, v12, v15
    s_nop 0
    v_readfirstlane_b32 s95, v12
    s_nop 0
    s_cmp_ge_u32 s95, 2
    s_cbranch_scc1 L_cs_144
    s_mov_b32 s100, 0
L_cl_143:
    ds_read_b128 v[12:15], v16 offset:0
    s_add_u32 s100, s100, 1
    s_waitcnt lgkmcnt(0)
    v_min3_u32 v12, v12, v13, v14
    v_min_u32 v12, v12, v15
    s_nop 0
    v_readfirstlane_b32 s95, v12
    s_cmp_ge_u32 s100, 0x40000
    s_cbranch_scc1 L_cs_144
    s_cmp_lt_u32 s95, 2
    s_cbranch_scc1 L_cl_143
L_cs_144:
    v_mfma_f32_32x32x16_bf16 v[32:47], v[116:119], v[112:115], v[32:47]
    ds_read_b128 v[128:131], v27 offset:0
    ds_read_b64_tr_b16 v[132:133], v28 offset:8192
    ds_read_b64_tr_b16 v[134:135], v28 offset:8704
    ds_read_b128 v[136:139], v27 offset:1024
    ds_read_b64_tr_b16 v[140:141], v28 offset:10240
    ds_read_b64_tr_b16 v[142:143], v28 offset:10752
    v_mfma_f32_32x32x16_bf16 v[32:47], v[124:127], v[120:123], v[32:47]
    ds_read_b128 v[144:147], v27 offset:2048
    ds_read_b64_tr_b16 v[148:149], v28 offset:12288
    ds_read_b64_tr_b16 v[150:151], v28 offset:12800
    ds_read_b128 v[152:155], v27 offset:3072
    ds_read_b64_tr_b16 v[156:157], v28 offset:14336
    ds_read_b64_tr_b16 v[158:159], v28 offset:14848
    s_waitcnt lgkmcnt(9)
    v_mfma_f32_32x32x16_bf16 v[32:47], v[132:135], v[128:131], v[32:47]
    ds_read_b128 v[96:99], v26 offset:32768
    ds_read_b64_tr_b16 v[100:101], v1 offset:16384
    ds_read_b64_tr_b16 v[102:103], v1 offset:16896
    ds_read_b128 v[104:107], v26 offset:33792
    ds_read_b64_tr_b16 v[108:109], v1 offset:18432
    ds_read_b64_tr_b16 v[110:111], v1 offset:18944
    s_waitcnt lgkmcnt(12)
    v_mfma_f32_32x32x16_bf16 v[32:47], v[140:143], v[136:139], v[32:47]
    ds_read_b128 v[112:115], v26 offset:34816
    ds_read_b64_tr_b16 v[116:117], v1 offset:20480
    ds_read_b64_tr_b16 v[118:119], v1 offset:20992
    s_waitcnt lgkmcnt(12)
    v_mfma_f32_32x32x16_bf16 v[32:47], v[148:151], v[144:147], v[32:47]
    ds_read_b128 v[120:123], v26 offset:35840
    ds_read_b64_tr_b16 v[124:125], v1 offset:22528
    ds_read_b64_tr_b16 v[126:127], v1 offset:23040
    s_waitcnt lgkmcnt(12)
    v_mfma_f32_32x32x16_bf16 v[32:47], v[156:159], v[152:155], v[32:47]
    ds_read_b128 v[128:131], v26 offset:40960
    ds_read_b64_tr_b16 v[132:133], v20 offset:0
    ds_read_b64_tr_b16 v[134:135], v20 offset:512
    s_waitcnt lgkmcnt(12)
    v_mfma_f32_32x32x16_bf16 v[32:47], v[100:103], v[96:99], v[32:47]
    ds_read_b128 v[136:139], v26 offset:41984
    ds_read_b64_tr_b16 v[140:141], v20 offset:2048
    ds_read_b64_tr_b16 v[142:143], v20 offset:2560
    s_waitcnt lgkmcnt(12)
    v_mfma_f32_32x32x16_bf16 v[32:47], v[108:111], v[104:107], v[32:47]
    ds_read_b128 v[144:147], v26 offset:43008
    ds_read_b64_tr_b16 v[148:149], v20 offset:4096
    ds_read_b64_tr_b16 v[150:151], v20 offset:4608
    s_waitcnt lgkmcnt(12)
    v_mfma_f32_32x32x16_bf16 v[32:47], v[116:119], v[112:115], v[32:47]
    ds_read_b128 v[152:155], v26 offset:44032
    ds_read_b64_tr_b16 v[156:157], v20 offset:6144
    ds_read_b64_tr_b16 v[158:159], v20 offset:6656
    s_waitcnt lgkmcnt(12)
    v_mfma_f32_32x32x16_bf16 v[32:47], v[124:127], v[120:123], v[32:47]
    s_waitcnt lgkmcnt(9)
    v_mfma_f32_32x32x16_bf16 v[32:47], v[132:135], v[128:131], v[32:47]
    s_waitcnt lgkmcnt(6)
    v_mfma_f32_32x32x16_bf16 v[32:47], v[140:143], v[136:139], v[32:47]
    s_waitcnt lgkmcnt(0)
    s_barrier
    v_mfma_f32_32x32x16_bf16 v[32:47], v[148:151], v[144:147], v[32:47]
    ds_read_b128 v[96:99], v27 offset:8192
    ds_read_b64_tr_b16 v[100:101], v20 offset:8192
    ds_read_b64_tr_b16 v[102:103], v20 offset:8704
    ds_read_b128 v[104:107], v27 offset:9216
    ds_read_b64_tr_b16 v[108:109], v20 offset:10240
    ds_read_b64_tr_b16 v[110:111], v20 offset:10752
    v_mfma_f32_32x32x16_bf16 v[32:47], v[156:159], v[152:155], v[32:47]
    ds_read_b128 v[112:115], v27 offset:10240
    ds_read_b64_tr_b16 v[116:117], v20 offset:12288
    ds_read_b64_tr_b16 v[118:119], v20 offset:12800
    ds_read_b128 v[120:123], v27 offset:11264
    ds_read_b64_tr_b16 v[124:125], v20 offset:14336
    ds_read_b64_tr_b16 v[126:127], v20 offset:14848
    s_waitcnt lgkmcnt(9)
    v_mfma_f32_32x32x16_bf16 v[32:47], v[100:103], v[96:99], v[32:47]
    ds_read_b128 v[128:131], v29 offset:32768
    ds_read_b64_tr_b16 v[132:133], v28 offset:16384
    ds_read_b64_tr_b16 v[134:135], v28 offset:16896
    ds_read_b128 v[136:139], v29 offset:33792
    ds_read_b64_tr_b16 v[140:141], v28 offset:18432
    ds_read_b64_tr_b16 v[142:143], v28 offset:18944
    s_waitcnt lgkmcnt(12)
    v_mfma_f32_32x32x16_bf16 v[32:47], v[108:111], v[104:107], v[32:47]
    ds_read_b128 v[144:147], v29 offset:34816
    ds_read_b64_tr_b16 v[148:149], v28 offset:20480
    ds_read_b64_tr_b16 v[150:151], v28 offset:20992
    s_waitcnt lgkmcnt(12)
    v_mfma_f32_32x32x16_bf16 v[32:47], v[116:119], v[112:115], v[32:47]
    ds_read_b128 v[152:155], v29 offset:35840
    ds_read_b64_tr_b16 v[156:157], v28 offset:22528
    ds_read_b64_tr_b16 v[158:159], v28 offset:23040
    s_waitcnt lgkmcnt(12)
    v_mfma_f32_32x32x16_bf16 v[32:47], v[124:127], v[120:123], v[32:47]
    ds_read_b128 v[96:99], v26 offset:16384
    ds_read_b64_tr_b16 v[100:101], v20 offset:49152
    ds_read_b64_tr_b16 v[102:103], v20 offset:49664
    s_waitcnt lgkmcnt(12)
    v_mfma_f32_32x32x16_bf16 v[32:47], v[132:135], v[128:131], v[32:47]
    ds_read_b128 v[104:107], v26 offset:17408
    ds_read_b64_tr_b16 v[108:109], v20 offset:51200
    ds_read_b64_tr_b16 v[110:111], v20 offset:51712
    s_waitcnt lgkmcnt(12)
    v_mfma_f32_32x32x16_bf16 v[32:47], v[140:143], v[136:139], v[32:47]
    ds_read_b128 v[112:115], v26 offset:18432
    ds_read_b64_tr_b16 v[116:117], v20 offset:53248
    ds_read_b64_tr_b16 v[118:119], v20 offset:53760
    s_waitcnt lgkmcnt(12)
    v_mfma_f32_32x32x16_bf16 v[32:47], v[148:151], v[144:147], v[32:47]
    ds_read_b128 v[120:123], v26 offset:19456
    ds_read_b64_tr_b16 v[124:125], v20 offset:55296
    ds_read_b64_tr_b16 v[126:127], v20 offset:55808
    s_waitcnt lgkmcnt(12)
    v_mfma_f32_32x32x16_bf16 v[32:47], v[156:159], v[152:155], v[32:47]
    s_waitcnt lgkmcnt(9)
    v_mfma_f32_32x32x16_bf16 v[32:47], v[100:103], v[96:99], v[32:47]
    s_waitcnt lgkmcnt(6)
    v_mfma_f32_32x32x16_bf16 v[32:47], v[108:111], v[104:107], v[32:47]
    s_waitcnt lgkmcnt(0)
    s_barrier
    v_mfma_f32_32x32x16_bf16 v[32:47], v[116:119], v[112:115], v[32:47]
    ds_read_b128 v[128:131], v29 offset:0
    ds_read_b64_tr_b16 v[132:133], v20 offset:57344
    ds_read_b64_tr_b16 v[134:135], v20 offset:57856
    ds_read_b128 v[136:139], v29 offset:1024
    ds_read_b64_tr_b16 v[140:141], v20 offset:59392
    ds_read_b64_tr_b16 v[142:143], v20 offset:59904
    v_mfma_f32_32x32x16_bf16 v[32:47], v[124:127], v[120:123], v[32:47]
    ds_read_b128 v[144:147], v29 offset:2048
    ds_read_b64_tr_b16 v[148:149], v20 offset:61440
    ds_read_b64_tr_b16 v[150:151], v20 offset:61952
    ds_read_b128 v[152:155], v29 offset:3072
    ds_read_b64_tr_b16 v[156:157], v20 offset:63488
    ds_read_b64_tr_b16 v[158:159], v20 offset:64000
    s_waitcnt lgkmcnt(9)
    v_mfma_f32_32x32x16_bf16 v[32:47], v[132:135], v[128:131], v[32:47]
    ds_read_b128 v[96:99], v26 offset:24576
    ds_read_b64_tr_b16 v[100:101], v28 offset:40960
    ds_read_b64_tr_b16 v[102:103], v28 offset:41472
    ds_read_b128 v[104:107], v26 offset:25600
    ds_read_b64_tr_b16 v[108:109], v28 offset:43008
    ds_read_b64_tr_b16 v[110:111], v28 offset:43520
    s_waitcnt lgkmcnt(12)
    v_mfma_f32_32x32x16_bf16 v[32:47], v[140:143], v[136:139], v[32:47]
    ds_read_b128 v[112:115], v26 offset:26624
    ds_read_b64_tr_b16 v[116:117], v28 offset:45056
    ds_read_b64_tr_b16 v[118:119], v28 offset:45568
    s_waitcnt lgkmcnt(12)
    v_mfma_f32_32x32x16_bf16 v[32:47], v[148:151], v[144:147], v[32:47]
    ds_read_b128 v[120:123], v26 offset:27648
    ds_read_b64_tr_b16 v[124:125], v28 offset:47104
    ds_read_b64_tr_b16 v[126:127], v28 offset:47616
    s_waitcnt lgkmcnt(12)
    v_mfma_f32_32x32x16_bf16 v[32:47], v[156:159], v[152:155], v[32:47]
    ds_read_b128 v[128:131], v27 offset:0
    ds_read_b64_tr_b16 v[132:133], v28 offset:49152
    ds_read_b64_tr_b16 v[134:135], v28 offset:49664
    s_waitcnt lgkmcnt(12)
    v_mfma_f32_32x32x16_bf16 v[32:47], v[100:103], v[96:99], v[32:47]
    ds_read_b128 v[136:139], v27 offset:1024
    ds_read_b64_tr_b16 v[140:141], v28 offset:51200
    ds_read_b64_tr_b16 v[142:143], v28 offset:51712
    s_waitcnt lgkmcnt(12)
    v_mfma_f32_32x32x16_bf16 v[32:47], v[108:111], v[104:107], v[32:47]
    ds_read_b128 v[144:147], v27 offset:2048
    ds_read_b64_tr_b16 v[148:149], v28 offset:53248
    ds_read_b64_tr_b16 v[150:151], v28 offset:53760
    s_waitcnt lgkmcnt(12)
    v_mfma_f32_32x32x16_bf16 v[32:47], v[116:119], v[112:115], v[32:47]
    ds_read_b128 v[152:155], v27 offset:3072
    ds_read_b64_tr_b16 v[156:157], v28 offset:55296
    ds_read_b64_tr_b16 v[158:159], v28 offset:55808
    s_waitcnt lgkmcnt(12)
    v_mfma_f32_32x32x16_bf16 v[32:47], v[124:127], v[120:123], v[32:47]
    s_waitcnt lgkmcnt(9)
    v_mfma_f32_32x32x16_bf16 v[32:47], v[132:135], v[128:131], v[32:47]
    s_waitcnt lgkmcnt(6)
    v_mfma_f32_32x32x16_bf16 v[32:47], v[140:143], v[136:139], v[32:47]
    s_waitcnt lgkmcnt(0)
    s_barrier
    v_mfma_f32_32x32x16_bf16 v[32:47], v[148:151], v[144:147], v[32:47]
    ds_read_b128 v[96:99], v29 offset:8192
    ds_read_b64_tr_b16 v[100:101], v28 offset:24576
    ds_read_b64_tr_b16 v[102:103], v28 offset:25088
    ds_read_b128 v[104:107], v29 offset:9216
    ds_read_b64_tr_b16 v[108:109], v28 offset:26624
    ds_read_b64_tr_b16 v[110:111], v28 offset:27136
    v_mfma_f32_32x32x16_bf16 v[32:47], v[156:159], v[152:155], v[32:47]
    ds_read_b128 v[112:115], v29 offset:10240
    ds_read_b64_tr_b16 v[116:117], v28 offset:28672
    ds_read_b64_tr_b16 v[118:119], v28 offset:29184
    ds_read_b128 v[120:123], v29 offset:11264
    ds_read_b64_tr_b16 v[124:125], v28 offset:30720
    ds_read_b64_tr_b16 v[126:127], v28 offset:31232
    s_waitcnt lgkmcnt(9)
    v_mfma_f32_32x32x16_bf16 v[32:47], v[100:103], v[96:99], v[32:47]
    ds_read_b128 v[128:131], v26 offset:32768
    ds_read_b64_tr_b16 v[132:133], v28 offset:57344
    ds_read_b64_tr_b16 v[134:135], v28 offset:57856
    ds_read_b128 v[136:139], v26 offset:33792
    ds_read_b64_tr_b16 v[140:141], v28 offset:59392
    ds_read_b64_tr_b16 v[142:143], v28 offset:59904
    s_waitcnt lgkmcnt(12)
    v_mfma_f32_32x32x16_bf16 v[32:47], v[108:111], v[104:107], v[32:47]
    ds_read_b128 v[144:147], v26 offset:34816
    ds_read_b64_tr_b16 v[148:149], v28 offset:61440
    ds_read_b64_tr_b16 v[150:151], v28 offset:61952
    s_waitcnt lgkmcnt(12)
    v_mfma_f32_32x32x16_bf16 v[32:47], v[116:119], v[112:115], v[32:47]
    ds_read_b128 v[152:155], v26 offset:35840
    ds_read_b64_tr_b16 v[156:157], v28 offset:63488
    ds_read_b64_tr_b16 v[158:159], v28 offset:64000
    s_waitcnt lgkmcnt(12)
    v_mfma_f32_32x32x16_bf16 v[32:47], v[124:127], v[120:123], v[32:47]
    ds_read_b128 v[96:99], v27 offset:8192
    ds_read_b64_tr_b16 v[100:101], v1 offset:16384
    ds_read_b64_tr_b16 v[102:103], v1 offset:16896
    s_waitcnt lgkmcnt(12)
    v_mfma_f32_32x32x16_bf16 v[32:47], v[132:135], v[128:131], v[32:47]
    ds_read_b128 v[104:107], v27 offset:9216
    ds_read_b64_tr_b16 v[108:109], v1 offset:18432
    ds_read_b64_tr_b16 v[110:111], v1 offset:18944
    s_waitcnt lgkmcnt(12)
    v_mfma_f32_32x32x16_bf16 v[32:47], v[140:143], v[136:139], v[32:47]
    ds_read_b128 v[112:115], v27 offset:10240
    ds_read_b64_tr_b16 v[116:117], v1 offset:20480
    ds_read_b64_tr_b16 v[118:119], v1 offset:20992
    s_waitcnt lgkmcnt(12)
    v_mfma_f32_32x32x16_bf16 v[32:47], v[148:151], v[144:147], v[32:47]
    ds_read_b128 v[120:123], v27 offset:11264
    ds_read_b64_tr_b16 v[124:125], v1 offset:22528
    ds_read_b64_tr_b16 v[126:127], v1 offset:23040
    s_waitcnt lgkmcnt(12)
    v_mfma_f32_32x32x16_bf16 v[32:47], v[156:159], v[152:155], v[32:47]
    s_waitcnt lgkmcnt(9)
    v_mfma_f32_32x32x16_bf16 v[32:47], v[100:103], v[96:99], v[32:47]
    s_waitcnt lgkmcnt(6)
    v_mfma_f32_32x32x16_bf16 v[32:47], v[108:111], v[104:107], v[32:47]
    s_waitcnt lgkmcnt(0)
    s_barrier
    v_mfma_f32_32x32x16_bf16 v[32:47], v[116:119], v[112:115], v[32:47]
    ds_read_b128 v[128:131], v26 offset:8192
    ds_read_b64_tr_b16 v[132:133], v20 offset:40960
    ds_read_b64_tr_b16 v[134:135], v20 offset:41472
    ds_read_b128 v[136:139], v26 offset:9216
    ds_read_b64_tr_b16 v[140:141], v20 offset:43008
    ds_read_b64_tr_b16 v[142:143], v20 offset:43520
    v_mfma_f32_32x32x16_bf16 v[32:47], v[124:127], v[120:123], v[32:47]
    ds_read_b128 v[144:147], v26 offset:10240
    ds_read_b64_tr_b16 v[148:149], v20 offset:45056
    ds_read_b64_tr_b16 v[150:151], v20 offset:45568
    ds_read_b128 v[152:155], v26 offset:11264
    ds_read_b64_tr_b16 v[156:157], v20 offset:47104
    ds_read_b64_tr_b16 v[158:159], v20 offset:47616
    s_waitcnt lgkmcnt(9)
    v_mfma_f32_32x32x16_bf16 v[32:47], v[132:135], v[128:131], v[32:47]
    ds_read_b128 v[96:99], v29 offset:32768
    ds_read_b64_tr_b16 v[100:101], v20 offset:0
    ds_read_b64_tr_b16 v[102:103], v20 offset:512
    ds_read_b128 v[104:107], v29 offset:33792
    ds_read_b64_tr_b16 v[108:109], v20 offset:2048
    ds_read_b64_tr_b16 v[110:111], v20 offset:2560
    s_waitcnt lgkmcnt(12)
    v_mfma_f32_32x32x16_bf16 v[32:47], v[140:143], v[136:139], v[32:47]
    ds_read_b128 v[112:115], v29 offset:34816
    ds_read_b64_tr_b16 v[116:117], v20 offset:4096
    ds_read_b64_tr_b16 v[118:119], v20 offset:4608
    s_waitcnt lgkmcnt(12)
    v_mfma_f32_32x32x16_bf16 v[32:47], v[148:151], v[144:147], v[32:47]
    ds_read_b128 v[120:123], v29 offset:35840
    ds_read_b64_tr_b16 v[124:125], v20 offset:6144
    ds_read_b64_tr_b16 v[126:127], v20 offset:6656
    s_waitcnt lgkmcnt(12)
    v_mfma_f32_32x32x16_bf16 v[32:47], v[156:159], v[152:155], v[32:47]
    ds_read_b128 v[128:131], v29 offset:0
    ds_read_b64_tr_b16 v[132:133], v28 offset:16384
    ds_read_b64_tr_b16 v[134:135], v28 offset:16896
    s_waitcnt lgkmcnt(12)
    v_mfma_f32_32x32x16_bf16 v[32:47], v[100:103], v[96:99], v[32:47]
    ds_read_b128 v[136:139], v29 offset:1024
    ds_read_b64_tr_b16 v[140:141], v28 offset:18432
    ds_read_b64_tr_b16 v[142:143], v28 offset:18944
    s_waitcnt lgkmcnt(12)
    v_mfma_f32_32x32x16_bf16 v[32:47], v[108:111], v[104:107], v[32:47]
    ds_read_b128 v[144:147], v29 offset:2048
    ds_read_b64_tr_b16 v[148:149], v28 offset:20480
    ds_read_b64_tr_b16 v[150:151], v28 offset:20992
    s_waitcnt lgkmcnt(12)
    v_mfma_f32_32x32x16_bf16 v[32:47], v[116:119], v[112:115], v[32:47]
    ds_read_b128 v[152:155], v29 offset:3072
    ds_read_b64_tr_b16 v[156:157], v28 offset:22528
    ds_read_b64_tr_b16 v[158:159], v28 offset:23040
    s_waitcnt lgkmcnt(12)
    v_mfma_f32_32x32x16_bf16 v[32:47], v[124:127], v[120:123], v[32:47]
    s_waitcnt lgkmcnt(9)
    v_mfma_f32_32x32x16_bf16 v[32:47], v[132:135], v[128:131], v[32:47]
    s_waitcnt lgkmcnt(6)
    v_mfma_f32_32x32x16_bf16 v[32:47], v[140:143], v[136:139], v[32:47]
    s_waitcnt lgkmcnt(0)
    s_barrier
    v_mfma_f32_32x32x16_bf16 v[32:47], v[148:151], v[144:147], v[32:47]
    ds_read_b128 v[96:99], v26 offset:57344
    ds_read_b64_tr_b16 v[100:101], v20 offset:16384
    ds_read_b64_tr_b16 v[102:103], v20 offset:16896
    ds_read_b128 v[104:107], v26 offset:58368
    ds_read_b64_tr_b16 v[108:109], v20 offset:18432
    ds_read_b64_tr_b16 v[110:111], v20 offset:18944
    v_mfma_f32_32x32x16_bf16 v[32:47], v[156:159], v[152:155], v[32:47]
    ds_read_b128 v[112:115], v26 offset:59392
    ds_read_b64_tr_b16 v[116:117], v20 offset:20480
    ds_read_b64_tr_b16 v[118:119], v20 offset:20992
    ds_read_b128 v[120:123], v26 offset:60416
    ds_read_b64_tr_b16 v[124:125], v20 offset:22528
    ds_read_b64_tr_b16 v[126:127], v20 offset:23040
    s_waitcnt lgkmcnt(9)
    v_mfma_f32_32x32x16_bf16 v[32:47], v[100:103], v[96:99], v[32:47]
    ds_read_b128 v[128:131], v26 offset:24576
    ds_read_b64_tr_b16 v[132:133], v20 offset:49152
    ds_read_b64_tr_b16 v[134:135], v20 offset:49664
    ds_read_b128 v[136:139], v26 offset:25600
    ds_read_b64_tr_b16 v[140:141], v20 offset:51200
    ds_read_b64_tr_b16 v[142:143], v20 offset:51712
    s_waitcnt lgkmcnt(12)
    v_mfma_f32_32x32x16_bf16 v[32:47], v[108:111], v[104:107], v[32:47]
    ds_read_b128 v[144:147], v26 offset:26624
    ds_read_b64_tr_b16 v[148:149], v20 offset:53248
    ds_read_b64_tr_b16 v[150:151], v20 offset:53760
    s_waitcnt lgkmcnt(12)
    v_mfma_f32_32x32x16_bf16 v[32:47], v[116:119], v[112:115], v[32:47]
    ds_read_b128 v[152:155], v26 offset:27648
    ds_read_b64_tr_b16 v[156:157], v20 offset:55296
    ds_read_b64_tr_b16 v[158:159], v20 offset:55808
    s_waitcnt lgkmcnt(12)
    v_mfma_f32_32x32x16_bf16 v[32:47], v[124:127], v[120:123], v[32:47]
    ds_read_b128 v[96:99], v29 offset:8192
    ds_read_b64_tr_b16 v[100:101], v28 offset:40960
    ds_read_b64_tr_b16 v[102:103], v28 offset:41472
    s_waitcnt lgkmcnt(12)
    v_mfma_f32_32x32x16_bf16 v[32:47], v[132:135], v[128:131], v[32:47]
    ds_read_b128 v[104:107], v29 offset:9216
    ds_read_b64_tr_b16 v[108:109], v28 offset:43008
    ds_read_b64_tr_b16 v[110:111], v28 offset:43520
    s_waitcnt lgkmcnt(12)
    v_mfma_f32_32x32x16_bf16 v[32:47], v[140:143], v[136:139], v[32:47]
    ds_read_b128 v[112:115], v29 offset:10240
    ds_read_b64_tr_b16 v[116:117], v28 offset:45056
    ds_read_b64_tr_b16 v[118:119], v28 offset:45568
    s_waitcnt lgkmcnt(12)
    v_mfma_f32_32x32x16_bf16 v[32:47], v[148:151], v[144:147], v[32:47]
    ds_read_b128 v[120:123], v29 offset:11264
    ds_read_b64_tr_b16 v[124:125], v28 offset:47104
    ds_read_b64_tr_b16 v[126:127], v28 offset:47616
    s_waitcnt lgkmcnt(12)
    v_mfma_f32_32x32x16_bf16 v[32:47], v[156:159], v[152:155], v[32:47]
    s_waitcnt lgkmcnt(9)
    v_mfma_f32_32x32x16_bf16 v[32:47], v[100:103], v[96:99], v[32:47]
    s_waitcnt lgkmcnt(6)
    v_mfma_f32_32x32x16_bf16 v[32:47], v[108:111], v[104:107], v[32:47]
    s_waitcnt lgkmcnt(0)
    s_barrier
    v_mfma_f32_32x32x16_bf16 v[32:47], v[116:119], v[112:115], v[32:47]
    ds_read_b128 v[128:131], v29 offset:24576
    ds_read_b64_tr_b16 v[132:133], v1 offset:0
    ds_read_b64_tr_b16 v[134:135], v1 offset:512
    ds_read_b128 v[136:139], v29 offset:25600
    ds_read_b64_tr_b16 v[140:141], v1 offset:2048
    ds_read_b64_tr_b16 v[142:143], v1 offset:2560
    v_mfma_f32_32x32x16_bf16 v[32:47], v[124:127], v[120:123], v[32:47]
    ds_read_b128 v[144:147], v29 offset:26624
    ds_read_b64_tr_b16 v[148:149], v1 offset:4096
    ds_read_b64_tr_b16 v[150:151], v1 offset:4608
    ds_read_b128 v[152:155], v29 offset:27648
    ds_read_b64_tr_b16 v[156:157], v1 offset:6144
    ds_read_b64_tr_b16 v[158:159], v1 offset:6656
    s_waitcnt lgkmcnt(9)
    v_mfma_f32_32x32x16_bf16 v[32:47], v[132:135], v[128:131], v[32:47]
    ds_read_b128 v[96:99], v26 offset:32768
    ds_read_b64_tr_b16 v[100:101], v28 offset:49152
    ds_read_b64_tr_b16 v[102:103], v28 offset:49664
    ds_read_b128 v[104:107], v26 offset:33792
    ds_read_b64_tr_b16 v[108:109], v28 offset:51200
    ds_read_b64_tr_b16 v[110:111], v28 offset:51712
    s_waitcnt lgkmcnt(12)
    v_mfma_f32_32x32x16_bf16 v[32:47], v[140:143], v[136:139], v[32:47]
    ds_read_b128 v[112:115], v26 offset:34816
    ds_read_b64_tr_b16 v[116:117], v28 offset:53248
    ds_read_b64_tr_b16 v[118:119], v28 offset:53760
    s_waitcnt lgkmcnt(12)
    v_mfma_f32_32x32x16_bf16 v[32:47], v[148:151], v[144:147], v[32:47]
    ds_read_b128 v[120:123], v26 offset:35840
    ds_read_b64_tr_b16 v[124:125], v28 offset:55296
    ds_read_b64_tr_b16 v[126:127], v28 offset:55808
    s_waitcnt lgkmcnt(12)
    v_mfma_f32_32x32x16_bf16 v[32:47], v[156:159], v[152:155], v[32:47]
    ds_read_b128 v[128:131], v26 offset:8192
    ds_read_b64_tr_b16 v[132:133], v28 offset:57344
    ds_read_b64_tr_b16 v[134:135], v28 offset:57856
    s_waitcnt lgkmcnt(12)
    v_mfma_f32_32x32x16_bf16 v[32:47], v[100:103], v[96:99], v[32:47]
    ds_read_b128 v[136:139], v26 offset:9216
    ds_read_b64_tr_b16 v[140:141], v28 offset:59392
    ds_read_b64_tr_b16 v[142:143], v28 offset:59904
    s_waitcnt lgkmcnt(12)
    v_mfma_f32_32x32x16_bf16 v[32:47], v[108:111], v[104:107], v[32:47]
    ds_read_b128 v[144:147], v26 offset:10240
    ds_read_b64_tr_b16 v[148:149], v28 offset:61440
    ds_read_b64_tr_b16 v[150:151], v28 offset:61952
    s_waitcnt lgkmcnt(12)
    v_mfma_f32_32x32x16_bf16 v[32:47], v[116:119], v[112:115], v[32:47]
    ds_read_b128 v[152:155], v26 offset:11264
    ds_read_b64_tr_b16 v[156:157], v28 offset:63488
    ds_read_b64_tr_b16 v[158:159], v28 offset:64000
    s_waitcnt lgkmcnt(12)
    v_mfma_f32_32x32x16_bf16 v[32:47], v[124:127], v[120:123], v[32:47]
    s_waitcnt lgkmcnt(9)
    v_mfma_f32_32x32x16_bf16 v[32:47], v[132:135], v[128:131], v[32:47]
    s_waitcnt lgkmcnt(6)
    v_mfma_f32_32x32x16_bf16 v[32:47], v[140:143], v[136:139], v[32:47]
    s_waitcnt lgkmcnt(0)
    s_barrier
    v_mfma_f32_32x32x16_bf16 v[32:47], v[148:151], v[144:147], v[32:47]
    ds_read_b128 v[96:99], v26 offset:40960
    ds_read_b64_tr_b16 v[100:101], v1 offset:8192
    ds_read_b64_tr_b16 v[102:103], v1 offset:8704
    ds_read_b128 v[104:107], v26 offset:41984
    ds_read_b64_tr_b16 v[108:109], v1 offset:10240
    ds_read_b64_tr_b16 v[110:111], v1 offset:10752
    v_mfma_f32_32x32x16_bf16 v[32:47], v[156:159], v[152:155], v[32:47]
    ds_read_b128 v[112:115], v26 offset:43008
    ds_read_b64_tr_b16 v[116:117], v1 offset:12288
    ds_read_b64_tr_b16 v[118:119], v1 offset:12800
    ds_read_b128 v[120:123], v26 offset:44032
    ds_read_b64_tr_b16 v[124:125], v1 offset:14336
    ds_read_b64_tr_b16 v[126:127], v1 offset:14848
    s_waitcnt lgkmcnt(9)
    v_mfma_f32_32x32x16_bf16 v[32:47], v[100:103], v[96:99], v[32:47]
    ds_read_b128 v[128:131], v29 offset:32768
    ds_read_b64_tr_b16 v[132:133], v1 offset:16384
    ds_read_b64_tr_b16 v[134:135], v1 offset:16896
    ds_read_b128 v[136:139], v29 offset:33792
    ds_read_b64_tr_b16 v[140:141], v1 offset:18432
    ds_read_b64_tr_b16 v[142:143], v1 offset:18944
    s_waitcnt lgkmcnt(12)
    v_mfma_f32_32x32x16_bf16 v[32:47], v[108:111], v[104:107], v[32:47]
    ds_read_b128 v[144:147], v29 offset:34816
    ds_read_b64_tr_b16 v[148:149], v1 offset:20480
    ds_read_b64_tr_b16 v[150:151], v1 offset:20992
    s_waitcnt lgkmcnt(12)
    v_mfma_f32_32x32x16_bf16 v[32:47], v[116:119], v[112:115], v[32:47]
    ds_read_b128 v[152:155], v29 offset:35840
    ds_read_b64_tr_b16 v[156:157], v1 offset:22528
    ds_read_b64_tr_b16 v[158:159], v1 offset:23040
    s_waitcnt lgkmcnt(12)
    v_mfma_f32_32x32x16_bf16 v[32:47], v[124:127], v[120:123], v[32:47]
    ds_read_b128 v[96:99], v26 offset:57344
    ds_read_b64_tr_b16 v[100:101], v20 offset:0
    ds_read_b64_tr_b16 v[102:103], v20 offset:512
    s_waitcnt lgkmcnt(12)
    v_mfma_f32_32x32x16_bf16 v[32:47], v[132:135], v[128:131], v[32:47]
    ds_read_b128 v[104:107], v26 offset:58368
    ds_read_b64_tr_b16 v[108:109], v20 offset:2048
    ds_read_b64_tr_b16 v[110:111], v20 offset:2560
    s_waitcnt lgkmcnt(12)
    v_mfma_f32_32x32x16_bf16 v[32:47], v[140:143], v[136:139], v[32:47]
    ds_read_b128 v[112:115], v26 offset:59392
    ds_read_b64_tr_b16 v[116:117], v20 offset:4096
    ds_read_b64_tr_b16 v[118:119], v20 offset:4608
    s_waitcnt lgkmcnt(12)
    v_mfma_f32_32x32x16_bf16 v[32:47], v[148:151], v[144:147], v[32:47]
    ds_read_b128 v[120:123], v26 offset:60416
    ds_read_b64_tr_b16 v[124:125], v20 offset:6144
    ds_read_b64_tr_b16 v[126:127], v20 offset:6656
    s_waitcnt lgkmcnt(12)
    v_mfma_f32_32x32x16_bf16 v[32:47], v[156:159], v[152:155], v[32:47]
    s_waitcnt lgkmcnt(9)
    v_mfma_f32_32x32x16_bf16 v[32:47], v[100:103], v[96:99], v[32:47]
    s_waitcnt lgkmcnt(6)
    v_mfma_f32_32x32x16_bf16 v[32:47], v[108:111], v[104:107], v[32:47]
    s_waitcnt lgkmcnt(0)
    s_barrier
    v_mfma_f32_32x32x16_bf16 v[32:47], v[116:119], v[112:115], v[32:47]
    ds_read_b128 v[128:131], v26 offset:16384
    ds_read_b64_tr_b16 v[132:133], v28 offset:0
    ds_read_b64_tr_b16 v[134:135], v28 offset:512
    ds_read_b128 v[136:139], v26 offset:17408
    ds_read_b64_tr_b16 v[140:141], v28 offset:2048
    ds_read_b64_tr_b16 v[142:143], v28 offset:2560
    v_mfma_f32_32x32x16_bf16 v[32:47], v[124:127], v[120:123], v[32:47]
    ds_read_b128 v[144:147], v26 offset:18432
    ds_read_b64_tr_b16 v[148:149], v28 offset:4096
    ds_read_b64_tr_b16 v[150:151], v28 offset:4608
    ds_read_b128 v[152:155], v26 offset:19456
    ds_read_b64_tr_b16 v[156:157], v28 offset:6144
    ds_read_b64_tr_b16 v[158:159], v28 offset:6656
    s_waitcnt lgkmcnt(9)
    v_mfma_f32_32x32x16_bf16 v[32:47], v[132:135], v[128:131], v[32:47]
    ds_read_b128 v[96:99], v26 offset:24576
    ds_read_b64_tr_b16 v[100:101], v28 offset:16384
    ds_read_b64_tr_b16 v[102:103], v28 offset:16896
    ds_read_b128 v[104:107], v26 offset:25600
    ds_read_b64_tr_b16 v[108:109], v28 offset:18432
    ds_read_b64_tr_b16 v[110:111], v28 offset:18944
    s_waitcnt lgkmcnt(12)
    v_mfma_f32_32x32x16_bf16 v[32:47], v[140:143], v[136:139], v[32:47]
    ds_read_b128 v[112:115], v26 offset:26624
    ds_read_b64_tr_b16 v[116:117], v28 offset:20480
    ds_read_b64_tr_b16 v[118:119], v28 offset:20992
    s_waitcnt lgkmcnt(12)
    v_mfma_f32_32x32x16_bf16 v[32:47], v[148:151], v[144:147], v[32:47]
    ds_read_b128 v[120:123], v26 offset:27648
    ds_read_b64_tr_b16 v[124:125], v28 offset:22528
    ds_read_b64_tr_b16 v[126:127], v28 offset:23040
    s_waitcnt lgkmcnt(12)
    v_mfma_f32_32x32x16_bf16 v[32:47], v[156:159], v[152:155], v[32:47]
    ds_read_b128 v[128:131], v26 offset:49152
    ds_read_b64_tr_b16 v[132:133], v28 offset:8192
    ds_read_b64_tr_b16 v[134:135], v28 offset:8704
    s_waitcnt lgkmcnt(12)
    v_mfma_f32_32x32x16_bf16 v[48:63], v[100:103], v[96:99], 0
    ds_read_b128 v[136:139], v26 offset:50176
    ds_read_b64_tr_b16 v[140:141], v28 offset:10240
    ds_read_b64_tr_b16 v[142:143], v28 offset:10752
    s_waitcnt lgkmcnt(12)
    v_mfma_f32_32x32x16_bf16 v[48:63], v[108:111], v[104:107], v[48:63]
    ds_read_b128 v[144:147], v26 offset:51200
    ds_read_b64_tr_b16 v[148:149], v28 offset:12288
    ds_read_b64_tr_b16 v[150:151], v28 offset:12800
    s_waitcnt lgkmcnt(12)
    v_mfma_f32_32x32x16_bf16 v[48:63], v[116:119], v[112:115], v[48:63]
    ds_read_b128 v[152:155], v26 offset:52224
    ds_read_b64_tr_b16 v[156:157], v28 offset:14336
    ds_read_b64_tr_b16 v[158:159], v28 offset:14848
    s_waitcnt lgkmcnt(12)
    v_mfma_f32_32x32x16_bf16 v[48:63], v[124:127], v[120:123], v[48:63]
    v_and_b32 v92, 31, v0
    v_lshrrev_b32 v93, 5, v0
    s_and_b32 s11, s10, 1
    s_lshl_b32 s11, s11, 2
    v_lshl_or_b32 v93, v93, 1, s11
    s_waitcnt lgkmcnt(9)
    v_mfma_f32_32x32x16_bf16 v[48:63], v[132:135], v[128:131], v[48:63]
    v_and_b32 v94, 7, v0
    v_xor_b32 v93, v93, v94
    v_lshlrev_b32 v93, 4, v93
    v_lshl_or_b32 v88, v92, 7, v93
    s_lshr_b32 s11, s10, 1
    s_waitcnt lgkmcnt(6)
    v_mfma_f32_32x32x16_bf16 v[48:63], v[140:143], v[136:139], v[48:63]
    s_lshl_b32 s11, s11, 12
    s_add_u32 s11, s11, 139264
    v_add_u32 v88, s11, v88
    v_xor_b32 v89, 16, v88
    v_lshrrev_b32 v92, 3, v0
    s_waitcnt lgkmcnt(0)
    s_barrier
    v_mfma_f32_32x32x16_bf16 v[48:63], v[148:151], v[144:147], v[48:63]
    ds_read_b128 v[96:99], v29 offset:24576
    ds_read_b64_tr_b16 v[100:101], v28 offset:40960
    ds_read_b64_tr_b16 v[102:103], v28 offset:41472
    ds_read_b128 v[104:107], v29 offset:25600
    ds_read_b64_tr_b16 v[108:109], v28 offset:43008
    ds_read_b64_tr_b16 v[110:111], v28 offset:43520
    v_xor_b32 v93, v94, v92
    v_lshlrev_b32 v93, 4, v93
    v_lshl_or_b32 v90, v92, 7, v93
    v_mfma_f32_32x32x16_bf16 v[48:63], v[156:159], v[152:155], v[48:63]
    ds_read_b128 v[112:115], v29 offset:26624
    ds_read_b64_tr_b16 v[116:117], v28 offset:45056
    ds_read_b64_tr_b16 v[118:119], v28 offset:45568
    ds_read_b128 v[120:123], v29 offset:27648
    ds_read_b64_tr_b16 v[124:125], v28 offset:47104
    ds_read_b64_tr_b16 v[126:127], v28 offset:47616
    s_lshl_b32 s11, s10, 11
    s_add_u32 s11, s11, 139264
    v_add_u32 v90, s11, v90
    s_waitcnt lgkmcnt(9)
    v_mfma_f32_32x32x16_bf16 v[48:63], v[100:103], v[96:99], v[48:63]
    ds_read_b128 v[128:131], v27 offset:0
    ds_read_b64_tr_b16 v[132:133], v28 offset:49152
    ds_read_b64_tr_b16 v[134:135], v28 offset:49664
    ds_read_b128 v[136:139], v27 offset:1024
    ds_read_b64_tr_b16 v[140:141], v28 offset:51200
    ds_read_b64_tr_b16 v[142:143], v28 offset:51712
    v_lshlrev_b32 v94, 4, v94
    v_lshl_or_b32 v91, v92, 10, v94
    s_lshl_b32 s11, s8, 16
    s_waitcnt lgkmcnt(12)
    v_mfma_f32_32x32x16_bf16 v[48:63], v[108:111], v[104:107], v[48:63]
    ds_read_b128 v[144:147], v27 offset:2048
    ds_read_b64_tr_b16 v[148:149], v28 offset:53248
    ds_read_b64_tr_b16 v[150:151], v28 offset:53760
    s_lshl_b32 s12, s10, 14
    s_add_u32 s11, s11, s12
    s_lshl_b32 s12, s9, 7
    s_waitcnt lgkmcnt(12)
    v_mfma_f32_32x32x16_bf16 v[48:63], v[116:119], v[112:115], v[48:63]
    ds_read_b128 v[152:155], v27 offset:3072
    ds_read_b64_tr_b16 v[156:157], v28 offset:55296
    ds_read_b64_tr_b16 v[158:159], v28 offset:55808
    s_add_u32 s11, s11, s12
    v_add_u32 v91, s11, v91
    s_mov_b32 s11, 8192
    s_waitcnt lgkmcnt(12)
    v_mfma_f32_32x32x16_bf16 v[48:63], v[124:127], v[120:123], v[48:63]
    ds_read_b128 v[96:99], v26 offset:32768
    ds_read_b64_tr_b16 v[100:101], v20 offset:8192
    ds_read_b64_tr_b16 v[102:103], v20 offset:8704
    buffer_load_dword v64, v19, s[56:59], 0 offen offset:0 sc1
    s_waitcnt lgkmcnt(12)
    v_mfma_f32_32x32x16_bf16 v[48:63], v[132:135], v[128:131], v[48:63]
    ds_read_b128 v[104:107], v26 offset:33792
    ds_read_b64_tr_b16 v[108:109], v20 offset:10240
    ds_read_b64_tr_b16 v[110:111], v20 offset:10752
    buffer_load_dword v65, v19, s[56:59], 0 offen offset:512 sc1
    s_waitcnt lgkmcnt(12)
    v_mfma_f32_32x32x16_bf16 v[48:63], v[140:143], v[136:139], v[48:63]
    ds_read_b128 v[112:115], v26 offset:34816
    ds_read_b64_tr_b16 v[116:117], v20 offset:12288
    ds_read_b64_tr_b16 v[118:119], v20 offset:12800
    buffer_load_dword v66, v19, s[56:59], 0 offen offset:1024 sc1
    s_waitcnt lgkmcnt(12)
    v_mfma_f32_32x32x16_bf16 v[48:63], v[148:151], v[144:147], v[48:63]
    ds_read_b128 v[120:123], v26 offset:35840
    ds_read_b64_tr_b16 v[124:125], v20 offset:14336
    ds_read_b64_tr_b16 v[126:127], v20 offset:14848
    buffer_load_dword v67, v19, s[56:59], 0 offen offset:1536 sc1
    s_waitcnt lgkmcnt(12)
    v_mfma_f32_32x32x16_bf16 v[48:63], v[156:159], v[152:155], v[48:63]
    buffer_load_dword v68, v19, s[56:59], 0 offen offset:2048 sc1
    s_waitcnt lgkmcnt(9)
    v_mfma_f32_32x32x16_bf16 v[48:63], v[100:103], v[96:99], v[48:63]
    buffer_load_dword v69, v19, s[56:59], 0 offen offset:2560 sc1
    s_waitcnt lgkmcnt(6)
    v_mfma_f32_32x32x16_bf16 v[48:63], v[108:111], v[104:107], v[48:63]
    buffer_load_dword v70, v19, s[56:59], 0 offen offset:3072 sc1
    s_waitcnt lgkmcnt(0)
    s_barrier
    v_mfma_f32_32x32x16_bf16 v[48:63], v[116:119], v[112:115], v[48:63]
    ds_read_b128 v[128:131], v26 offset:40960
    ds_read_b64_tr_b16 v[132:133], v28 offset:57344
    ds_read_b64_tr_b16 v[134:135], v28 offset:57856
    ds_read_b128 v[136:139], v26 offset:41984
    ds_read_b64_tr_b16 v[140:141], v28 offset:59392
    ds_read_b64_tr_b16 v[142:143], v28 offset:59904
    buffer_load_dword v71, v19, s[56:59], 0 offen offset:3584 sc1
    v_mfma_f32_32x32x16_bf16 v[48:63], v[124:127], v[120:123], v[48:63]
    ds_read_b128 v[144:147], v26 offset:43008
    ds_read_b64_tr_b16 v[148:149], v28 offset:61440
    ds_read_b64_tr_b16 v[150:151], v28 offset:61952
    ds_read_b128 v[152:155], v26 offset:44032
    ds_read_b64_tr_b16 v[156:157], v28 offset:63488
    ds_read_b64_tr_b16 v[158:159], v28 offset:64000
    s_waitcnt lgkmcnt(9)
    v_mfma_f32_32x32x16_bf16 v[48:63], v[132:135], v[128:131], v[48:63]
    ds_read_b128 v[96:99], v27 offset:8192
    ds_read_b64_tr_b16 v[100:101], v1 offset:16384
    ds_read_b64_tr_b16 v[102:103], v1 offset:16896
    ds_read_b128 v[104:107], v27 offset:9216
    ds_read_b64_tr_b16 v[108:109], v1 offset:18432
    ds_read_b64_tr_b16 v[110:111], v1 offset:18944
    s_waitcnt lgkmcnt(12)
    v_mfma_f32_32x32x16_bf16 v[48:63], v[140:143], v[136:139], v[48:63]
    ds_read_b128 v[112:115], v27 offset:10240
    ds_read_b64_tr_b16 v[116:117], v1 offset:20480
    ds_read_b64_tr_b16 v[118:119], v1 offset:20992
    s_waitcnt lgkmcnt(12)
    v_mfma_f32_32x32x16_bf16 v[48:63], v[148:151], v[144:147], v[48:63]
    ds_read_b128 v[120:123], v27 offset:11264
    ds_read_b64_tr_b16 v[124:125], v1 offset:22528
    ds_read_b64_tr_b16 v[126:127], v1 offset:23040
    s_waitcnt lgkmcnt(12)
    v_mfma_f32_32x32x16_bf16 v[48:63], v[156:159], v[152:155], v[48:63]
    s_waitcnt vmcnt(0)
    v_add_f32 v64, v64, v68
    v_add_f32 v65, v65, v69
    v_add_f32 v66, v66, v70
    v_add_f32 v67, v67, v71
    s_waitcnt lgkmcnt(9)
    v_mfma_f32_32x32x16_bf16 v[48:63], v[100:103], v[96:99], v[48:63]
    v_add_f32 v64, v64, v65
    v_add_f32 v66, v66, v67
    v_add_f32 v64, v64, v66
    v_mul_f32 v64, 0xbfb8aa3b, v64
    v_exp_f32 v64, v64
    s_waitcnt lgkmcnt(6)
    v_mfma_f32_32x32x16_bf16 v[48:63], v[108:111], v[104:107], v[48:63]
    v_add_f32 v64, 1.0, v64
    v_rcp_f32 v64, v64
    s_nop 0
    v_sub_f32 v66, 1.0, v64
    v_pk_mul_f32 v[32:33], v[32:33], v[66:67] op_sel_hi:[1,0]
    s_waitcnt lgkmcnt(0)
    s_barrier
    v_mfma_f32_32x32x16_bf16 v[48:63], v[116:119], v[112:115], v[48:63]
    ds_read_b128 v[128:131], v29 offset:32768
    ds_read_b64_tr_b16 v[132:133], v20 offset:57344
    ds_read_b64_tr_b16 v[134:135], v20 offset:57856
    ds_read_b128 v[136:139], v29 offset:33792
    ds_read_b64_tr_b16 v[140:141], v20 offset:59392
    ds_read_b64_tr_b16 v[142:143], v20 offset:59904
    v_pk_mul_f32 v[34:35], v[34:35], v[66:67] op_sel_hi:[1,0]
    v_pk_mul_f32 v[36:37], v[36:37], v[66:67] op_sel_hi:[1,0]
    v_pk_mul_f32 v[38:39], v[38:39], v[66:67] op_sel_hi:[1,0]
    v_mfma_f32_32x32x16_bf16 v[48:63], v[124:127], v[120:123], v[48:63]
    ds_read_b128 v[144:147], v29 offset:34816
    ds_read_b64_tr_b16 v[148:149], v20 offset:61440
    ds_read_b64_tr_b16 v[150:151], v20 offset:61952
    ds_read_b128 v[152:155], v29 offset:35840
    ds_read_b64_tr_b16 v[156:157], v20 offset:63488
    ds_read_b64_tr_b16 v[158:159], v20 offset:64000
    v_pk_mul_f32 v[40:41], v[40:41], v[66:67] op_sel_hi:[1,0]
    v_pk_mul_f32 v[42:43], v[42:43], v[66:67] op_sel_hi:[1,0]
    v_pk_mul_f32 v[44:45], v[44:45], v[66:67] op_sel_hi:[1,0]
    s_waitcnt lgkmcnt(9)
    v_mfma_f32_32x32x16_bf16 v[48:63], v[132:135], v[128:131], v[48:63]
    v_pk_mul_f32 v[46:47], v[46:47], v[66:67] op_sel_hi:[1,0]
    s_waitcnt lgkmcnt(6)
    v_mfma_f32_32x32x16_bf16 v[48:63], v[140:143], v[136:139], v[48:63]
    s_waitcnt lgkmcnt(3)
    v_mfma_f32_32x32x16_bf16 v[48:63], v[148:151], v[144:147], v[48:63]
    s_waitcnt lgkmcnt(0)
    v_mfma_f32_32x32x16_bf16 v[48:63], v[156:159], v[152:155], v[48:63]
    s_nop 11
    v_pk_fma_f32 v[32:33], v[48:49], v[64:65], v[32:33] op_sel_hi:[1,0,1]
    v_pk_fma_f32 v[34:35], v[50:51], v[64:65], v[34:35] op_sel_hi:[1,0,1]
    v_pk_fma_f32 v[36:37], v[52:53], v[64:65], v[36:37] op_sel_hi:[1,0,1]
    v_pk_fma_f32 v[38:39], v[54:55], v[64:65], v[38:39] op_sel_hi:[1,0,1]
    v_pk_fma_f32 v[40:41], v[56:57], v[64:65], v[40:41] op_sel_hi:[1,0,1]
    v_pk_fma_f32 v[42:43], v[58:59], v[64:65], v[42:43] op_sel_hi:[1,0,1]
    v_pk_fma_f32 v[44:45], v[60:61], v[64:65], v[44:45] op_sel_hi:[1,0,1]
    v_pk_fma_f32 v[46:47], v[62:63], v[64:65], v[46:47] op_sel_hi:[1,0,1]
    v_cvt_pk_bf16_f32 v80, v32, v33
    v_cvt_pk_bf16_f32 v81, v34, v35
    v_cvt_pk_bf16_f32 v82, v36, v37
    v_cvt_pk_bf16_f32 v83, v38, v39
    ds_write_b128 v88, v[80:83]
    v_cvt_pk_bf16_f32 v84, v40, v41
    v_cvt_pk_bf16_f32 v85, v42, v43
    v_cvt_pk_bf16_f32 v86, v44, v45
    v_cvt_pk_bf16_f32 v87, v46, v47
    ds_write_b128 v89, v[84:87]
    s_waitcnt lgkmcnt(0)
    s_barrier
    ds_read_b128 v[80:83], v90
    ds_read_b128 v[84:87], v90 offset:1024
    s_waitcnt lgkmcnt(1)
    buffer_store_dwordx4 v[80:83], v91, s[44:47], 0 offen sc1
    s_waitcnt lgkmcnt(0)
    buffer_store_dwordx4 v[84:87], v91, s[44:47], s11 offen sc1
    s_endpgm
.p2align 6
L_B_ffn:
    s_lshr_b32 s11, s2, 3
    s_or_b32 s11, s11, s10
    s_cbranch_scc1 L_nw_145
    s_memrealtime s[94:95]
    s_waitcnt lgkmcnt(0)
    s_or_b32 s11, s94, 1
    v_mov_b32 v8, s11
    v_mov_b32 v9, 0
    s_mov_b64 exec, 1
    global_atomic_cmpswap v9, v[8:9], s[34:35] sc1
    s_mov_b64 exec, -1
    s_nop 1
L_nw_145:
    v_and_b32 v8, 31, v0
    v_lshrrev_b32 v9, 5, v0
    v_bfe_u32 v10, v0, 1, 3
    v_xor_b32 v10, v10, v9
    v_lshlrev_b32 v10, 4, v10
    v_lshl_or_b32 v21, v8, 7, v10
    s_lshl_b32 s12, s10, 12
    v_add_u32 v21, s12, v21
    v_xor_b32 v22, 32, v21
    v_xor_b32 v23, 64, v21
    v_xor_b32 v24, 96, v21
    v_lshrrev_b32 v9, 5, v0
    v_bfe_u32 v8, v0, 2, 2
    v_lshl_or_b32 v8, v9, 3, v8
    v_and_b32 v12, 1, v0
    v_bfe_u32 v13, v0, 1, 1
    v_lshlrev_b32 v9, 4, v12
    v_lshl_or_b32 v9, v13, 3, v9
    v_bfe_u32 v10, v0, 4, 1
    v_bfe_u32 v11, v0, 3, 1
    v_lshlrev_b32 v11, 6, v11
    v_lshl_or_b32 v14, v10, 5, v9
    v_xor_b32 v15, v14, v11
    v_lshl_add_u32 v15, v8, 7, v15
    v_add_u32 v26, 131072, v15
    v_xor_b32 v27, 64, v26
    v_lshl_add_u32 v15, v8, 6, v14
    v_add_u32 v28, 135168, v15
    s_lshl_b32 s12, s4, 1
    s_lshr_b32 s13, s10, 1
    s_add_u32 s12, s12, s13
    s_mul_i32 s12, s12, 4352
    s_lshl_b32 s13, s6, 3
    s_add_u32 s12, s12, s13
    s_and_b32 s13, s10, 1
    s_lshl_b32 s13, s13, 2
    s_add_u32 s101, s12, s13
    s_add_u32 s25, s101, 10555392
    s_lshl_b32 s12, s4, 2
    s_add_u32 s12, s12, s10
    s_mul_i32 s12, s12, 147456
    v_subrev_u32 v2, 131072, v26
    v_subrev_u32 v3, 131072, v27
    v_subrev_u32 v4, 131072, v28
    s_lshl_b32 s13, s85, 6
    s_add_u32 s27, s12, s13
    s_lshl_b32 s13, s86, 6
    s_add_u32 s28, s12, s13
    v_lshlrev_b32 v13, 16, v0
    s_mov_b32 s63, 0x20000
    s_cmp_eq_u32 s10, 1
    s_cbranch_scc1 L_t1_146
    s_cmp_eq_u32 s10, 2
    s_cbranch_scc1 L_t2_147
    s_cmp_eq_u32 s10, 3
    s_cbranch_scc1 L_t3_148
    s_mov_b64 s[60:61], s[64:65]
    s_mov_b32 s62, 1835008
    s_lshl_b32 s11, s9, 7
    buffer_load_dword v14, v13, s[60:63], s11 offen
    s_branch L_td_149
L_t1_146:
    s_mov_b64 s[60:61], s[66:67]
    s_mov_b32 s62, 524288
    s_lshl_b32 s11, s9, 7
    buffer_load_dword v14, v13, s[60:63], s11 offen
    s_mov_b64 s[60:61], s[32:33]
    s_mov_b32 s62, 2097152
    s_lshl_b32 s12, s8, 16
    s_add_u32 s11, s11, s12
    s_mov_b64 exec, 1
    buffer_load_dword v14, off, s[60:63], s11
    s_mov_b64 exec, -1
    s_branch L_td_149
L_t2_147:
    s_mul_i32 s11, s4, 589824
    s_mov_b64 exec, 0x3ff
    buffer_load_dword v14, v13, s[56:59], s11 offen sc1
    s_mov_b64 exec, -1
    s_branch L_td_149
L_t3_148:
    s_mul_i32 s11, s8, 294912
    s_mov_b64 exec, 0x3f
    buffer_load_dword v14, v13, s[56:59], s11 offen sc1
    s_mov_b32 s11, 10092544
    s_mov_b64 exec, 0x3fff
    buffer_load_dword v14, v13, s[56:59], s11 offen sc1
    s_mov_b64 exec, -1
L_td_149:
    s_barrier
    s_mov_b64 exec, 1
    buffer_load_dword v14, off, s[56:59], s25 sc1
    s_mul_i32 s11, s4, 4352
    s_add_u32 s11, s11, 10485760
    buffer_load_dword v14, off, s[56:59], s11 sc1
    s_mov_b64 exec, -1
    s_barrier
    s_barrier
    s_barrier
    s_barrier
    s_barrier
    s_barrier
    s_barrier
    s_barrier
    s_barrier
    s_barrier
    s_barrier
    s_barrier
    s_barrier
    s_barrier
    s_barrier
    s_barrier
    ds_read_b128 v[80:83], v21 offset:0
    ds_read_b64_tr_b16 v[84:85], v26 offset:0
    ds_read_b64_tr_b16 v[86:87], v26 offset:512
    ds_read_b64_tr_b16 v[88:89], v27 offset:0
    ds_read_b64_tr_b16 v[90:91], v27 offset:512
    ds_read_b64_tr_b16 v[92:93], v28 offset:0
    ds_read_b64_tr_b16 v[94:95], v28 offset:256
    ds_read_b128 v[96:99], v22 offset:0
    ds_read_b64_tr_b16 v[100:101], v26 offset:2048
    ds_read_b64_tr_b16 v[102:103], v26 offset:2560
    ds_read_b64_tr_b16 v[104:105], v27 offset:2048
    ds_read_b64_tr_b16 v[106:107], v27 offset:2560
    ds_read_b64_tr_b16 v[108:109], v28 offset:1024
    ds_read_b64_tr_b16 v[110:111], v28 offset:1280
    s_waitcnt lgkmcnt(0)
    s_barrier
    v_mfma_f32_32x32x16_bf16 v[32:47], v[84:87], v[80:83], 0
    ds_read_b128 v[112:115], v23 offset:0
    ds_read_b64_tr_b16 v[116:117], v26 offset:8192
    ds_read_b64_tr_b16 v[118:119], v26 offset:8704
    ds_read_b64_tr_b16 v[120:121], v27 offset:8192
    ds_read_b64_tr_b16 v[122:123], v27 offset:8704
    v_mfma_f32_32x32x16_bf16 v[48:63], v[88:91], v[80:83], 0
    ds_read_b64_tr_b16 v[124:125], v28 offset:8192
    ds_read_b64_tr_b16 v[126:127], v28 offset:8448
    ds_read_b128 v[128:131], v24 offset:0
    ds_read_b64_tr_b16 v[132:133], v26 offset:10240
    ds_read_b64_tr_b16 v[134:135], v26 offset:10752
    v_mfma_f32_32x32x16_bf16 v[64:79], v[92:95], v[80:83], 0
    ds_read_b64_tr_b16 v[136:137], v27 offset:10240
    ds_read_b64_tr_b16 v[138:139], v27 offset:10752
    ds_read_b64_tr_b16 v[140:141], v28 offset:9216
    ds_read_b64_tr_b16 v[142:143], v28 offset:9472
    v_mfma_f32_32x32x16_bf16 v[32:47], v[100:103], v[96:99], v[32:47]
    v_mfma_f32_32x32x16_bf16 v[48:63], v[104:107], v[96:99], v[48:63]
    v_mfma_f32_32x32x16_bf16 v[64:79], v[108:111], v[96:99], v[64:79]
    s_waitcnt lgkmcnt(0)
    s_barrier
    v_mfma_f32_32x32x16_bf16 v[32:47], v[116:119], v[112:115], v[32:47]
    ds_read_b128 v[80:83], v21 offset:16384
    ds_read_b64_tr_b16 v[84:85], v26 offset:16384
    ds_read_b64_tr_b16 v[86:87], v26 offset:16896
    ds_read_b64_tr_b16 v[88:89], v27 offset:16384
    ds_read_b64_tr_b16 v[90:91], v27 offset:16896
    v_mfma_f32_32x32x16_bf16 v[48:63], v[120:123], v[112:115], v[48:63]
    ds_read_b64_tr_b16 v[92:93], v28 offset:16384
    ds_read_b64_tr_b16 v[94:95], v28 offset:16640
    ds_read_b128 v[96:99], v22 offset:16384
    ds_read_b64_tr_b16 v[100:101], v26 offset:18432
    ds_read_b64_tr_b16 v[102:103], v26 offset:18944
    v_mfma_f32_32x32x16_bf16 v[64:79], v[124:127], v[112:115], v[64:79]
    ds_read_b64_tr_b16 v[104:105], v27 offset:18432
    ds_read_b64_tr_b16 v[106:107], v27 offset:18944
    ds_read_b64_tr_b16 v[108:109], v28 offset:17408
    ds_read_b64_tr_b16 v[110:111], v28 offset:17664
    v_mfma_f32_32x32x16_bf16 v[32:47], v[132:135], v[128:131], v[32:47]
    v_mfma_f32_32x32x16_bf16 v[48:63], v[136:139], v[128:131], v[48:63]
    v_mfma_f32_32x32x16_bf16 v[64:79], v[140:143], v[128:131], v[64:79]
    s_waitcnt lgkmcnt(0)
    s_barrier
    v_mfma_f32_32x32x16_bf16 v[32:47], v[84:87], v[80:83], v[32:47]
    ds_read_b128 v[112:115], v23 offset:16384
    ds_read_b64_tr_b16 v[116:117], v26 offset:24576
    ds_read_b64_tr_b16 v[118:119], v26 offset:25088
    ds_read_b64_tr_b16 v[120:121], v27 offset:24576
    ds_read_b64_tr_b16 v[122:123], v27 offset:25088
    v_mfma_f32_32x32x16_bf16 v[48:63], v[88:91], v[80:83], v[48:63]
    ds_read_b64_tr_b16 v[124:125], v28 offset:24576
    ds_read_b64_tr_b16 v[126:127], v28 offset:24832
    ds_read_b128 v[128:131], v24 offset:16384
    ds_read_b64_tr_b16 v[132:133], v26 offset:26624
    ds_read_b64_tr_b16 v[134:135], v26 offset:27136
    v_mfma_f32_32x32x16_bf16 v[64:79], v[92:95], v[80:83], v[64:79]
    ds_read_b64_tr_b16 v[136:137], v27 offset:26624
    ds_read_b64_tr_b16 v[138:139], v27 offset:27136
    ds_read_b64_tr_b16 v[140:141], v28 offset:25600
    ds_read_b64_tr_b16 v[142:143], v28 offset:25856
    v_mfma_f32_32x32x16_bf16 v[32:47], v[100:103], v[96:99], v[32:47]
    v_mfma_f32_32x32x16_bf16 v[48:63], v[104:107], v[96:99], v[48:63]
    v_mfma_f32_32x32x16_bf16 v[64:79], v[108:111], v[96:99], v[64:79]
    s_waitcnt lgkmcnt(0)
    s_barrier
    v_mfma_f32_32x32x16_bf16 v[32:47], v[116:119], v[112:115], v[32:47]
    ds_read_b128 v[80:83], v21 offset:32768
    ds_read_b64_tr_b16 v[84:85], v26 offset:0
    ds_read_b64_tr_b16 v[86:87], v26 offset:512
    ds_read_b64_tr_b16 v[88:89], v27 offset:0
    ds_read_b64_tr_b16 v[90:91], v27 offset:512
    v_mfma_f32_32x32x16_bf16 v[48:63], v[120:123], v[112:115], v[48:63]
    ds_read_b64_tr_b16 v[92:93], v28 offset:0
    ds_read_b64_tr_b16 v[94:95], v28 offset:256
    ds_read_b128 v[96:99], v22 offset:32768
    ds_read_b64_tr_b16 v[100:101], v26 offset:2048
    ds_read_b64_tr_b16 v[102:103], v26 offset:2560
    v_mfma_f32_32x32x16_bf16 v[64:79], v[124:127], v[112:115], v[64:79]
    ds_read_b64_tr_b16 v[104:105], v27 offset:2048
    ds_read_b64_tr_b16 v[106:107], v27 offset:2560
    ds_read_b64_tr_b16 v[108:109], v28 offset:1024
    ds_read_b64_tr_b16 v[110:111], v28 offset:1280
    v_mfma_f32_32x32x16_bf16 v[32:47], v[132:135], v[128:131], v[32:47]
    v_mfma_f32_32x32x16_bf16 v[48:63], v[136:139], v[128:131], v[48:63]
    v_mfma_f32_32x32x16_bf16 v[64:79], v[140:143], v[128:131], v[64:79]
    s_waitcnt lgkmcnt(0)
    s_barrier
    v_mfma_f32_32x32x16_bf16 v[32:47], v[84:87], v[80:83], v[32:47]
    ds_read_b128 v[112:115], v23 offset:32768
    ds_read_b64_tr_b16 v[116:117], v26 offset:8192
    ds_read_b64_tr_b16 v[118:119], v26 offset:8704
    ds_read_b64_tr_b16 v[120:121], v27 offset:8192
    ds_read_b64_tr_b16 v[122:123], v27 offset:8704
    v_mfma_f32_32x32x16_bf16 v[48:63], v[88:91], v[80:83], v[48:63]
    ds_read_b64_tr_b16 v[124:125], v28 offset:8192
    ds_read_b64_tr_b16 v[126:127], v28 offset:8448
    ds_read_b128 v[128:131], v24 offset:32768
    ds_read_b64_tr_b16 v[132:133], v26 offset:10240
    ds_read_b64_tr_b16 v[134:135], v26 offset:10752
    v_mfma_f32_32x32x16_bf16 v[64:79], v[92:95], v[80:83], v[64:79]
    ds_read_b64_tr_b16 v[136:137], v27 offset:10240
    ds_read_b64_tr_b16 v[138:139], v27 offset:10752
    ds_read_b64_tr_b16 v[140:141], v28 offset:9216
    ds_read_b64_tr_b16 v[142:143], v28 offset:9472
    v_mfma_f32_32x32x16_bf16 v[32:47], v[100:103], v[96:99], v[32:47]
    v_mfma_f32_32x32x16_bf16 v[48:63], v[104:107], v[96:99], v[48:63]
    v_mfma_f32_32x32x16_bf16 v[64:79], v[108:111], v[96:99], v[64:79]
    s_waitcnt lgkmcnt(0)
    s_barrier
    v_mfma_f32_32x32x16_bf16 v[32:47], v[116:119], v[112:115], v[32:47]
    ds_read_b128 v[80:83], v21 offset:49152
    ds_read_b64_tr_b16 v[84:85], v2 offset:0
    ds_read_b64_tr_b16 v[86:87], v2 offset:512
    ds_read_b64_tr_b16 v[88:89], v3 offset:0
    ds_read_b64_tr_b16 v[90:91], v3 offset:512
    v_mfma_f32_32x32x16_bf16 v[48:63], v[120:123], v[112:115], v[48:63]
    ds_read_b64_tr_b16 v[92:93], v4 offset:0
    ds_read_b64_tr_b16 v[94:95], v4 offset:256
    ds_read_b128 v[96:99], v22 offset:49152
    ds_read_b64_tr_b16 v[100:101], v2 offset:2048
    ds_read_b64_tr_b16 v[102:103], v2 offset:2560
    v_mfma_f32_32x32x16_bf16 v[64:79], v[124:127], v[112:115], v[64:79]
    ds_read_b64_tr_b16 v[104:105], v3 offset:2048
    ds_read_b64_tr_b16 v[106:107], v3 offset:2560
    ds_read_b64_tr_b16 v[108:109], v4 offset:1024
    ds_read_b64_tr_b16 v[110:111], v4 offset:1280
    v_mfma_f32_32x32x16_bf16 v[32:47], v[132:135], v[128:131], v[32:47]
    v_mfma_f32_32x32x16_bf16 v[48:63], v[136:139], v[128:131], v[48:63]
    v_mfma_f32_32x32x16_bf16 v[64:79], v[140:143], v[128:131], v[64:79]
    s_waitcnt lgkmcnt(0)
    s_barrier
    v_mfma_f32_32x32x16_bf16 v[32:47], v[84:87], v[80:83], v[32:47]
    ds_read_b128 v[112:115], v23 offset:49152
    ds_read_b64_tr_b16 v[116:117], v2 offset:8192
    ds_read_b64_tr_b16 v[118:119], v2 offset:8704
    ds_read_b64_tr_b16 v[120:121], v3 offset:8192
    ds_read_b64_tr_b16 v[122:123], v3 offset:8704
    v_mfma_f32_32x32x16_bf16 v[48:63], v[88:91], v[80:83], v[48:63]
    ds_read_b64_tr_b16 v[124:125], v4 offset:8192
    ds_read_b64_tr_b16 v[126:127], v4 offset:8448
    ds_read_b128 v[128:131], v24 offset:49152
    ds_read_b64_tr_b16 v[132:133], v2 offset:10240
    ds_read_b64_tr_b16 v[134:135], v2 offset:10752
    v_mfma_f32_32x32x16_bf16 v[64:79], v[92:95], v[80:83], v[64:79]
    ds_read_b64_tr_b16 v[136:137], v3 offset:10240
    ds_read_b64_tr_b16 v[138:139], v3 offset:10752
    ds_read_b64_tr_b16 v[140:141], v4 offset:9216
    ds_read_b64_tr_b16 v[142:143], v4 offset:9472
    v_mfma_f32_32x32x16_bf16 v[32:47], v[100:103], v[96:99], v[32:47]
    v_mfma_f32_32x32x16_bf16 v[48:63], v[104:107], v[96:99], v[48:63]
    v_mfma_f32_32x32x16_bf16 v[64:79], v[108:111], v[96:99], v[64:79]
    s_waitcnt lgkmcnt(0)
    s_barrier
    v_add_u32 v21, 0x10000, v21
    v_add_u32 v22, 0x10000, v22
    v_add_u32 v23, 0x10000, v23
    v_add_u32 v24, 0x10000, v24
    v_mfma_f32_32x32x16_bf16 v[32:47], v[116:119], v[112:115], v[32:47]
    ds_read_b128 v[80:83], v21 offset:0
    ds_read_b64_tr_b16 v[84:85], v26 offset:16384
    ds_read_b64_tr_b16 v[86:87], v26 offset:16896
    ds_read_b64_tr_b16 v[88:89], v27 offset:16384
    ds_read_b64_tr_b16 v[90:91], v27 offset:16896
    v_mfma_f32_32x32x16_bf16 v[48:63], v[120:123], v[112:115], v[48:63]
    ds_read_b64_tr_b16 v[92:93], v28 offset:16384
    ds_read_b64_tr_b16 v[94:95], v28 offset:16640
    ds_read_b128 v[96:99], v22 offset:0
    ds_read_b64_tr_b16 v[100:101], v26 offset:18432
    ds_read_b64_tr_b16 v[102:103], v26 offset:18944
    v_mfma_f32_32x32x16_bf16 v[64:79], v[124:127], v[112:115], v[64:79]
    ds_read_b64_tr_b16 v[104:105], v27 offset:18432
    ds_read_b64_tr_b16 v[106:107], v27 offset:18944
    ds_read_b64_tr_b16 v[108:109], v28 offset:17408
    ds_read_b64_tr_b16 v[110:111], v28 offset:17664
    v_mfma_f32_32x32x16_bf16 v[32:47], v[132:135], v[128:131], v[32:47]
    v_mfma_f32_32x32x16_bf16 v[48:63], v[136:139], v[128:131], v[48:63]
    v_mfma_f32_32x32x16_bf16 v[64:79], v[140:143], v[128:131], v[64:79]
    s_waitcnt lgkmcnt(0)
    s_barrier
    v_mfma_f32_32x32x16_bf16 v[32:47], v[84:87], v[80:83], v[32:47]
    ds_read_b128 v[112:115], v23 offset:0
    ds_read_b64_tr_b16 v[116:117], v26 offset:24576
    ds_read_b64_tr_b16 v[118:119], v26 offset:25088
    ds_read_b64_tr_b16 v[120:121], v27 offset:24576
    ds_read_b64_tr_b16 v[122:123], v27 offset:25088
    v_mfma_f32_32x32x16_bf16 v[48:63], v[88:91], v[80:83], v[48:63]
    ds_read_b64_tr_b16 v[124:125], v28 offset:24576
    ds_read_b64_tr_b16 v[126:127], v28 offset:24832
    ds_read_b128 v[128:131], v24 offset:0
    ds_read_b64_tr_b16 v[132:133], v26 offset:26624
    ds_read_b64_tr_b16 v[134:135], v26 offset:27136
    v_mfma_f32_32x32x16_bf16 v[64:79], v[92:95], v[80:83], v[64:79]
    ds_read_b64_tr_b16 v[136:137], v27 offset:26624
    ds_read_b64_tr_b16 v[138:139], v27 offset:27136
    ds_read_b64_tr_b16 v[140:141], v28 offset:25600
    ds_read_b64_tr_b16 v[142:143], v28 offset:25856
    v_mfma_f32_32x32x16_bf16 v[32:47], v[100:103], v[96:99], v[32:47]
    v_mfma_f32_32x32x16_bf16 v[48:63], v[104:107], v[96:99], v[48:63]
    v_mfma_f32_32x32x16_bf16 v[64:79], v[108:111], v[96:99], v[64:79]
    s_waitcnt lgkmcnt(0)
    s_barrier
    v_mfma_f32_32x32x16_bf16 v[32:47], v[116:119], v[112:115], v[32:47]
    ds_read_b128 v[80:83], v21 offset:16384
    ds_read_b64_tr_b16 v[84:85], v2 offset:16384
    ds_read_b64_tr_b16 v[86:87], v2 offset:16896
    ds_read_b64_tr_b16 v[88:89], v3 offset:16384
    ds_read_b64_tr_b16 v[90:91], v3 offset:16896
    v_mfma_f32_32x32x16_bf16 v[48:63], v[120:123], v[112:115], v[48:63]
    ds_read_b64_tr_b16 v[92:93], v4 offset:16384
    ds_read_b64_tr_b16 v[94:95], v4 offset:16640
    ds_read_b128 v[96:99], v22 offset:16384
    ds_read_b64_tr_b16 v[100:101], v2 offset:18432
    ds_read_b64_tr_b16 v[102:103], v2 offset:18944
    v_mfma_f32_32x32x16_bf16 v[64:79], v[124:127], v[112:115], v[64:79]
    ds_read_b64_tr_b16 v[104:105], v3 offset:18432
    ds_read_b64_tr_b16 v[106:107], v3 offset:18944
    ds_read_b64_tr_b16 v[108:109], v4 offset:17408
    ds_read_b64_tr_b16 v[110:111], v4 offset:17664
    v_mfma_f32_32x32x16_bf16 v[32:47], v[132:135], v[128:131], v[32:47]
    v_mfma_f32_32x32x16_bf16 v[48:63], v[136:139], v[128:131], v[48:63]
    v_mfma_f32_32x32x16_bf16 v[64:79], v[140:143], v[128:131], v[64:79]
    s_waitcnt lgkmcnt(0)
    s_barrier
    v_mfma_f32_32x32x16_bf16 v[32:47], v[84:87], v[80:83], v[32:47]
    ds_read_b128 v[112:115], v23 offset:16384
    ds_read_b64_tr_b16 v[116:117], v2 offset:24576
    ds_read_b64_tr_b16 v[118:119], v2 offset:25088
    ds_read_b64_tr_b16 v[120:121], v3 offset:24576
    ds_read_b64_tr_b16 v[122:123], v3 offset:25088
    v_mfma_f32_32x32x16_bf16 v[48:63], v[88:91], v[80:83], v[48:63]
    ds_read_b64_tr_b16 v[124:125], v4 offset:24576
    ds_read_b64_tr_b16 v[126:127], v4 offset:24832
    ds_read_b128 v[128:131], v24 offset:16384
    ds_read_b64_tr_b16 v[132:133], v2 offset:26624
    ds_read_b64_tr_b16 v[134:135], v2 offset:27136
    v_mfma_f32_32x32x16_bf16 v[64:79], v[92:95], v[80:83], v[64:79]
    ds_read_b64_tr_b16 v[136:137], v3 offset:26624
    ds_read_b64_tr_b16 v[138:139], v3 offset:27136
    ds_read_b64_tr_b16 v[140:141], v4 offset:25600
    ds_read_b64_tr_b16 v[142:143], v4 offset:25856
    v_mfma_f32_32x32x16_bf16 v[32:47], v[100:103], v[96:99], v[32:47]
    v_mfma_f32_32x32x16_bf16 v[48:63], v[104:107], v[96:99], v[48:63]
    v_mfma_f32_32x32x16_bf16 v[64:79], v[108:111], v[96:99], v[64:79]
    s_waitcnt lgkmcnt(0)
    s_barrier
    v_mfma_f32_32x32x16_bf16 v[32:47], v[116:119], v[112:115], v[32:47]
    ds_read_b128 v[80:83], v21 offset:32768
    ds_read_b64_tr_b16 v[84:85], v26 offset:0
    ds_read_b64_tr_b16 v[86:87], v26 offset:512
    ds_read_b64_tr_b16 v[88:89], v27 offset:0
    ds_read_b64_tr_b16 v[90:91], v27 offset:512
    v_mfma_f32_32x32x16_bf16 v[48:63], v[120:123], v[112:115], v[48:63]
    ds_read_b64_tr_b16 v[92:93], v28 offset:0
    ds_read_b64_tr_b16 v[94:95], v28 offset:256
    ds_read_b128 v[96:99], v22 offset:32768
    ds_read_b64_tr_b16 v[100:101], v26 offset:2048
    ds_read_b64_tr_b16 v[102:103], v26 offset:2560
    v_mfma_f32_32x32x16_bf16 v[64:79], v[124:127], v[112:115], v[64:79]
    ds_read_b64_tr_b16 v[104:105], v27 offset:2048
    ds_read_b64_tr_b16 v[106:107], v27 offset:2560
    ds_read_b64_tr_b16 v[108:109], v28 offset:1024
    ds_read_b64_tr_b16 v[110:111], v28 offset:1280
    v_mfma_f32_32x32x16_bf16 v[32:47], v[132:135], v[128:131], v[32:47]
    v_mfma_f32_32x32x16_bf16 v[48:63], v[136:139], v[128:131], v[48:63]
    v_mfma_f32_32x32x16_bf16 v[64:79], v[140:143], v[128:131], v[64:79]
    s_waitcnt lgkmcnt(0)
    s_barrier
    v_mfma_f32_32x32x16_bf16 v[32:47], v[84:87], v[80:83], v[32:47]
    ds_read_b128 v[112:115], v23 offset:32768
    ds_read_b64_tr_b16 v[116:117], v26 offset:8192
    ds_read_b64_tr_b16 v[118:119], v26 offset:8704
    ds_read_b64_tr_b16 v[120:121], v27 offset:8192
    ds_read_b64_tr_b16 v[122:123], v27 offset:8704
    v_mfma_f32_32x32x16_bf16 v[48:63], v[88:91], v[80:83], v[48:63]
    ds_read_b64_tr_b16 v[124:125], v28 offset:8192
    ds_read_b64_tr_b16 v[126:127], v28 offset:8448
    ds_read_b128 v[128:131], v24 offset:32768
    ds_read_b64_tr_b16 v[132:133], v26 offset:10240
    ds_read_b64_tr_b16 v[134:135], v26 offset:10752
    v_mfma_f32_32x32x16_bf16 v[64:79], v[92:95], v[80:83], v[64:79]
    ds_read_b64_tr_b16 v[136:137], v27 offset:10240
    ds_read_b64_tr_b16 v[138:139], v27 offset:10752
    ds_read_b64_tr_b16 v[140:141], v28 offset:9216
    ds_read_b64_tr_b16 v[142:143], v28 offset:9472
    v_mfma_f32_32x32x16_bf16 v[32:47], v[100:103], v[96:99], v[32:47]
    v_mfma_f32_32x32x16_bf16 v[48:63], v[104:107], v[96:99], v[48:63]
    v_mfma_f32_32x32x16_bf16 v[64:79], v[108:111], v[96:99], v[64:79]
    s_waitcnt lgkmcnt(0)
    s_barrier
    v_mfma_f32_32x32x16_bf16 v[32:47], v[116:119], v[112:115], v[32:47]
    ds_read_b128 v[80:83], v21 offset:49152
    ds_read_b64_tr_b16 v[84:85], v2 offset:32768
    ds_read_b64_tr_b16 v[86:87], v2 offset:33280
    ds_read_b64_tr_b16 v[88:89], v3 offset:32768
    ds_read_b64_tr_b16 v[90:91], v3 offset:33280
    v_mfma_f32_32x32x16_bf16 v[48:63], v[120:123], v[112:115], v[48:63]
    ds_read_b64_tr_b16 v[92:93], v4 offset:32768
    ds_read_b64_tr_b16 v[94:95], v4 offset:33024
    ds_read_b128 v[96:99], v22 offset:49152
    ds_read_b64_tr_b16 v[100:101], v2 offset:34816
    ds_read_b64_tr_b16 v[102:103], v2 offset:35328
    v_mfma_f32_32x32x16_bf16 v[64:79], v[124:127], v[112:115], v[64:79]
    ds_read_b64_tr_b16 v[104:105], v3 offset:34816
    ds_read_b64_tr_b16 v[106:107], v3 offset:35328
    ds_read_b64_tr_b16 v[108:109], v4 offset:33792
    ds_read_b64_tr_b16 v[110:111], v4 offset:34048
    v_mfma_f32_32x32x16_bf16 v[32:47], v[132:135], v[128:131], v[32:47]
    v_mfma_f32_32x32x16_bf16 v[48:63], v[136:139], v[128:131], v[48:63]
    v_mfma_f32_32x32x16_bf16 v[64:79], v[140:143], v[128:131], v[64:79]
    s_waitcnt lgkmcnt(0)
    s_barrier
    v_mfma_f32_32x32x16_bf16 v[32:47], v[84:87], v[80:83], v[32:47]
    ds_read_b128 v[112:115], v23 offset:49152
    ds_read_b64_tr_b16 v[116:117], v2 offset:40960
    ds_read_b64_tr_b16 v[118:119], v2 offset:41472
    ds_read_b64_tr_b16 v[120:121], v3 offset:40960
    ds_read_b64_tr_b16 v[122:123], v3 offset:41472
    v_mfma_f32_32x32x16_bf16 v[48:63], v[88:91], v[80:83], v[48:63]
    ds_read_b64_tr_b16 v[124:125], v4 offset:40960
    ds_read_b64_tr_b16 v[126:127], v4 offset:41216
    ds_read_b128 v[128:131], v24 offset:49152
    ds_read_b64_tr_b16 v[132:133], v2 offset:43008
    ds_read_b64_tr_b16 v[134:135], v2 offset:43520
    v_mfma_f32_32x32x16_bf16 v[64:79], v[92:95], v[80:83], v[64:79]
    ds_read_b64_tr_b16 v[136:137], v3 offset:43008
    ds_read_b64_tr_b16 v[138:139], v3 offset:43520
    ds_read_b64_tr_b16 v[140:141], v4 offset:41984
    ds_read_b64_tr_b16 v[142:143], v4 offset:42240
    v_mfma_f32_32x32x16_bf16 v[32:47], v[100:103], v[96:99], v[32:47]
    v_mfma_f32_32x32x16_bf16 v[48:63], v[104:107], v[96:99], v[48:63]
    v_mfma_f32_32x32x16_bf16 v[64:79], v[108:111], v[96:99], v[64:79]
    s_waitcnt lgkmcnt(0)
    s_barrier
    s_load_dword s15, s[34:35], 0
    v_mfma_f32_32x32x16_bf16 v[32:47], v[116:119], v[112:115], v[32:47]
    v_mfma_f32_32x32x16_bf16 v[32:47], v[132:135], v[128:131], v[32:47]
    v_mfma_f32_32x32x16_bf16 v[48:63], v[120:123], v[112:115], v[48:63]
    v_mfma_f32_32x32x16_bf16 v[48:63], v[136:139], v[128:131], v[48:63]
    v_mfma_f32_32x32x16_bf16 v[64:79], v[124:127], v[112:115], v[64:79]
    v_mfma_f32_32x32x16_bf16 v[64:79], v[140:143], v[128:131], v[64:79]
    s_nop 7
    v_cvt_pk_bf16_f32 v32, v32, v33
    v_cvt_pk_bf16_f32 v33, v34, v35
    v_cvt_pk_bf16_f32 v34, v36, v37
    v_cvt_pk_bf16_f32 v35, v38, v39
    v_cvt_pk_bf16_f32 v36, v40, v41
    v_cvt_pk_bf16_f32 v37, v42, v43
    v_cvt_pk_bf16_f32 v38, v44, v45
    v_cvt_pk_bf16_f32 v39, v46, v47
    v_pk_max_i16 v32, v32, 0
    v_pk_max_i16 v33, v33, 0
    v_pk_max_i16 v34, v34, 0
    v_pk_max_i16 v35, v35, 0
    v_pk_max_i16 v36, v36, 0
    v_pk_max_i16 v37, v37, 0
    v_pk_max_i16 v38, v38, 0
    v_pk_max_i16 v39, v39, 0
    buffer_store_dwordx4 v[32:35], v6, s[56:59], s27 offen offset:0 sc1
    buffer_store_dwordx4 v[36:39], v6, s[56:59], s27 offen offset:1024 sc1
    v_cvt_pk_bf16_f32 v48, v48, v49
    v_cvt_pk_bf16_f32 v49, v50, v51
    v_cvt_pk_bf16_f32 v50, v52, v53
    v_cvt_pk_bf16_f32 v51, v54, v55
    v_cvt_pk_bf16_f32 v52, v56, v57
    v_cvt_pk_bf16_f32 v53, v58, v59
    v_cvt_pk_bf16_f32 v54, v60, v61
    v_cvt_pk_bf16_f32 v55, v62, v63
    v_pk_max_i16 v48, v48, 0
    v_pk_max_i16 v49, v49, 0
    v_pk_max_i16 v50, v50, 0
    v_pk_max_i16 v51, v51, 0
    v_pk_max_i16 v52, v52, 0
    v_pk_max_i16 v53, v53, 0
    v_pk_max_i16 v54, v54, 0
    v_pk_max_i16 v55, v55, 0
    buffer_store_dwordx4 v[48:51], v6, s[56:59], s27 offen offset:2048 sc1
    buffer_store_dwordx4 v[52:55], v6, s[56:59], s27 offen offset:3072 sc1
    v_cvt_pk_bf16_f32 v64, v64, v65
    v_cvt_pk_bf16_f32 v65, v66, v67
    v_cvt_pk_bf16_f32 v66, v68, v69
    v_cvt_pk_bf16_f32 v67, v70, v71
    v_cvt_pk_bf16_f32 v68, v72, v73
    v_cvt_pk_bf16_f32 v69, v74, v75
    v_cvt_pk_bf16_f32 v70, v76, v77
    v_cvt_pk_bf16_f32 v71, v78, v79
    v_pk_max_i16 v64, v64, 0
    v_pk_max_i16 v65, v65, 0
    v_pk_max_i16 v66, v66, 0
    v_pk_max_i16 v67, v67, 0
    v_pk_max_i16 v68, v68, 0
    v_pk_max_i16 v69, v69, 0
    v_pk_max_i16 v70, v70, 0
    v_pk_max_i16 v71, v71, 0
    buffer_store_dwordx4 v[64:67], v6, s[56:59], s28 offen offset:0 sc1
    buffer_store_dwordx4 v[68:71], v6, s[56:59], s28 offen offset:1024 sc1
    s_waitcnt lgkmcnt(0)
    s_cmp_lg_u32 s15, 0
    s_cbranch_scc1 L_nok_150
    s_mov_b32 s100, 0
L_nlp_151:
    s_sleep 16
    v_mov_b32 v17, 0
    global_load_dword v17, v17, s[34:35] sc1
    s_waitcnt vmcnt(0)
    s_nop 0
    v_readfirstlane_b32 s15, v17
    s_add_u32 s100, s100, 1
    s_cmp_ge_u32 s100, 20000
    s_cbranch_scc1 L_nok_150
    s_cmp_eq_u32 s15, 0
    s_cbranch_scc1 L_nlp_151
L_nok_150:
    v_mov_b32 v17, s15
    s_waitcnt vmcnt(0)
    s_cmp_lg_u32 s29, 0
    s_cbranch_scc1 L_fl_152
    s_waitcnt vmcnt(0)
    s_mov_b64 exec, 1
    buffer_store_dword v17, off, s[56:59], s25 sc1
    s_mov_b64 exec, -1
    s_movk_i32 s29, 0x100
L_fl_152:
    s_endpgm
.p2align 6
L_B_attn:
    v_and_b32 v8, 31, v0
    v_lshrrev_b32 v9, 5, v0
    v_bfe_u32 v10, v0, 1, 3
    v_xor_b32 v10, v10, v9
    v_lshlrev_b32 v10, 4, v10
    v_lshl_or_b32 v21, v8, 7, v10
    s_lshl_b32 s12, s10, 12
    v_add_u32 v21, s12, v21
    v_xor_b32 v22, 32, v21
    v_xor_b32 v23, 64, v21
    v_xor_b32 v24, 96, v21
    v_lshrrev_b32 v9, 5, v0
    v_bfe_u32 v8, v0, 2, 2
    v_lshl_or_b32 v8, v9, 3, v8
    v_and_b32 v12, 1, v0
    v_bfe_u32 v13, v0, 1, 1
    v_lshlrev_b32 v9, 4, v12
    v_lshl_or_b32 v9, v13, 3, v9
    v_bfe_u32 v10, v0, 4, 1
    v_bfe_u32 v11, v0, 3, 1
    v_lshlrev_b32 v11, 6, v11
    v_lshl_or_b32 v14, v10, 5, v9
    v_xor_b32 v15, v14, v11
    v_lshl_add_u32 v15, v8, 7, v15
    v_add_u32 v26, 131072, v15
    v_xor_b32 v27, 64, v26
    v_lshl_add_u32 v15, v8, 6, v14
    v_add_u32 v28, 135168, v15
    s_lshl_b32 s12, s4, 1
    s_lshr_b32 s13, s10, 1
    s_add_u32 s12, s12, s13
    s_mul_i32 s12, s12, 4352
    s_lshl_b32 s13, s6, 3
    s_add_u32 s12, s12, s13
    s_and_b32 s13, s10, 1
    s_lshl_b32 s13, s13, 2
    s_add_u32 s101, s12, s13
    s_add_u32 s25, s101, 10694656
    s_lshl_b32 s12, s4, 2
    s_add_u32 s12, s12, s10
    s_mul_i32 s12, s12, 147456
    s_lshl_b32 s13, s6, 12
    s_add_u32 s12, s12, s13
    s_add_u32 s26, s12, 114688
    s_lshl_b32 s12, s6, 2
    s_add_u32 s12, s12, s10
    s_mul_i32 s13, s12, 4352
    s_add_u32 s23, s13, 10833920
    s_mul_i32 s12, s12, 17408
    s_add_u32 s24, s12, 9437184
    s_lshl_b32 s12, s4, 3
    s_add_u32 s12, s12, s6
    s_lshl_b32 s12, s12, 9
    s_lshl_b32 s13, s10, 7
    s_add_u32 s12, s12, s13
    s_add_u32 s27, s12, 10092544
    v_lshlrev_b32 v14, 10, v10
    v_and_b32 v15, 0x2f, v0
    v_lshl_add_u32 v14, v15, 4, v14
    s_lshl_b32 s12, s10, 11
    s_add_u32 s12, s12, 147456
    v_add_u32 v29, s12, v14
    v_lshlrev_b32 v14, 4, v10
    v_lshl_or_b32 v14, v13, 3, v14
    v_lshl_add_u32 v14, v8, 5, v14
    v_add_u32 v4, 122880, v14
    v_bfe_u32 v14, v0, 2, 1
    v_sub_u32 v14, 0, v14
    v_and_b32 v5, 0x80008000, v14
    v_lshrrev_b32 v8, 5, v0
    s_bfe_u32 s94, s2, 65538
    s_add_u32 s11, s7, s94
    s_lshl_b32 s11, s11, 7
    v_lshl_add_u32 v1, v8, 4, s11
    v_and_b32 v8, 15, v0
    v_lshrrev_b32 v9, 4, v0
    v_lshlrev_b32 v9, 4, v9
    v_lshl_or_b32 v25, v8, 6, v9
    v_add_u32 v25, 16384, v25
    v_and_b32 v12, 1, v0
    v_lshlrev_b32 v12, 4, v12
    v_mov_b32 v13, 0x3f80
    v_lshlrev_b32 v12, v12, v13
    v_bfe_u32 v13, v0, 2, 1
    v_lshrrev_b32 v14, 5, v0
    v_cmp_eq_u32 vcc, v13, v14
    v_bfe_u32 v13, v0, 3, 2
    v_bfe_u32 v14, v0, 1, 1
    v_cndmask_b32 v12, 0, v12, vcc
    v_lshl_or_b32 v13, v13, 1, v14
    v_cmp_eq_u32 vcc, 0, v13
    s_nop 1
    v_cndmask_b32 v160, 0, v12, vcc
    v_cmp_eq_u32 vcc, 1, v13
    s_nop 1
    v_cndmask_b32 v161, 0, v12, vcc
    v_cmp_eq_u32 vcc, 2, v13
    s_nop 1
    v_cndmask_b32 v162, 0, v12, vcc
    v_cmp_eq_u32 vcc, 3, v13
    s_nop 1
    v_cndmask_b32 v163, 0, v12, vcc
    v_cmp_eq_u32 vcc, 4, v13
    s_nop 1
    v_cndmask_b32 v164, 0, v12, vcc
    v_cmp_eq_u32 vcc, 5, v13
    s_nop 1
    v_cndmask_b32 v165, 0, v12, vcc
    v_cmp_eq_u32 vcc, 6, v13
    s_nop 1
    v_cndmask_b32 v166, 0, v12, vcc
    v_cmp_eq_u32 vcc, 7, v13
    s_nop 1
    v_cndmask_b32 v167, 0, v12, vcc
    s_lshl_b32 s12, s10, 2
    s_add_u32 s12, s12, 24592
    v_mov_b32 v8, s12
    v_lshlrev_b32 v9, 2, v0
    v_add_u32 v9, 25600, v9
    v_cmp_eq_u32 vcc, 0, v0
    v_mov_b32 v16, 24576
    s_mov_b32 s95, 0
    v_cndmask_b32 v7, v9, v8, vcc
    v_subrev_u32 v2, 131072, v26
    v_subrev_u32 v3, 131072, v27
    v_lshlrev_b32 v13, 16, v0
    s_mov_b32 s63, 0x20000
    s_cmp_eq_u32 s10, 1
    s_cbranch_scc1 L_t1_153
    s_cmp_eq_u32 s10, 2
    s_cbranch_scc1 L_t2_154
    s_cmp_eq_u32 s10, 3
    s_cbranch_scc1 L_t3_155
    s_mov_b64 s[60:61], s[64:65]
    s_mov_b32 s62, 1835008
    s_lshl_b32 s11, s9, 7
    buffer_load_dword v14, v13, s[60:63], s11 offen
    s_branch L_td_156
L_t1_153:
    s_mov_b64 s[60:61], s[66:67]
    s_mov_b32 s62, 524288
    s_lshl_b32 s11, s9, 7
    buffer_load_dword v14, v13, s[60:63], s11 offen
    s_mov_b64 s[60:61], s[32:33]
    s_mov_b32 s62, 2097152
    s_lshl_b32 s12, s8, 16
    s_add_u32 s11, s11, s12
    s_mov_b64 exec, 1
    buffer_load_dword v14, off, s[60:63], s11
    s_mov_b64 exec, -1
    s_branch L_td_156
L_t2_154:
    s_mul_i32 s11, s4, 589824
    s_mov_b64 exec, 0x3ff
    buffer_load_dword v14, v13, s[56:59], s11 offen sc1
    s_mov_b64 exec, -1
    s_branch L_td_156
L_t3_155:
    s_mul_i32 s11, s8, 294912
    s_mov_b64 exec, 0x3f
    buffer_load_dword v14, v13, s[56:59], s11 offen sc1
    s_mov_b32 s11, 10092544
    s_mov_b64 exec, 0x3fff
    buffer_load_dword v14, v13, s[56:59], s11 offen sc1
    s_mov_b64 exec, -1
L_td_156:
    s_barrier
    s_mov_b64 exec, 1
    buffer_load_dword v14, off, s[56:59], s25 sc1
    buffer_load_dword v14, off, s[56:59], s23 sc1
    s_lshl_b32 s11, s4, 6
    s_add_u32 s11, s11, s24
    s_add_u32 s11, s11, 16384
    buffer_load_dword v14, off, s[56:59], s11 sc1
    s_mov_b64 exec, -1
    global_load_dwordx4 v[128:131], v1, s[30:31] offset:0
    global_load_dwordx4 v[132:135], v1, s[30:31] offset:32
    global_load_dwordx4 v[136:139], v1, s[30:31] offset:64
    global_load_dwordx4 v[140:143], v1, s[30:31] offset:96
    s_barrier
    s_barrier
    ds_read_b64_tr_b16 v[112:113], v4 offset:0
    ds_read_b64_tr_b16 v[114:115], v4 offset:128
    ds_read_b64_tr_b16 v[116:117], v4 offset:512
    ds_read_b64_tr_b16 v[118:119], v4 offset:640
    ds_read_b64_tr_b16 v[120:121], v4 offset:1024
    ds_read_b64_tr_b16 v[122:123], v4 offset:1152
    ds_read_b64_tr_b16 v[124:125], v4 offset:1536
    ds_read_b64_tr_b16 v[126:127], v4 offset:1664
    s_waitcnt lgkmcnt(0)
    v_xor_b32 v112, v112, v5
    v_xor_b32 v113, v113, v5
    v_xor_b32 v114, v114, v5
    v_xor_b32 v115, v115, v5
    v_xor_b32 v116, v116, v5
    v_xor_b32 v117, v117, v5
    v_xor_b32 v118, v118, v5
    v_xor_b32 v119, v119, v5
    v_xor_b32 v120, v120, v5
    v_xor_b32 v121, v121, v5
    v_xor_b32 v122, v122, v5
    v_xor_b32 v123, v123, v5
    v_xor_b32 v124, v124, v5
    v_xor_b32 v125, v125, v5
    v_xor_b32 v126, v126, v5
    v_xor_b32 v127, v127, v5
    v_lshlrev_b32 v1, 2, v0
    s_barrier
    s_barrier
    s_barrier
    s_barrier
    s_barrier
    s_barrier
    s_barrier
    s_barrier
    s_barrier
    s_barrier
    s_barrier
    s_barrier
    s_barrier
    s_waitcnt vmcnt(0)
    s_barrier
    ds_read_b128 v[64:67], v21 offset:0
    ds_read_b64_tr_b16 v[68:69], v26 offset:0
    ds_read_b64_tr_b16 v[70:71], v26 offset:512
    ds_read_b64_tr_b16 v[72:73], v27 offset:0
    ds_read_b64_tr_b16 v[74:75], v27 offset:512
    ds_read_b128 v[76:79], v22 offset:0
    ds_read_b64_tr_b16 v[80:81], v26 offset:2048
    ds_read_b64_tr_b16 v[82:83], v26 offset:2560
    ds_read_b64_tr_b16 v[84:85], v27 offset:2048
    ds_read_b64_tr_b16 v[86:87], v27 offset:2560
    ds_read_b128 v[88:91], v23 offset:0
    ds_read_b64_tr_b16 v[92:93], v26 offset:4096
    ds_read_b64_tr_b16 v[94:95], v26 offset:4608
    ds_read_b64_tr_b16 v[96:97], v27 offset:4096
    ds_read_b64_tr_b16 v[98:99], v27 offset:4608
    s_waitcnt lgkmcnt(10)
    v_mfma_f32_32x32x16_bf16 v[32:47], v[68:71], v[64:67], 0
    ds_read_b128 v[100:103], v24 offset:0
    ds_read_b64_tr_b16 v[104:105], v26 offset:6144
    ds_read_b64_tr_b16 v[106:107], v26 offset:6656
    v_mfma_f32_32x32x16_bf16 v[48:63], v[72:75], v[64:67], 0
    ds_read_b64_tr_b16 v[108:109], v27 offset:6144
    ds_read_b64_tr_b16 v[110:111], v27 offset:6656
    s_cmp_lg_u32 s94, 0
    s_cbranch_scc1 L_gt_157
    v_mfma_f32_32x32x16_bf16 v[144:159], v[128:131], v[64:67], 0
L_gt_157:
    s_waitcnt lgkmcnt(10)
    v_mfma_f32_32x32x16_bf16 v[32:47], v[80:83], v[76:79], v[32:47]
    s_barrier
    ds_read_b128 v[64:67], v21 offset:16384
    ds_read_b64_tr_b16 v[68:69], v26 offset:8192
    ds_read_b64_tr_b16 v[70:71], v26 offset:8704
    v_mfma_f32_32x32x16_bf16 v[48:63], v[84:87], v[76:79], v[48:63]
    ds_read_b64_tr_b16 v[72:73], v27 offset:8192
    ds_read_b64_tr_b16 v[74:75], v27 offset:8704
    s_cmp_lg_u32 s94, 0
    s_cbranch_scc1 L_gt_158
    v_mfma_f32_32x32x16_bf16 v[144:159], v[132:135], v[76:79], v[144:159]
L_gt_158:
    s_waitcnt lgkmcnt(10)
    v_mfma_f32_32x32x16_bf16 v[32:47], v[92:95], v[88:91], v[32:47]
    ds_read_b128 v[76:79], v22 offset:16384
    ds_read_b64_tr_b16 v[80:81], v26 offset:10240
    ds_read_b64_tr_b16 v[82:83], v26 offset:10752
    v_mfma_f32_32x32x16_bf16 v[48:63], v[96:99], v[88:91], v[48:63]
    ds_read_b64_tr_b16 v[84:85], v27 offset:10240
    ds_read_b64_tr_b16 v[86:87], v27 offset:10752
    s_cmp_lg_u32 s94, 0
    s_cbranch_scc1 L_gt_159
    v_mfma_f32_32x32x16_bf16 v[144:159], v[136:139], v[88:91], v[144:159]
L_gt_159:
    s_waitcnt lgkmcnt(10)
    v_mfma_f32_32x32x16_bf16 v[32:47], v[104:107], v[100:103], v[32:47]
    ds_read_b128 v[88:91], v23 offset:16384
    ds_read_b64_tr_b16 v[92:93], v26 offset:12288
    ds_read_b64_tr_b16 v[94:95], v26 offset:12800
    v_mfma_f32_32x32x16_bf16 v[48:63], v[108:111], v[100:103], v[48:63]
    ds_read_b64_tr_b16 v[96:97], v27 offset:12288
    ds_read_b64_tr_b16 v[98:99], v27 offset:12800
    s_cmp_lg_u32 s94, 0
    s_cbranch_scc1 L_gt_160
    v_mfma_f32_32x32x16_bf16 v[144:159], v[140:143], v[100:103], v[144:159]
L_gt_160:
    s_waitcnt lgkmcnt(10)
    v_mfma_f32_32x32x16_bf16 v[32:47], v[68:71], v[64:67], v[32:47]
    ds_read_b128 v[100:103], v24 offset:16384
    ds_read_b64_tr_b16 v[104:105], v26 offset:14336
    ds_read_b64_tr_b16 v[106:107], v26 offset:14848
    v_mfma_f32_32x32x16_bf16 v[48:63], v[72:75], v[64:67], v[48:63]
    ds_read_b64_tr_b16 v[108:109], v27 offset:14336
    ds_read_b64_tr_b16 v[110:111], v27 offset:14848
    s_cmp_lg_u32 s94, 1
    s_cbranch_scc1 L_gt_161
    v_mfma_f32_32x32x16_bf16 v[144:159], v[128:131], v[64:67], 0
L_gt_161:
    s_waitcnt lgkmcnt(10)
    v_mfma_f32_32x32x16_bf16 v[32:47], v[80:83], v[76:79], v[32:47]
    s_barrier
    ds_read_b128 v[64:67], v21 offset:32768
    ds_read_b64_tr_b16 v[68:69], v26 offset:16384
    ds_read_b64_tr_b16 v[70:71], v26 offset:16896
    v_mfma_f32_32x32x16_bf16 v[48:63], v[84:87], v[76:79], v[48:63]
    ds_read_b64_tr_b16 v[72:73], v27 offset:16384
    ds_read_b64_tr_b16 v[74:75], v27 offset:16896
    s_cmp_lg_u32 s94, 1
    s_cbranch_scc1 L_gt_162
    v_mfma_f32_32x32x16_bf16 v[144:159], v[132:135], v[76:79], v[144:159]
L_gt_162:
    s_waitcnt lgkmcnt(10)
    v_mfma_f32_32x32x16_bf16 v[32:47], v[92:95], v[88:91], v[32:47]
    ds_read_b128 v[76:79], v22 offset:32768
    ds_read_b64_tr_b16 v[80:81], v26 offset:18432
    ds_read_b64_tr_b16 v[82:83], v26 offset:18944
    v_mfma_f32_32x32x16_bf16 v[48:63], v[96:99], v[88:91], v[48:63]
    ds_read_b64_tr_b16 v[84:85], v27 offset:18432
    ds_read_b64_tr_b16 v[86:87], v27 offset:18944
    s_cmp_lg_u32 s94, 1
    s_cbranch_scc1 L_gt_163
    v_mfma_f32_32x32x16_bf16 v[144:159], v[136:139], v[88:91], v[144:159]
L_gt_163:
    s_waitcnt lgkmcnt(10)
    v_mfma_f32_32x32x16_bf16 v[32:47], v[104:107], v[100:103], v[32:47]
    ds_read_b128 v[88:91], v23 offset:32768
    ds_read_b64_tr_b16 v[92:93], v26 offset:20480
    ds_read_b64_tr_b16 v[94:95], v26 offset:20992
    v_mfma_f32_32x32x16_bf16 v[48:63], v[108:111], v[100:103], v[48:63]
    ds_read_b64_tr_b16 v[96:97], v27 offset:20480
    ds_read_b64_tr_b16 v[98:99], v27 offset:20992
    s_cmp_lg_u32 s94, 1
    s_cbranch_scc1 L_gt_164
    v_mfma_f32_32x32x16_bf16 v[144:159], v[140:143], v[100:103], v[144:159]
L_gt_164:
    s_waitcnt lgkmcnt(10)
    v_mfma_f32_32x32x16_bf16 v[32:47], v[68:71], v[64:67], v[32:47]
    ds_read_b128 v[100:103], v24 offset:32768
    ds_read_b64_tr_b16 v[104:105], v26 offset:22528
    ds_read_b64_tr_b16 v[106:107], v26 offset:23040
    v_mfma_f32_32x32x16_bf16 v[48:63], v[72:75], v[64:67], v[48:63]
    ds_read_b64_tr_b16 v[108:109], v27 offset:22528
    ds_read_b64_tr_b16 v[110:111], v27 offset:23040
    s_waitcnt lgkmcnt(10)
    v_mfma_f32_32x32x16_bf16 v[32:47], v[80:83], v[76:79], v[32:47]
    s_barrier
    ds_read_b128 v[64:67], v21 offset:49152
    ds_read_b64_tr_b16 v[68:69], v26 offset:24576
    ds_read_b64_tr_b16 v[70:71], v26 offset:25088
    v_mfma_f32_32x32x16_bf16 v[48:63], v[84:87], v[76:79], v[48:63]
    ds_read_b64_tr_b16 v[72:73], v27 offset:24576
    ds_read_b64_tr_b16 v[74:75], v27 offset:25088
    s_waitcnt lgkmcnt(10)
    v_mfma_f32_32x32x16_bf16 v[32:47], v[92:95], v[88:91], v[32:47]
    ds_read_b128 v[76:79], v22 offset:49152
    ds_read_b64_tr_b16 v[80:81], v26 offset:26624
    ds_read_b64_tr_b16 v[82:83], v26 offset:27136
    v_mfma_f32_32x32x16_bf16 v[48:63], v[96:99], v[88:91], v[48:63]
    ds_read_b64_tr_b16 v[84:85], v27 offset:26624
    ds_read_b64_tr_b16 v[86:87], v27 offset:27136
    s_waitcnt lgkmcnt(10)
    v_mfma_f32_32x32x16_bf16 v[32:47], v[104:107], v[100:103], v[32:47]
    ds_read_b128 v[88:91], v23 offset:49152
    ds_read_b64_tr_b16 v[92:93], v26 offset:28672
    ds_read_b64_tr_b16 v[94:95], v26 offset:29184
    v_mfma_f32_32x32x16_bf16 v[48:63], v[108:111], v[100:103], v[48:63]
    ds_read_b64_tr_b16 v[96:97], v27 offset:28672
    ds_read_b64_tr_b16 v[98:99], v27 offset:29184
    s_waitcnt lgkmcnt(10)
    v_mfma_f32_32x32x16_bf16 v[32:47], v[68:71], v[64:67], v[32:47]
    ds_read_b128 v[100:103], v24 offset:49152
    ds_read_b64_tr_b16 v[104:105], v26 offset:30720
    ds_read_b64_tr_b16 v[106:107], v26 offset:31232
    v_mfma_f32_32x32x16_bf16 v[48:63], v[72:75], v[64:67], v[48:63]
    ds_read_b64_tr_b16 v[108:109], v27 offset:30720
    ds_read_b64_tr_b16 v[110:111], v27 offset:31232
    s_waitcnt lgkmcnt(10)
    v_mfma_f32_32x32x16_bf16 v[32:47], v[80:83], v[76:79], v[32:47]
    s_barrier
    v_add_u32 v21, 0x10000, v21
    ds_read_b128 v[64:67], v21 offset:0
    ds_read_b64_tr_b16 v[68:69], v26 offset:0
    ds_read_b64_tr_b16 v[70:71], v26 offset:512
    v_mfma_f32_32x32x16_bf16 v[48:63], v[84:87], v[76:79], v[48:63]
    ds_read_b64_tr_b16 v[72:73], v27 offset:0
    ds_read_b64_tr_b16 v[74:75], v27 offset:512
    s_waitcnt lgkmcnt(10)
    v_mfma_f32_32x32x16_bf16 v[32:47], v[92:95], v[88:91], v[32:47]
    v_add_u32 v22, 0x10000, v22
    ds_read_b128 v[76:79], v22 offset:0
    ds_read_b64_tr_b16 v[80:81], v26 offset:2048
    ds_read_b64_tr_b16 v[82:83], v26 offset:2560
    v_mfma_f32_32x32x16_bf16 v[48:63], v[96:99], v[88:91], v[48:63]
    ds_read_b64_tr_b16 v[84:85], v27 offset:2048
    ds_read_b64_tr_b16 v[86:87], v27 offset:2560
    s_waitcnt lgkmcnt(10)
    v_mfma_f32_32x32x16_bf16 v[32:47], v[104:107], v[100:103], v[32:47]
    v_add_u32 v23, 0x10000, v23
    ds_read_b128 v[88:91], v23 offset:0
    ds_read_b64_tr_b16 v[92:93], v26 offset:4096
    ds_read_b64_tr_b16 v[94:95], v26 offset:4608
    v_mfma_f32_32x32x16_bf16 v[48:63], v[108:111], v[100:103], v[48:63]
    ds_read_b64_tr_b16 v[96:97], v27 offset:4096
    ds_read_b64_tr_b16 v[98:99], v27 offset:4608
    s_waitcnt lgkmcnt(10)
    v_mfma_f32_32x32x16_bf16 v[32:47], v[68:71], v[64:67], v[32:47]
    v_add_u32 v24, 0x10000, v24
    ds_read_b128 v[100:103], v24 offset:0
    ds_read_b64_tr_b16 v[104:105], v26 offset:6144
    ds_read_b64_tr_b16 v[106:107], v26 offset:6656
    v_mfma_f32_32x32x16_bf16 v[48:63], v[72:75], v[64:67], v[48:63]
    ds_read_b64_tr_b16 v[108:109], v27 offset:6144
    ds_read_b64_tr_b16 v[110:111], v27 offset:6656
    s_waitcnt lgkmcnt(10)
    v_mfma_f32_32x32x16_bf16 v[32:47], v[80:83], v[76:79], v[32:47]
    s_barrier
    ds_read_b128 v[64:67], v21 offset:16384
    ds_read_b64_tr_b16 v[68:69], v2 offset:0
    ds_read_b64_tr_b16 v[70:71], v2 offset:512
    v_mfma_f32_32x32x16_bf16 v[48:63], v[84:87], v[76:79], v[48:63]
    ds_read_b64_tr_b16 v[72:73], v3 offset:0
    ds_read_b64_tr_b16 v[74:75], v3 offset:512
    s_waitcnt lgkmcnt(10)
    v_mfma_f32_32x32x16_bf16 v[32:47], v[92:95], v[88:91], v[32:47]
    ds_read_b128 v[76:79], v22 offset:16384
    ds_read_b64_tr_b16 v[80:81], v2 offset:2048
    ds_read_b64_tr_b16 v[82:83], v2 offset:2560
    v_mfma_f32_32x32x16_bf16 v[48:63], v[96:99], v[88:91], v[48:63]
    ds_read_b64_tr_b16 v[84:85], v3 offset:2048
    ds_read_b64_tr_b16 v[86:87], v3 offset:2560
    s_waitcnt lgkmcnt(10)
    v_mfma_f32_32x32x16_bf16 v[32:47], v[104:107], v[100:103], v[32:47]
    ds_read_b128 v[88:91], v23 offset:16384
    ds_read_b64_tr_b16 v[92:93], v2 offset:4096
    ds_read_b64_tr_b16 v[94:95], v2 offset:4608
    v_mfma_f32_32x32x16_bf16 v[48:63], v[108:111], v[100:103], v[48:63]
    ds_read_b64_tr_b16 v[96:97], v3 offset:4096
    ds_read_b64_tr_b16 v[98:99], v3 offset:4608
    s_waitcnt lgkmcnt(10)
    v_mfma_f32_32x32x16_bf16 v[32:47], v[68:71], v[64:67], v[32:47]
    ds_read_b128 v[100:103], v24 offset:16384
    ds_read_b64_tr_b16 v[104:105], v2 offset:6144
    ds_read_b64_tr_b16 v[106:107], v2 offset:6656
    v_mfma_f32_32x32x16_bf16 v[48:63], v[72:75], v[64:67], v[48:63]
    ds_read_b64_tr_b16 v[108:109], v3 offset:6144
    ds_read_b64_tr_b16 v[110:111], v3 offset:6656
    s_waitcnt lgkmcnt(10)
    v_mfma_f32_32x32x16_bf16 v[32:47], v[80:83], v[76:79], v[32:47]
    s_barrier
    ds_read_b128 v[64:67], v21 offset:32768
    ds_read_b64_tr_b16 v[68:69], v2 offset:8192
    ds_read_b64_tr_b16 v[70:71], v2 offset:8704
    v_mfma_f32_32x32x16_bf16 v[48:63], v[84:87], v[76:79], v[48:63]
    ds_read_b64_tr_b16 v[72:73], v3 offset:8192
    ds_read_b64_tr_b16 v[74:75], v3 offset:8704
    s_waitcnt lgkmcnt(10)
    v_mfma_f32_32x32x16_bf16 v[32:47], v[92:95], v[88:91], v[32:47]
    ds_read_b128 v[76:79], v22 offset:32768
    ds_read_b64_tr_b16 v[80:81], v2 offset:10240
    ds_read_b64_tr_b16 v[82:83], v2 offset:10752
    v_mfma_f32_32x32x16_bf16 v[48:63], v[96:99], v[88:91], v[48:63]
    ds_read_b64_tr_b16 v[84:85], v3 offset:10240
    ds_read_b64_tr_b16 v[86:87], v3 offset:10752
    s_waitcnt lgkmcnt(10)
    v_mfma_f32_32x32x16_bf16 v[32:47], v[104:107], v[100:103], v[32:47]
    ds_read_b128 v[88:91], v23 offset:32768
    ds_read_b64_tr_b16 v[92:93], v2 offset:12288
    ds_read_b64_tr_b16 v[94:95], v2 offset:12800
    v_mfma_f32_32x32x16_bf16 v[48:63], v[108:111], v[100:103], v[48:63]
    ds_read_b64_tr_b16 v[96:97], v3 offset:12288
    ds_read_b64_tr_b16 v[98:99], v3 offset:12800
    s_waitcnt lgkmcnt(10)
    v_mfma_f32_32x32x16_bf16 v[32:47], v[68:71], v[64:67], v[32:47]
    ds_read_b128 v[100:103], v24 offset:32768
    ds_read_b64_tr_b16 v[104:105], v2 offset:14336
    ds_read_b64_tr_b16 v[106:107], v2 offset:14848
    v_mfma_f32_32x32x16_bf16 v[48:63], v[72:75], v[64:67], v[48:63]
    ds_read_b64_tr_b16 v[108:109], v3 offset:14336
    ds_read_b64_tr_b16 v[110:111], v3 offset:14848
    s_waitcnt lgkmcnt(10)
    v_mfma_f32_32x32x16_bf16 v[32:47], v[80:83], v[76:79], v[32:47]
    s_barrier
    ds_read_b128 v[64:67], v21 offset:49152
    ds_read_b64_tr_b16 v[68:69], v26 offset:8192
    ds_read_b64_tr_b16 v[70:71], v26 offset:8704
    v_mfma_f32_32x32x16_bf16 v[48:63], v[84:87], v[76:79], v[48:63]
    ds_read_b64_tr_b16 v[72:73], v27 offset:8192
    ds_read_b64_tr_b16 v[74:75], v27 offset:8704
    s_waitcnt lgkmcnt(10)
    v_mfma_f32_32x32x16_bf16 v[32:47], v[92:95], v[88:91], v[32:47]
    ds_read_b128 v[76:79], v22 offset:49152
    ds_read_b64_tr_b16 v[80:81], v26 offset:10240
    ds_read_b64_tr_b16 v[82:83], v26 offset:10752
    v_mfma_f32_32x32x16_bf16 v[48:63], v[96:99], v[88:91], v[48:63]
    ds_read_b64_tr_b16 v[84:85], v27 offset:10240
    ds_read_b64_tr_b16 v[86:87], v27 offset:10752
    s_waitcnt lgkmcnt(10)
    v_mfma_f32_32x32x16_bf16 v[32:47], v[104:107], v[100:103], v[32:47]
    ds_read_b128 v[88:91], v23 offset:49152
    ds_read_b64_tr_b16 v[92:93], v26 offset:12288
    ds_read_b64_tr_b16 v[94:95], v26 offset:12800
    v_mfma_f32_32x32x16_bf16 v[48:63], v[108:111], v[100:103], v[48:63]
    ds_read_b64_tr_b16 v[96:97], v27 offset:12288
    ds_read_b64_tr_b16 v[98:99], v27 offset:12800
    s_waitcnt lgkmcnt(10)
    v_mfma_f32_32x32x16_bf16 v[32:47], v[68:71], v[64:67], v[32:47]
    ds_read_b128 v[100:103], v24 offset:49152
    ds_read_b64_tr_b16 v[104:105], v26 offset:14336
    ds_read_b64_tr_b16 v[106:107], v26 offset:14848
    v_mfma_f32_32x32x16_bf16 v[48:63], v[72:75], v[64:67], v[48:63]
    ds_read_b64_tr_b16 v[108:109], v27 offset:14336
    ds_read_b64_tr_b16 v[110:111], v27 offset:14848
    s_waitcnt lgkmcnt(10)
    v_mfma_f32_32x32x16_bf16 v[32:47], v[80:83], v[76:79], v[32:47]
    s_barrier
    v_mfma_f32_32x32x16_bf16 v[48:63], v[84:87], v[76:79], v[48:63]
    s_waitcnt lgkmcnt(5)
    v_mfma_f32_32x32x16_bf16 v[32:47], v[92:95], v[88:91], v[32:47]
    v_mfma_f32_32x32x16_bf16 v[48:63], v[96:99], v[88:91], v[48:63]
    s_waitcnt lgkmcnt(0)
    v_mfma_f32_32x32x16_bf16 v[32:47], v[104:107], v[100:103], v[32:47]
    v_mfma_f32_32x32x16_bf16 v[48:63], v[108:111], v[100:103], v[48:63]
    s_waitcnt lgkmcnt(0)
    s_barrier
    s_load_dword s15, s[34:35], 0
    s_setprio 1
    s_nop 6
    v_cvt_pk_bf16_f32 v32, v32, v33
    v_cvt_pk_bf16_f32 v33, v34, v35
    v_cvt_pk_bf16_f32 v34, v36, v37
    v_cvt_pk_bf16_f32 v35, v38, v39
    v_cvt_pk_bf16_f32 v36, v40, v41
    v_cvt_pk_bf16_f32 v37, v42, v43
    v_cvt_pk_bf16_f32 v38, v44, v45
    v_cvt_pk_bf16_f32 v39, v46, v47
    v_cvt_pk_bf16_f32 v40, v48, v49
    v_cvt_pk_bf16_f32 v41, v50, v51
    v_cvt_pk_bf16_f32 v42, v52, v53
    v_cvt_pk_bf16_f32 v43, v54, v55
    v_cvt_pk_bf16_f32 v44, v56, v57
    v_cvt_pk_bf16_f32 v45, v58, v59
    v_cvt_pk_bf16_f32 v46, v60, v61
    v_cvt_pk_bf16_f32 v47, v62, v63
    v_mfma_f32_32x32x16_bf16 v[48:63], v[112:115], v[32:35], 0
    v_mfma_f32_32x32x16_bf16 v[64:79], v[116:119], v[36:39], 0
    s_mov_b32 exec_hi, 0
    buffer_store_dword v144, v1, s[56:59], s27 offen sc1
    s_mov_b64 exec, -1
    s_waitcnt lgkmcnt(0)
    s_cmp_lg_u32 s15, 0
    s_nop 6
    s_cbranch_scc1 L_nok_165
    s_mov_b32 s100, 0
L_nlp_166:
    s_sleep 16
    v_mov_b32 v17, 0
    global_load_dword v17, v17, s[34:35] sc1
    s_waitcnt vmcnt(0)
    s_nop 0
    v_readfirstlane_b32 s15, v17
    s_add_u32 s100, s100, 1
    s_cmp_ge_u32 s100, 20000
    s_cbranch_scc1 L_nok_165
    s_cmp_eq_u32 s15, 0
    s_cbranch_scc1 L_nlp_166
L_nok_165:
    v_mov_b32 v17, s15
    v_max3_f32 v8, v48, v49, v50
    v_max3_f32 v9, v51, v52, v53
    v_max3_f32 v10, v54, v55, v56
    v_max3_f32 v11, v57, v58, v59
    v_max3_f32 v8, v8, v60, v61
    v_max3_f32 v9, v9, v62, v63
    v_max3_f32 v8, v8, v10, v11
    v_max_f32 v8, v8, v9
    v_mul_f32 v8, 0xbfb8aa3b, v8
    v_pk_fma_f32 v[48:49], v[48:49], s[38:39], v[8:9] op_sel_hi:[1,1,0]
    v_pk_fma_f32 v[50:51], v[50:51], s[38:39], v[8:9] op_sel_hi:[1,1,0]
    v_pk_fma_f32 v[52:53], v[52:53], s[38:39], v[8:9] op_sel_hi:[1,1,0]
    v_pk_fma_f32 v[54:55], v[54:55], s[38:39], v[8:9] op_sel_hi:[1,1,0]
    v_pk_fma_f32 v[56:57], v[56:57], s[38:39], v[8:9] op_sel_hi:[1,1,0]
    v_pk_fma_f32 v[58:59], v[58:59], s[38:39], v[8:9] op_sel_hi:[1,1,0]
    v_pk_fma_f32 v[60:61], v[60:61], s[38:39], v[8:9] op_sel_hi:[1,1,0]
    v_pk_fma_f32 v[62:63], v[62:63], s[38:39], v[8:9] op_sel_hi:[1,1,0]
    v_exp_f32 v48, v48
    v_exp_f32 v49, v49
    v_exp_f32 v50, v50
    v_exp_f32 v51, v51
    v_exp_f32 v52, v52
    v_exp_f32 v53, v53
    v_exp_f32 v54, v54
    v_exp_f32 v55, v55
    v_exp_f32 v56, v56
    v_exp_f32 v57, v57
    v_exp_f32 v58, v58
    v_exp_f32 v59, v59
    v_exp_f32 v60, v60
    v_exp_f32 v61, v61
    v_exp_f32 v62, v62
    v_exp_f32 v63, v63
    v_pk_add_f32 v[8:9], v[48:49], v[50:51]
    v_pk_add_f32 v[10:11], v[52:53], v[54:55]
    v_pk_add_f32 v[8:9], v[8:9], v[56:57]
    v_pk_add_f32 v[10:11], v[10:11], v[58:59]
    v_pk_add_f32 v[8:9], v[8:9], v[60:61]
    v_pk_add_f32 v[10:11], v[10:11], v[62:63]
    v_pk_add_f32 v[8:9], v[8:9], v[10:11]
    v_add_f32 v8, v8, v9
    v_rcp_f32 v8, v8
    s_nop 0
    v_pk_mul_f32 v[48:49], v[48:49], v[8:9] op_sel_hi:[1,0]
    v_pk_mul_f32 v[50:51], v[50:51], v[8:9] op_sel_hi:[1,0]
    v_pk_mul_f32 v[52:53], v[52:53], v[8:9] op_sel_hi:[1,0]
    v_pk_mul_f32 v[54:55], v[54:55], v[8:9] op_sel_hi:[1,0]
    v_pk_mul_f32 v[56:57], v[56:57], v[8:9] op_sel_hi:[1,0]
    v_pk_mul_f32 v[58:59], v[58:59], v[8:9] op_sel_hi:[1,0]
    v_pk_mul_f32 v[60:61], v[60:61], v[8:9] op_sel_hi:[1,0]
    v_pk_mul_f32 v[62:63], v[62:63], v[8:9] op_sel_hi:[1,0]
    v_cvt_pk_bf16_f32 v128, v48, v49
    v_cvt_pk_bf16_f32 v129, v50, v51
    v_cvt_pk_bf16_f32 v130, v52, v53
    v_cvt_pk_bf16_f32 v131, v54, v55
    v_cvt_pk_bf16_f32 v132, v56, v57
    v_cvt_pk_bf16_f32 v133, v58, v59
    v_cvt_pk_bf16_f32 v134, v60, v61
    v_cvt_pk_bf16_f32 v135, v62, v63
    v_mfma_f32_32x32x16_bf16 v[48:63], v[120:123], v[40:43], 0
    v_max3_f32 v8, v64, v65, v66
    v_max3_f32 v9, v67, v68, v69
    v_max3_f32 v10, v70, v71, v72
    v_max3_f32 v11, v73, v74, v75
    v_max3_f32 v8, v8, v76, v77
    v_max3_f32 v9, v9, v78, v79
    v_max3_f32 v8, v8, v10, v11
    v_max_f32 v8, v8, v9
    v_mul_f32 v8, 0xbfb8aa3b, v8
    v_pk_fma_f32 v[64:65], v[64:65], s[38:39], v[8:9] op_sel_hi:[1,1,0]
    v_pk_fma_f32 v[66:67], v[66:67], s[38:39], v[8:9] op_sel_hi:[1,1,0]
    v_pk_fma_f32 v[68:69], v[68:69], s[38:39], v[8:9] op_sel_hi:[1,1,0]
    v_pk_fma_f32 v[70:71], v[70:71], s[38:39], v[8:9] op_sel_hi:[1,1,0]
    v_pk_fma_f32 v[72:73], v[72:73], s[38:39], v[8:9] op_sel_hi:[1,1,0]
    v_pk_fma_f32 v[74:75], v[74:75], s[38:39], v[8:9] op_sel_hi:[1,1,0]
    v_pk_fma_f32 v[76:77], v[76:77], s[38:39], v[8:9] op_sel_hi:[1,1,0]
    v_pk_fma_f32 v[78:79], v[78:79], s[38:39], v[8:9] op_sel_hi:[1,1,0]
    v_exp_f32 v64, v64
    v_exp_f32 v65, v65
    v_exp_f32 v66, v66
    v_exp_f32 v67, v67
    v_exp_f32 v68, v68
    v_exp_f32 v69, v69
    v_exp_f32 v70, v70
    v_exp_f32 v71, v71
    v_exp_f32 v72, v72
    v_exp_f32 v73, v73
    v_exp_f32 v74, v74
    v_exp_f32 v75, v75
    v_exp_f32 v76, v76
    v_exp_f32 v77, v77
    v_exp_f32 v78, v78
    v_exp_f32 v79, v79
    v_pk_add_f32 v[8:9], v[64:65], v[66:67]
    v_pk_add_f32 v[10:11], v[68:69], v[70:71]
    v_pk_add_f32 v[8:9], v[8:9], v[72:73]
    v_pk_add_f32 v[10:11], v[10:11], v[74:75]
    v_pk_add_f32 v[8:9], v[8:9], v[76:77]
    v_pk_add_f32 v[10:11], v[10:11], v[78:79]
    v_pk_add_f32 v[8:9], v[8:9], v[10:11]
    v_add_f32 v8, v8, v9
    v_rcp_f32 v8, v8
    s_nop 0
    v_pk_mul_f32 v[64:65], v[64:65], v[8:9] op_sel_hi:[1,0]
    v_pk_mul_f32 v[66:67], v[66:67], v[8:9] op_sel_hi:[1,0]
    v_pk_mul_f32 v[68:69], v[68:69], v[8:9] op_sel_hi:[1,0]
    v_pk_mul_f32 v[70:71], v[70:71], v[8:9] op_sel_hi:[1,0]
    v_pk_mul_f32 v[72:73], v[72:73], v[8:9] op_sel_hi:[1,0]
    v_pk_mul_f32 v[74:75], v[74:75], v[8:9] op_sel_hi:[1,0]
    v_pk_mul_f32 v[76:77], v[76:77], v[8:9] op_sel_hi:[1,0]
    v_pk_mul_f32 v[78:79], v[78:79], v[8:9] op_sel_hi:[1,0]
    v_cvt_pk_bf16_f32 v136, v64, v65
    v_cvt_pk_bf16_f32 v137, v66, v67
    v_cvt_pk_bf16_f32 v138, v68, v69
    v_cvt_pk_bf16_f32 v139, v70, v71
    v_cvt_pk_bf16_f32 v140, v72, v73
    v_cvt_pk_bf16_f32 v141, v74, v75
    v_cvt_pk_bf16_f32 v142, v76, v77
    v_cvt_pk_bf16_f32 v143, v78, v79
    v_mfma_f32_32x32x16_bf16 v[64:79], v[124:127], v[44:47], 0
    v_max3_f32 v8, v48, v49, v50
    v_max3_f32 v9, v51, v52, v53
    v_max3_f32 v10, v54, v55, v56
    v_max3_f32 v11, v57, v58, v59
    v_max3_f32 v8, v8, v60, v61
    v_max3_f32 v9, v9, v62, v63
    v_max3_f32 v8, v8, v10, v11
    v_max_f32 v8, v8, v9
    v_mul_f32 v8, 0xbfb8aa3b, v8
    v_pk_fma_f32 v[48:49], v[48:49], s[38:39], v[8:9] op_sel_hi:[1,1,0]
    v_pk_fma_f32 v[50:51], v[50:51], s[38:39], v[8:9] op_sel_hi:[1,1,0]
    v_pk_fma_f32 v[52:53], v[52:53], s[38:39], v[8:9] op_sel_hi:[1,1,0]
    v_pk_fma_f32 v[54:55], v[54:55], s[38:39], v[8:9] op_sel_hi:[1,1,0]
    v_pk_fma_f32 v[56:57], v[56:57], s[38:39], v[8:9] op_sel_hi:[1,1,0]
    v_pk_fma_f32 v[58:59], v[58:59], s[38:39], v[8:9] op_sel_hi:[1,1,0]
    v_pk_fma_f32 v[60:61], v[60:61], s[38:39], v[8:9] op_sel_hi:[1,1,0]
    v_pk_fma_f32 v[62:63], v[62:63], s[38:39], v[8:9] op_sel_hi:[1,1,0]
    v_exp_f32 v48, v48
    v_exp_f32 v49, v49
    v_exp_f32 v50, v50
    v_exp_f32 v51, v51
    v_exp_f32 v52, v52
    v_exp_f32 v53, v53
    v_exp_f32 v54, v54
    v_exp_f32 v55, v55
    v_exp_f32 v56, v56
    v_exp_f32 v57, v57
    v_exp_f32 v58, v58
    v_exp_f32 v59, v59
    v_exp_f32 v60, v60
    v_exp_f32 v61, v61
    v_exp_f32 v62, v62
    v_exp_f32 v63, v63
    v_pk_add_f32 v[8:9], v[48:49], v[50:51]
    v_pk_add_f32 v[10:11], v[52:53], v[54:55]
    v_pk_add_f32 v[8:9], v[8:9], v[56:57]
    v_pk_add_f32 v[10:11], v[10:11], v[58:59]
    v_pk_add_f32 v[8:9], v[8:9], v[60:61]
    v_pk_add_f32 v[10:11], v[10:11], v[62:63]
    v_pk_add_f32 v[8:9], v[8:9], v[10:11]
    v_add_f32 v8, v8, v9
    v_rcp_f32 v8, v8
    s_nop 0
    v_pk_mul_f32 v[48:49], v[48:49], v[8:9] op_sel_hi:[1,0]
    v_pk_mul_f32 v[50:51], v[50:51], v[8:9] op_sel_hi:[1,0]
    v_pk_mul_f32 v[52:53], v[52:53], v[8:9] op_sel_hi:[1,0]
    v_pk_mul_f32 v[54:55], v[54:55], v[8:9] op_sel_hi:[1,0]
    v_pk_mul_f32 v[56:57], v[56:57], v[8:9] op_sel_hi:[1,0]
    v_pk_mul_f32 v[58:59], v[58:59], v[8:9] op_sel_hi:[1,0]
    v_pk_mul_f32 v[60:61], v[60:61], v[8:9] op_sel_hi:[1,0]
    v_pk_mul_f32 v[62:63], v[62:63], v[8:9] op_sel_hi:[1,0]
    v_cvt_pk_bf16_f32 v144, v48, v49
    v_cvt_pk_bf16_f32 v145, v50, v51
    v_cvt_pk_bf16_f32 v146, v52, v53
    v_cvt_pk_bf16_f32 v147, v54, v55
    v_cvt_pk_bf16_f32 v148, v56, v57
    v_cvt_pk_bf16_f32 v149, v58, v59
    v_cvt_pk_bf16_f32 v150, v60, v61
    v_cvt_pk_bf16_f32 v151, v62, v63
    v_max3_f32 v8, v64, v65, v66
    v_max3_f32 v9, v67, v68, v69
    v_max3_f32 v10, v70, v71, v72
    v_max3_f32 v11, v73, v74, v75
    v_max3_f32 v8, v8, v76, v77
    v_max3_f32 v9, v9, v78, v79
    v_max3_f32 v8, v8, v10, v11
    v_max_f32 v8, v8, v9
    v_mul_f32 v8, 0xbfb8aa3b, v8
    v_pk_fma_f32 v[64:65], v[64:65], s[38:39], v[8:9] op_sel_hi:[1,1,0]
    v_pk_fma_f32 v[66:67], v[66:67], s[38:39], v[8:9] op_sel_hi:[1,1,0]
    v_pk_fma_f32 v[68:69], v[68:69], s[38:39], v[8:9] op_sel_hi:[1,1,0]
    v_pk_fma_f32 v[70:71], v[70:71], s[38:39], v[8:9] op_sel_hi:[1,1,0]
    v_pk_fma_f32 v[72:73], v[72:73], s[38:39], v[8:9] op_sel_hi:[1,1,0]
    v_pk_fma_f32 v[74:75], v[74:75], s[38:39], v[8:9] op_sel_hi:[1,1,0]
    v_pk_fma_f32 v[76:77], v[76:77], s[38:39], v[8:9] op_sel_hi:[1,1,0]
    v_pk_fma_f32 v[78:79], v[78:79], s[38:39], v[8:9] op_sel_hi:[1,1,0]
    v_exp_f32 v64, v64
    v_exp_f32 v65, v65
    v_exp_f32 v66, v66
    v_exp_f32 v67, v67
    v_exp_f32 v68, v68
    v_exp_f32 v69, v69
    v_exp_f32 v70, v70
    v_exp_f32 v71, v71
    v_exp_f32 v72, v72
    v_exp_f32 v73, v73
    v_exp_f32 v74, v74
    v_exp_f32 v75, v75
    v_exp_f32 v76, v76
    v_exp_f32 v77, v77
    v_exp_f32 v78, v78
    v_exp_f32 v79, v79
    v_pk_add_f32 v[8:9], v[64:65], v[66:67]
    s_add_u32 s40, s56, s23
    s_addc_u32 s41, s57, 0
    s_mov_b32 s42, s15
    s_mov_b32 s43, s15
    s_load_dwordx16 s[60:75], s[40:41], 0 glc
    v_pk_add_f32 v[10:11], v[68:69], v[70:71]
    v_pk_add_f32 v[8:9], v[8:9], v[72:73]
    v_pk_add_f32 v[10:11], v[10:11], v[74:75]
    v_pk_add_f32 v[8:9], v[8:9], v[76:77]
    v_pk_add_f32 v[10:11], v[10:11], v[78:79]
    v_pk_add_f32 v[8:9], v[8:9], v[10:11]
    v_add_f32 v8, v8, v9
    v_rcp_f32 v8, v8
    s_nop 0
    v_pk_mul_f32 v[64:65], v[64:65], v[8:9] op_sel_hi:[1,0]
    v_pk_mul_f32 v[66:67], v[66:67], v[8:9] op_sel_hi:[1,0]
    v_pk_mul_f32 v[68:69], v[68:69], v[8:9] op_sel_hi:[1,0]
    v_pk_mul_f32 v[70:71], v[70:71], v[8:9] op_sel_hi:[1,0]
    v_pk_mul_f32 v[72:73], v[72:73], v[8:9] op_sel_hi:[1,0]
    v_pk_mul_f32 v[74:75], v[74:75], v[8:9] op_sel_hi:[1,0]
    v_pk_mul_f32 v[76:77], v[76:77], v[8:9] op_sel_hi:[1,0]
    v_pk_mul_f32 v[78:79], v[78:79], v[8:9] op_sel_hi:[1,0]
    v_cvt_pk_bf16_f32 v152, v64, v65
    v_cvt_pk_bf16_f32 v153, v66, v67
    v_cvt_pk_bf16_f32 v154, v68, v69
    v_cvt_pk_bf16_f32 v155, v70, v71
    v_cvt_pk_bf16_f32 v156, v72, v73
    v_cvt_pk_bf16_f32 v157, v74, v75
    v_cvt_pk_bf16_f32 v158, v76, v77
    v_cvt_pk_bf16_f32 v159, v78, v79
    s_nop 1
    s_mov_b32 s100, 0
L_slp_168:
    s_waitcnt lgkmcnt(0)
    s_xor_b64 s[60:61], s[60:61], s[42:43]
    s_xor_b64 s[62:63], s[62:63], s[42:43]
    s_xor_b64 s[64:65], s[64:65], s[42:43]
    s_xor_b64 s[66:67], s[66:67], s[42:43]
    s_xor_b64 s[68:69], s[68:69], s[42:43]
    s_xor_b64 s[70:71], s[70:71], s[42:43]
    s_xor_b64 s[72:73], s[72:73], s[42:43]
    s_xor_b64 s[74:75], s[74:75], s[42:43]
    s_or_b64 s[60:61], s[60:61], s[62:63]
    s_or_b64 s[64:65], s[64:65], s[66:67]
    s_or_b64 s[68:69], s[68:69], s[70:71]
    s_or_b64 s[72:73], s[72:73], s[74:75]
    s_or_b64 s[60:61], s[60:61], s[64:65]
    s_or_b64 s[68:69], s[68:69], s[72:73]
    s_or_b64 s[60:61], s[60:61], s[68:69]
    s_cbranch_scc0 L_sok_167
    s_add_u32 s100, s100, 1
    s_cmp_ge_u32 s100, 20000
    s_cbranch_scc1 L_sok_167
    s_sleep 3
    s_load_dwordx16 s[60:75], s[40:41], 0 glc
    s_branch L_slp_168
L_sok_167:
L_sdn_169:
    buffer_load_dwordx4 v[12:15], v25, s[56:59], s24 offen sc1
    buffer_load_dwordx4 v[80:83], v6, s[56:59], s24 offen offset:0 sc1
    buffer_load_dwordx4 v[84:87], v6, s[56:59], s24 offen offset:1024 sc1
    buffer_load_dwordx4 v[88:91], v6, s[56:59], s24 offen offset:2048 sc1
    buffer_load_dwordx4 v[92:95], v6, s[56:59], s24 offen offset:3072 sc1
    s_add_u32 s24, s24, 4096
    buffer_load_dwordx4 v[96:99], v6, s[56:59], s24 offen offset:0 sc1
    buffer_load_dwordx4 v[100:103], v6, s[56:59], s24 offen offset:1024 sc1
    buffer_load_dwordx4 v[104:107], v6, s[56:59], s24 offen offset:2048 sc1
    buffer_load_dwordx4 v[108:111], v6, s[56:59], s24 offen offset:3072 sc1
    s_waitcnt vmcnt(8)
    v_mfma_f32_32x32x16_bf16 v[64:79], v[164:167], v[12:15], 0
    s_add_u32 s24, s24, 4096
    buffer_load_dwordx4 v[112:115], v6, s[56:59], s24 offen offset:0 sc1
    s_waitcnt vmcnt(8)
    v_mfma_f32_32x32x16_bf16 v[48:63], v[160:163], v[80:83], 0
    buffer_load_dwordx4 v[116:119], v6, s[56:59], s24 offen offset:1024 sc1
    s_waitcnt vmcnt(8)
    v_mfma_f32_32x32x16_bf16 v[48:63], v[160:163], v[84:87], v[48:63]
    buffer_load_dwordx4 v[120:123], v6, s[56:59], s24 offen offset:2048 sc1
    s_waitcnt vmcnt(8)
    v_mfma_f32_32x32x16_bf16 v[48:63], v[160:163], v[88:91], v[48:63]
    s_nop 1
    v_add_f32_dpp v72, v72, v72 row_ror:8 row_mask:0xf bank_mask:0xf
    v_add_f32_dpp v73, v73, v73 row_ror:8 row_mask:0xf bank_mask:0xf
    v_add_f32_dpp v74, v74, v74 row_ror:8 row_mask:0xf bank_mask:0xf
    v_add_f32_dpp v75, v75, v75 row_ror:8 row_mask:0xf bank_mask:0xf
    v_add_f32_dpp v76, v76, v76 row_ror:8 row_mask:0xf bank_mask:0xf
    buffer_load_dwordx4 v[124:127], v6, s[56:59], s24 offen offset:3072 sc1
    s_waitcnt vmcnt(8)
    v_mfma_f32_32x32x16_bf16 v[48:63], v[160:163], v[92:95], v[48:63]
    v_add_f32_dpp v77, v77, v77 row_ror:8 row_mask:0xf bank_mask:0xf
    v_add_f32_dpp v78, v78, v78 row_ror:8 row_mask:0xf bank_mask:0xf
    v_add_f32_dpp v79, v79, v79 row_ror:8 row_mask:0xf bank_mask:0xf
    v_add_f32_dpp v72, v72, v72 row_ror:4 row_mask:0xf bank_mask:0xf
    v_add_f32_dpp v73, v73, v73 row_ror:4 row_mask:0xf bank_mask:0xf
    s_add_u32 s24, s24, 4096
    buffer_load_dwordx4 v[32:35], v6, s[56:59], s24 offen offset:0 sc1
    s_waitcnt vmcnt(8)
    v_mfma_f32_32x32x16_bf16 v[48:63], v[160:163], v[96:99], v[48:63]
    v_add_f32_dpp v74, v74, v74 row_ror:4 row_mask:0xf bank_mask:0xf
    v_add_f32_dpp v75, v75, v75 row_ror:4 row_mask:0xf bank_mask:0xf
    v_add_f32_dpp v76, v76, v76 row_ror:4 row_mask:0xf bank_mask:0xf
    v_add_f32_dpp v77, v77, v77 row_ror:4 row_mask:0xf bank_mask:0xf
    v_add_f32_dpp v78, v78, v78 row_ror:4 row_mask:0xf bank_mask:0xf
    buffer_load_dwordx4 v[36:39], v6, s[56:59], s24 offen offset:1024 sc1
    s_waitcnt vmcnt(8)
    v_mfma_f32_32x32x16_bf16 v[48:63], v[160:163], v[100:103], v[48:63]
    v_add_f32_dpp v79, v79, v79 row_ror:4 row_mask:0xf bank_mask:0xf
    v_add_f32_dpp v72, v72, v72 row_ror:2 row_mask:0xf bank_mask:0xf
    v_add_f32_dpp v73, v73, v73 row_ror:2 row_mask:0xf bank_mask:0xf
    v_add_f32_dpp v74, v74, v74 row_ror:2 row_mask:0xf bank_mask:0xf
    v_add_f32_dpp v75, v75, v75 row_ror:2 row_mask:0xf bank_mask:0xf
    buffer_load_dwordx4 v[40:43], v6, s[56:59], s24 offen offset:2048 sc1
    s_waitcnt vmcnt(8)
    v_mfma_f32_32x32x16_bf16 v[48:63], v[160:163], v[104:107], v[48:63]
    v_add_f32_dpp v76, v76, v76 row_ror:2 row_mask:0xf bank_mask:0xf
    v_add_f32_dpp v77, v77, v77 row_ror:2 row_mask:0xf bank_mask:0xf
    v_add_f32_dpp v78, v78, v78 row_ror:2 row_mask:0xf bank_mask:0xf
    v_add_f32_dpp v79, v79, v79 row_ror:2 row_mask:0xf bank_mask:0xf
    v_add_f32_dpp v72, v72, v72 row_ror:1 row_mask:0xf bank_mask:0xf
    buffer_load_dwordx4 v[44:47], v6, s[56:59], s24 offen offset:3072 sc1
    s_waitcnt vmcnt(8)
    v_mfma_f32_32x32x16_bf16 v[48:63], v[160:163], v[108:111], v[48:63]
    v_add_f32_dpp v73, v73, v73 row_ror:1 row_mask:0xf bank_mask:0xf
    v_add_f32_dpp v74, v74, v74 row_ror:1 row_mask:0xf bank_mask:0xf
    v_add_f32_dpp v75, v75, v75 row_ror:1 row_mask:0xf bank_mask:0xf
    v_add_f32_dpp v76, v76, v76 row_ror:1 row_mask:0xf bank_mask:0xf
    v_add_f32_dpp v77, v77, v77 row_ror:1 row_mask:0xf bank_mask:0xf
    s_waitcnt vmcnt(7)
    v_mfma_f32_32x32x16_bf16 v[48:63], v[160:163], v[112:115], v[48:63]
    v_add_f32_dpp v78, v78, v78 row_ror:1 row_mask:0xf bank_mask:0xf
    v_add_f32_dpp v79, v79, v79 row_ror:1 row_mask:0xf bank_mask:0xf
    v_cvt_pk_bf16_f32 v64, v72, v73
    v_cvt_pk_bf16_f32 v65, v74, v75
    v_cvt_pk_bf16_f32 v66, v76, v77
    s_waitcnt vmcnt(6)
    v_mfma_f32_32x32x16_bf16 v[48:63], v[160:163], v[116:119], v[48:63]
    v_cvt_pk_bf16_f32 v67, v78, v79
    ds_write_b128 v29, v[64:67] offset:256
    v_add_u32 v25, 147456, v6
    s_mov_b32 s95, 0
    s_waitcnt vmcnt(5)
    v_mfma_f32_32x32x16_bf16 v[48:63], v[160:163], v[120:123], v[48:63]
    s_waitcnt vmcnt(4)
    v_mfma_f32_32x32x16_bf16 v[48:63], v[160:163], v[124:127], v[48:63]
    s_waitcnt vmcnt(3)
    v_mfma_f32_32x32x16_bf16 v[48:63], v[160:163], v[32:35], v[48:63]
    s_waitcnt vmcnt(2)
    v_mfma_f32_32x32x16_bf16 v[48:63], v[160:163], v[36:39], v[48:63]
    s_waitcnt vmcnt(1)
    v_mfma_f32_32x32x16_bf16 v[48:63], v[160:163], v[40:43], v[48:63]
    s_waitcnt vmcnt(0)
    v_mfma_f32_32x32x16_bf16 v[48:63], v[160:163], v[44:47], v[48:63]
    s_nop 11
    v_cvt_pk_bf16_f32 v48, v48, v49
    v_cvt_pk_bf16_f32 v49, v50, v51
    v_cvt_pk_bf16_f32 v50, v52, v53
    v_cvt_pk_bf16_f32 v51, v54, v55
    ds_write_b128 v29, v[48:51]
    v_mov_b32 v11, 1
    s_waitcnt lgkmcnt(0)
    ds_write_b32 v7, v11 offset:48
    s_cmp_ge_u32 s95, 1
    s_cbranch_scc1 L_cs_171
    s_mov_b32 s100, 0
L_cl_170:
    ds_read_b128 v[12:15], v16 offset:64
    s_add_u32 s100, s100, 1
    s_waitcnt lgkmcnt(0)
    v_min3_u32 v12, v12, v13, v14
    v_min_u32 v12, v12, v15
    s_nop 0
    v_readfirstlane_b32 s95, v12
    s_cmp_ge_u32 s100, 0x40000
    s_cbranch_scc1 L_cs_171
    s_cmp_lt_u32 s95, 1
    s_cbranch_scc1 L_cl_170
L_cs_171:
    ds_read_b128 v[80:83], v25 offset:0
    ds_read_b128 v[84:87], v25 offset:1024
    ds_read_b128 v[88:91], v25 offset:2048
    ds_read_b128 v[92:95], v25 offset:3072
    ds_read_b128 v[96:99], v25 offset:4096
    ds_read_b128 v[100:103], v25 offset:5120
    ds_read_b128 v[104:107], v25 offset:6144
    ds_read_b128 v[108:111], v25 offset:7168
    s_waitcnt lgkmcnt(6)
    v_mfma_f32_32x32x16_bf16 v[32:47], v[80:83], v[128:131], 0
    v_mfma_f32_32x32x16_bf16 v[32:47], v[84:87], v[132:135], v[32:47]
    s_waitcnt lgkmcnt(4)
    v_mfma_f32_32x32x16_bf16 v[48:63], v[88:91], v[136:139], 0
    v_mfma_f32_32x32x16_bf16 v[48:63], v[92:95], v[140:143], v[48:63]
    s_waitcnt lgkmcnt(2)
    v_mfma_f32_32x32x16_bf16 v[64:79], v[96:99], v[144:147], 0
    v_mfma_f32_32x32x16_bf16 v[64:79], v[100:103], v[148:151], v[64:79]
    s_waitcnt lgkmcnt(0)
    v_mfma_f32_32x32x16_bf16 v[112:127], v[104:107], v[152:155], 0
    v_mfma_f32_32x32x16_bf16 v[112:127], v[108:111], v[156:159], v[112:127]
    s_nop 2
    v_add_f32 v10, 0x358637bd, v40
    v_rcp_f32 v10, v10
    s_nop 0
    v_pk_mul_f32 v[32:33], v[32:33], v[10:11] op_sel_hi:[1,0]
    v_pk_mul_f32 v[34:35], v[34:35], v[10:11] op_sel_hi:[1,0]
    v_pk_mul_f32 v[36:37], v[36:37], v[10:11] op_sel_hi:[1,0]
    v_pk_mul_f32 v[38:39], v[38:39], v[10:11] op_sel_hi:[1,0]
    v_cvt_pk_bf16_f32 v32, v32, v33
    v_cvt_pk_bf16_f32 v33, v34, v35
    v_cvt_pk_bf16_f32 v34, v36, v37
    v_cvt_pk_bf16_f32 v35, v38, v39
    buffer_store_dwordx4 v[32:35], v6, s[56:59], s26 offen offset:0 sc1
    v_add_f32 v10, 0x358637bd, v56
    v_rcp_f32 v10, v10
    s_nop 0
    v_pk_mul_f32 v[48:49], v[48:49], v[10:11] op_sel_hi:[1,0]
    v_pk_mul_f32 v[50:51], v[50:51], v[10:11] op_sel_hi:[1,0]
    v_pk_mul_f32 v[52:53], v[52:53], v[10:11] op_sel_hi:[1,0]
    v_pk_mul_f32 v[54:55], v[54:55], v[10:11] op_sel_hi:[1,0]
    v_cvt_pk_bf16_f32 v48, v48, v49
    v_cvt_pk_bf16_f32 v49, v50, v51
    v_cvt_pk_bf16_f32 v50, v52, v53
    v_cvt_pk_bf16_f32 v51, v54, v55
    buffer_store_dwordx4 v[48:51], v6, s[56:59], s26 offen offset:1024 sc1
    v_add_f32 v10, 0x358637bd, v72
    v_rcp_f32 v10, v10
    s_nop 0
    v_pk_mul_f32 v[64:65], v[64:65], v[10:11] op_sel_hi:[1,0]
    v_pk_mul_f32 v[66:67], v[66:67], v[10:11] op_sel_hi:[1,0]
    v_pk_mul_f32 v[68:69], v[68:69], v[10:11] op_sel_hi:[1,0]
    v_pk_mul_f32 v[70:71], v[70:71], v[10:11] op_sel_hi:[1,0]
    v_cvt_pk_bf16_f32 v64, v64, v65
    v_cvt_pk_bf16_f32 v65, v66, v67
    v_cvt_pk_bf16_f32 v66, v68, v69
    v_cvt_pk_bf16_f32 v67, v70, v71
    buffer_store_dwordx4 v[64:67], v6, s[56:59], s26 offen offset:2048 sc1
    v_add_f32 v10, 0x358637bd, v120
    v_rcp_f32 v10, v10
    s_nop 0
    v_pk_mul_f32 v[112:113], v[112:113], v[10:11] op_sel_hi:[1,0]
    v_pk_mul_f32 v[114:115], v[114:115], v[10:11] op_sel_hi:[1,0]
    v_pk_mul_f32 v[116:117], v[116:117], v[10:11] op_sel_hi:[1,0]
    v_pk_mul_f32 v[118:119], v[118:119], v[10:11] op_sel_hi:[1,0]
    v_cvt_pk_bf16_f32 v112, v112, v113
    v_cvt_pk_bf16_f32 v113, v114, v115
    v_cvt_pk_bf16_f32 v114, v116, v117
    v_cvt_pk_bf16_f32 v115, v118, v119
    buffer_store_dwordx4 v[112:115], v6, s[56:59], s26 offen offset:3072 sc1
    s_waitcnt vmcnt(0)
    s_cmp_lg_u32 s29, 0
    s_cbranch_scc1 L_fl_172
    s_waitcnt vmcnt(0)
    s_mov_b64 exec, 1
    buffer_store_dword v17, off, s[56:59], s25 sc1
    s_mov_b64 exec, -1
    s_movk_i32 s29, 0x100
L_fl_172:
    s_endpgm
.p2align 6
L_code_end:
.section .rodata,"a"
.p2align 6
.amdhsa_kernel gated_mix__linear_kernel_hedgehog__dense_activation_relu__prompt_kernel
  .amdhsa_next_free_vgpr 168
  .amdhsa_next_free_sgpr 102
  .amdhsa_accum_offset 168
  .amdhsa_group_segment_fixed_size 0
  .amdhsa_kernarg_size 88
  .amdhsa_user_sgpr_count 2
  .amdhsa_user_sgpr_kernarg_segment_ptr 1
  .amdhsa_system_sgpr_workgroup_id_x 1
.end_amdhsa_kernel
```
